```python
import torch

def _softmax(x, axis=-1):
    return torch.softmax(x, dim=axis)

def _gelu(x):
    return torch.nn.functional.gelu(x, approximate='tanh')

def _silu(x):
    return torch.nn.functional.silu(x)

def _sigmoid(x):
    return torch.sigmoid(x)

def _layernorm(x, axis=-1, eps=1e-05):
    m = x.mean(dim=axis, keepdim=True)
    v = x.var(dim=axis, keepdim=True, unbiased=False)
    return (x - m) / torch.sqrt(v + eps)

def _scatter_add(tgt, idx, src, axis=0):
    return tgt.clone().index_add_(axis, idx, src)

def _segment_sum(src, seg, n):
    out = torch.zeros((n,) + src.shape[1:], dtype=src.dtype)
    return out.index_add_(0, seg, src)

def _pad(x, pw):
    flat = tuple((v for pair in reversed(pw) for v in pair))
    return torch.nn.functional.pad(x, flat)
kernel_name = 'interleave_layers__memory_aug_recurrent_mem_tr__mixer_channel_mlp__prompt'

def setup_inputs():

    _w = lambda a: (lambda t: t.to(torch.bfloat16) if t.is_floating_point() else t)(torch.as_tensor(a))

    def _A_setup():
        B, S, Dm = (1, 2048, 448)
        H, Dh = (16, 256)
        M, seg = (8, 32)
        seg = min(seg, S)
        S = S // seg * seg
        return {'x': _w((lambda *s: torch.randn(*s, dtype=torch.bfloat16) * 0.05)(B, S, Dm)), 'mem0': _w((lambda *s: torch.randn(*s, dtype=torch.bfloat16) * 0.8)(B, M, Dm)), 'Wq': _w((lambda *s: torch.randn(*s, dtype=torch.bfloat16) * 1.6)(Dm, H, Dh) * Dm ** (-0.5)), 'Wk': _w((lambda *s: torch.randn(*s, dtype=torch.bfloat16) * 1.6)(Dm, H, Dh) * Dm ** (-0.5)), 'Wv': _w((lambda *s: torch.randn(*s, dtype=torch.bfloat16) * 0.8)(Dm, H, Dh) * Dm ** (-0.5)), 'Wo': _w((lambda *s: torch.randn(*s, dtype=torch.bfloat16) * 0.8)(H, Dh, Dm) * (H * Dh) ** (-0.5)), 'seg_len': seg}
    _A_in = _A_setup()

    def _B_setup():
        B, S, D, F = (1, 2048, 448, 1792)
        return {'x': _w((lambda *s: torch.randn(*s, dtype=torch.bfloat16) * 0.05)(B, S, D)), 'w1': _w((lambda *s: torch.randn(*s, dtype=torch.bfloat16) * 3.2)(D, F) * D ** (-0.5)), 'b1': _w((lambda *s: torch.randn(*s, dtype=torch.bfloat16) * 1.6)(F)), 'w2': _w((lambda *s: torch.randn(*s, dtype=torch.bfloat16) * 0.1)(F, D) * F ** (-0.5)), 'b2': _w((lambda *s: torch.randn(*s, dtype=torch.bfloat16) * 0.1)(D))}
    _B_in = _B_setup()
    return {'A_x': _A_in['x'], 'A_mem0': _A_in['mem0'], 'A_Wq': _A_in['Wq'], 'A_Wk': _A_in['Wk'], 'A_Wv': _A_in['Wv'], 'A_Wo': _A_in['Wo'], 'A_seg_len': _A_in['seg_len'], 'B_x': _B_in['x'], 'B_w1': _B_in['w1'], 'B_b1': _B_in['b1'], 'B_w2': _B_in['w2'], 'B_b2': _B_in['b2']}

def reference(A_x, A_mem0, A_Wq, A_Wk, A_Wv, A_Wo, A_seg_len, B_x, B_w1, B_b1, B_w2, B_b2):

    def _A_ref(x, mem0, Wq, Wk, Wv, Wo, seg_len):
        B, S, Dm = x.shape
        H, Dh = (Wq.shape[1], Wq.shape[2])
        M = mem0.shape[1]
        scale = Dh ** (-0.5)
        n_seg = S // seg_len
        L = M + seg_len
        idx = torch.arange(L)
        mask = (idx[:, None] < M) | (idx[:, None] >= idx[None, :])
        mem = mem0
        outs = []
        for s in range(n_seg):
            xs = x[:, s * seg_len:(s + 1) * seg_len, :].clone()
            h = torch.concatenate([mem, xs], axis=1)
            q = torch.einsum('btd,dhe->bhte', h, Wq)
            k = torch.einsum('btd,dhe->bhte', h, Wk)
            v = torch.einsum('btd,dhe->bhte', h, Wv)
            scores = torch.einsum('bhqe,bhke->bhqk', q, k) * scale
            scores = torch.where(mask[None, None], scores, -1000000000.0)
            p = _softmax(scores, axis=-1)
            o = torch.einsum('bhqk,bhke->bhqe', p, v)
            o = torch.einsum('bhte,hed->btd', o, Wo)
            mem = o[:, :M, :].clone()
            outs.append(o[:, M:, :])
        return torch.concatenate(outs, axis=1)

    def _B_ref(x, w1, b1, w2, b2):
        y = _layernorm(x, axis=-1)
        h = _gelu(torch.einsum('bsd,df->bsf', y, w1) + b1)
        return torch.einsum('bsf,fd->bsd', h, w2) + b2
    x = A_x
    x = x + _A_ref(_layernorm(x, axis=-1), A_mem0, A_Wq, A_Wk, A_Wv, A_Wo, A_seg_len)
    x = x + _B_ref(_layernorm(x, axis=-1), B_w1, B_b1, B_w2, B_b2)
    x = x + _A_ref(_layernorm(x, axis=-1), A_mem0, A_Wq, A_Wk, A_Wv, A_Wo, A_seg_len)
    x = x + _B_ref(_layernorm(x, axis=-1), B_w1, B_b1, B_w2, B_b2)
    return x
```

```asm
; @launch grid=(256,1,1) block=(256,1,1) lds=163840
.amdgcn_target "amdgcn-amd-amdhsa--gfx950"
.text
.globl interleave_layers__memory_aug_recurrent_mem_tr__mixer_channel_mlp__prompt_kernel
.p2align 8
.type interleave_layers__memory_aug_recurrent_mem_tr__mixer_channel_mlp__prompt_kernel,@function
interleave_layers__memory_aug_recurrent_mem_tr__mixer_channel_mlp__prompt_kernel:
  s_cmp_ge_u32 s2, 256
  s_cbranch_scc1 K1_end
  s_load_dwordx4 s[92:95], s[0:1], 104
  s_load_dwordx4 s[40:43], s[0:1], 0
  s_load_dwordx8 s[44:51], s[0:1], 16
  s_getreg_b32 s9, hwreg(HW_REG_XCC_ID, 0, 3)
  v_lshrrev_b32 v1, 6, v0
  s_nop 0
  v_readfirstlane_b32 s8, v1
  v_and_b32 v1, 63, v0
  v_lshlrev_b32 v2, 4, v1
  s_getpc_b64 s[12:13]
  s_and_b32 s12, s12, 0xffffff00
  s_lshr_b32 s14, s2, 3
  s_lshl_b32 s14, s14, 2
  s_add_u32 s14, s14, s8
  s_lshl_b32 s14, s14, 9
  v_and_b32 v3, 3, v1
  v_lshl_add_u32 v3, v3, 7, s14
  v_min_u32 v3, K1_end-K1_top, v3
  global_load_dword v31, v3, s[12:13]
K1_top:
  s_mov_b32 s99, 2097152
  s_mov_b32 s98, 0
  s_lshl_b32 s14, s9, 2
  s_mov_b32 s3, 1
  s_waitcnt lgkmcnt(0)
  s_mov_b32 s4, s94
  s_mov_b32 s5, s95
  s_mov_b32 s6, 0x10000000
  s_mov_b32 s7, 0x20000
  s_mov_b32 s94, 256
  s_mov_b32 s95, 0x20000
  s_cmp_lg_u32 s8, 0
  s_cbranch_scc1 K1_nt
  s_atomic_add s3, s[92:93], s14 glc
K1_nt:
  s_and_b32 s37, s2, 7
  s_lshr_b32 s10, s2, 3
  s_cmp_ge_u32 s10, 28
  s_cbranch_scc1 K0_misc
  s_mul_i32 s14, s10, 9363
  s_lshr_b32 s14, s14, 16
  s_mul_i32 s15, s14, 7
  s_sub_u32 s12, s10, s15
  s_lshl_b32 s15, s37, 2
  s_add_u32 s14, s14, s15
  s_and_b32 s13, s14, 1
  s_lshr_b32 s11, s14, 1
  s_cmp_eq_u32 s13, 0
  s_cselect_b32 s20, s44, s48
  s_cselect_b32 s21, s45, s49
  s_cselect_b32 s24, s46, s50
  s_cselect_b32 s25, s47, s51
  s_mov_b32 s22, 3670016
  s_mov_b32 s23, 0x20000
  s_mov_b32 s26, 3670016
  s_mov_b32 s27, 0x20000
  v_lshrrev_b32 v10, 2, v1
  v_lshlrev_b32 v3, 13, v10
  v_and_b32 v11, 3, v1
  v_lshl_add_u32 v4, v11, 7, v3
  s_lshl_b32 s14, s12, 2
  s_add_u32 s14, s14, s8
  s_lshl_b32 s14, s14, 17
  s_lshl_b32 s28, s11, 9
  s_add_u32 s14, s14, s28
  buffer_load_dword v9, v4, s[20:23], s14 offen
  s_and_b32 s30, s8, 1
  s_lshr_b32 s31, s8, 1
  s_lshl_b32 s29, s8, 13
  s_cmp_eq_u32 s13, 1
  s_cbranch_scc1 K0_nB
  s_lshl_b32 s32, s12, 2
  s_add_u32 s32, s32, s8
  s_mul_i32 s33, s32, 9363
  s_lshr_b32 s33, s33, 16
  s_mul_i32 s34, s33, 7
  s_sub_u32 s34, s32, s34
  s_mul_i32 s33, s33, 112
  s_lshr_b32 s35, s34, 1
  s_lshl_b32 s35, s35, 3
  s_and_b32 s18, s34, 1
  s_lshl_b32 s18, s18, 1
  s_add_u32 s35, s35, s18
  s_lshl_b32 s18, s34, 1
  s_add_u32 s18, s18, 56
  s_cmp_lt_u32 s34, 4
  s_cselect_b32 s35, s35, s18
  s_cselect_b32 s18, 16, 8
  s_lshl_b32 s18, s18, 13
  s_lshl_b32 s19, s18, 1
  s_cmp_eq_u32 s34, 6
  s_cselect_b32 s35, 96, s35
  s_cselect_b32 s19, 16384, s19
  s_add_u32 s33, s33, s35
  s_lshl_b32 s33, s33, 13
  s_add_u32 s33, s33, s28
  v_lshrrev_b32 v10, 5, v1
  v_and_b32 v11, 31, v1
  v_xor_b32 v11, v11, v10
  v_lshlrev_b32 v11, 4, v11
  v_lshl_add_u32 v5, v10, 13, v11
  s_add_u32 s34, s33, 0
  s_add_u32 m0, s29, 0
  v_xor_b32 v10, 0, v5
  buffer_load_dwordx4 v10, s[24:27], s34 offen lds
  s_add_u32 s34, s33, 32768
  s_add_u32 m0, s29, 1024
  v_xor_b32 v10, 32, v5
  buffer_load_dwordx4 v10, s[24:27], s34 offen lds
  s_add_u32 s34, s33, 0
  s_add_u32 s34, s34, s18
  s_add_u32 m0, s29, 2048
  v_xor_b32 v10, 64, v5
  buffer_load_dwordx4 v10, s[24:27], s34 offen lds
  s_add_u32 s34, s33, 32768
  s_add_u32 s34, s34, s18
  s_add_u32 m0, s29, 3072
  v_xor_b32 v10, 96, v5
  buffer_load_dwordx4 v10, s[24:27], s34 offen lds
  s_add_u32 s34, s33, 0
  s_add_u32 s34, s34, s19
  s_add_u32 m0, s29, 4096
  v_xor_b32 v10, 128, v5
  buffer_load_dwordx4 v10, s[24:27], s34 offen lds
  s_add_u32 s34, s33, 32768
  s_add_u32 s34, s34, s19
  s_add_u32 m0, s29, 5120
  v_xor_b32 v10, 160, v5
  buffer_load_dwordx4 v10, s[24:27], s34 offen lds
  s_add_u32 s34, s33, 0
  s_add_u32 s34, s34, s18
  s_add_u32 s34, s34, s19
  s_add_u32 m0, s29, 6144
  v_xor_b32 v10, 192, v5
  buffer_load_dwordx4 v10, s[24:27], s34 offen lds
  s_add_u32 s34, s33, 32768
  s_add_u32 s34, s34, s18
  s_add_u32 s34, s34, s19
  s_add_u32 m0, s29, 7168
  v_xor_b32 v10, 224, v5
  buffer_load_dwordx4 v10, s[24:27], s34 offen lds
  s_mul_i32 s16, s11, 14
  s_lshl_b32 s32, s12, 1
  s_add_u32 s16, s16, s32
  s_add_u32 s16, s16, s30
  s_mul_i32 s16, s16, 28672
  s_mul_i32 s36, s11, 7
  s_add_u32 s36, s36, s12
  s_mov_b32 s18, 0x3db8aa3b
  s_branch K0_k
K0_nB:
  v_lshrrev_b32 v10, 3, v1
  v_mul_u32_u24 v10, 896, v10
  v_and_b32 v11, 7, v1
  v_lshl_add_u32 v5, v11, 4, v10
  s_lshl_b32 s33, s11, 2
  s_add_u32 s33, s33, s8
  s_mul_i32 s33, s33, 57344
  s_lshl_b32 s34, s12, 7
  s_add_u32 s33, s33, s34
  s_add_u32 m0, s29, 0
  s_add_u32 s34, s33, 0
  buffer_load_dwordx4 v5, s[24:27], s34 offen lds
  s_add_u32 m0, s29, 1024
  s_add_u32 s34, s33, 7168
  buffer_load_dwordx4 v5, s[24:27], s34 offen lds
  s_add_u32 m0, s29, 2048
  s_add_u32 s34, s33, 14336
  buffer_load_dwordx4 v5, s[24:27], s34 offen lds
  s_add_u32 m0, s29, 3072
  s_add_u32 s34, s33, 21504
  buffer_load_dwordx4 v5, s[24:27], s34 offen lds
  s_add_u32 m0, s29, 4096
  s_add_u32 s34, s33, 28672
  buffer_load_dwordx4 v5, s[24:27], s34 offen lds
  s_add_u32 m0, s29, 5120
  s_add_u32 s34, s33, 35840
  buffer_load_dwordx4 v5, s[24:27], s34 offen lds
  s_add_u32 m0, s29, 6144
  s_add_u32 s34, s33, 43008
  buffer_load_dwordx4 v5, s[24:27], s34 offen lds
  s_add_u32 m0, s29, 7168
  s_add_u32 s34, s33, 50176
  buffer_load_dwordx4 v5, s[24:27], s34 offen lds
  s_lshl_b32 s32, s12, 1
  s_add_u32 s32, s32, s30
  s_lshl_b32 s16, s32, 4
  s_add_u32 s16, s16, s11
  s_mul_i32 s16, s16, 28672
  s_add_u32 s16, s16, 7340032
  s_lshl_b32 s36, s12, 4
  s_add_u32 s36, s36, s11
  s_add_u32 s36, s36, 112
  s_mov_b32 s18, 1.0
K0_k:
  v_mov_b32 v24, -1
  v_mov_b32 v25, -1
  v_mov_b32 v26, -1
  v_mov_b32 v27, -1
  s_lshl_b32 s100, s2, 2
  s_add_u32 s100, s100, s8
  s_lshl_b32 s100, s100, 10
  s_add_u32 s100, s100, 28893184
fl_2:
  s_cmp_ge_u32 s100, 29753344
  s_cbranch_scc1 fd_3
  buffer_store_dwordx4 v[24:27], v2, s[4:7], s100 offen sc1
  s_add_u32 s100, s100, 1048576
  s_branch fl_2
fd_3:
  s_add_u32 s100, s100, 2752512
fl_4:
  s_cmp_ge_u32 s100, 32964608
  s_cbranch_scc1 fd_5
  buffer_store_dwordx4 v[24:27], v2, s[4:7], s100 offen sc1
  s_add_u32 s100, s100, 1048576
  s_branch fl_4
fd_5:
  s_add_u32 s100, s100, 1376256
fl_6:
  s_cmp_ge_u32 s100, 34799616
  s_cbranch_scc1 fd_7
  buffer_store_dwordx4 v[24:27], v2, s[4:7], s100 offen sc1
  s_add_u32 s100, s100, 1048576
  s_branch fl_6
fd_7:
  s_add_u32 s100, s100, 1376256
fl_8:
  s_cmp_ge_u32 s100, 36634624
  s_cbranch_scc1 fd_9
  buffer_store_dwordx4 v[24:27], v2, s[4:7], s100 offen sc1
  s_add_u32 s100, s100, 1048576
  s_branch fl_8
fd_9:
  s_add_u32 s100, s100, 1376256
fl_10:
  s_cmp_ge_u32 s100, 38469632
  s_cbranch_scc1 fd_11
  buffer_store_dwordx4 v[24:27], v2, s[4:7], s100 offen sc1
  s_add_u32 s100, s100, 1048576
  s_branch fl_10
fd_11:
  s_add_u32 s100, s100, 1376256
fl_12:
  s_cmp_ge_u32 s100, 40501248
  s_cbranch_scc1 fd_13
  buffer_store_dwordx4 v[24:27], v2, s[4:7], s100 offen sc1
  s_add_u32 s100, s100, 1048576
  s_branch fl_12
fd_13:
  s_add_u32 s100, s100, 1966080
fl_14:
  s_cmp_ge_u32 s100, 43122688
  s_cbranch_scc1 fd_15
  buffer_store_dwordx4 v[24:27], v2, s[4:7], s100 offen sc1
  s_add_u32 s100, s100, 1048576
  s_branch fl_14
fd_15:
  s_add_u32 s100, s100, 1966080
fl_16:
  s_cmp_ge_u32 s100, 45252608
  s_cbranch_scc1 fd_17
  buffer_store_dwordx4 v[24:27], v2, s[4:7], s100 offen sc1
  s_add_u32 s100, s100, 1048576
  s_branch fl_16
fd_17:
  s_add_u32 s100, s100, 491520
fl_18:
  s_cmp_ge_u32 s100, 45907968
  s_cbranch_scc1 fd_19
  buffer_store_dwordx4 v[24:27], v2, s[4:7], s100 offen sc1
  s_add_u32 s100, s100, 1048576
  s_branch fl_18
fd_19:
nf_1:
  v_lshrrev_b32 v10, 3, v1
  v_lshlrev_b32 v3, 13, v10
  v_bfe_u32 v10, v1, 4, 1
  s_lshl_b32 s14, s8, 1
  v_add_u32 v10, s14, v10
  v_and_b32 v11, 7, v1
  v_xor_b32 v10, v10, v11
  v_lshl_add_u32 v3, v10, 4, v3
  s_lshl_b32 s14, s8, 16
  s_add_u32 s28, s28, s14
  s_lshl_b32 s29, s8, 10
  s_add_u32 s29, s29, 32768
  s_add_u32 s14, s28, 0
  s_add_u32 m0, s29, 0
  s_nop 0
  buffer_load_dwordx4 v3, s[20:23], s14 offen lds
  s_add_u32 s14, s28, 1835008
  s_add_u32 m0, s29, 16384
  s_nop 0
  buffer_load_dwordx4 v3, s[20:23], s14 offen lds
  s_add_u32 s14, s28, 262144
  s_add_u32 m0, s29, 4096
  s_nop 0
  buffer_load_dwordx4 v3, s[20:23], s14 offen lds
  s_add_u32 s14, s28, 2097152
  s_add_u32 m0, s29, 20480
  s_nop 0
  buffer_load_dwordx4 v3, s[20:23], s14 offen lds
  s_add_u32 s14, s28, 524288
  s_add_u32 m0, s29, 8192
  s_nop 0
  buffer_load_dwordx4 v3, s[20:23], s14 offen lds
  s_add_u32 s14, s28, 2359296
  s_add_u32 m0, s29, 24576
  s_nop 0
  buffer_load_dwordx4 v3, s[20:23], s14 offen lds
  s_add_u32 s14, s28, 786432
  s_add_u32 m0, s29, 12288
  s_nop 0
  buffer_load_dwordx4 v3, s[20:23], s14 offen lds
  s_add_u32 s14, s28, 2621440
  s_add_u32 m0, s29, 28672
  s_nop 0
  buffer_load_dwordx4 v3, s[20:23], s14 offen lds
  s_add_u32 s14, s28, 1048576
  s_add_u32 m0, s29, 32768
  s_nop 0
  buffer_load_dwordx4 v3, s[20:23], s14 offen lds
  s_add_u32 s14, s28, 2883584
  s_add_u32 m0, s29, 49152
  s_nop 0
  buffer_load_dwordx4 v3, s[20:23], s14 offen lds
  s_add_u32 s14, s28, 1310720
  s_add_u32 m0, s29, 36864
  s_nop 0
  buffer_load_dwordx4 v3, s[20:23], s14 offen lds
  s_add_u32 s14, s28, 3145728
  s_add_u32 m0, s29, 53248
  s_nop 0
  buffer_load_dwordx4 v3, s[20:23], s14 offen lds
  s_add_u32 s14, s28, 1572864
  s_add_u32 m0, s29, 40960
  s_nop 0
  buffer_load_dwordx4 v3, s[20:23], s14 offen lds
  s_add_u32 s14, s28, 3407872
  s_add_u32 m0, s29, 57344
  s_nop 0
  buffer_load_dwordx4 v3, s[20:23], s14 offen lds
  s_add_u32 s14, s28, 128
  s_add_u32 m0, s29, 65536
  s_nop 0
  buffer_load_dwordx4 v3, s[20:23], s14 offen lds
  s_add_u32 s14, s28, 1835136
  s_add_u32 m0, s29, 81920
  s_nop 0
  buffer_load_dwordx4 v3, s[20:23], s14 offen lds
  s_add_u32 s14, s28, 262272
  s_add_u32 m0, s29, 69632
  s_nop 0
  buffer_load_dwordx4 v3, s[20:23], s14 offen lds
  s_add_u32 s14, s28, 2097280
  s_add_u32 m0, s29, 86016
  s_nop 0
  buffer_load_dwordx4 v3, s[20:23], s14 offen lds
  s_add_u32 s14, s28, 524416
  s_add_u32 m0, s29, 73728
  s_nop 0
  buffer_load_dwordx4 v3, s[20:23], s14 offen lds
  s_add_u32 s14, s28, 2359424
  s_add_u32 m0, s29, 90112
  s_nop 0
  buffer_load_dwordx4 v3, s[20:23], s14 offen lds
  s_add_u32 s14, s28, 786560
  s_add_u32 m0, s29, 77824
  s_nop 0
  buffer_load_dwordx4 v3, s[20:23], s14 offen lds
  s_add_u32 s14, s28, 2621568
  s_add_u32 m0, s29, 94208
  s_nop 0
  buffer_load_dwordx4 v3, s[20:23], s14 offen lds
  v_mov_b32 v6, 0x8000
  v_bfe_u32 v10, v1, 0, 2
  s_mov_b32 s100, 0x80
  v_mul_lo_u32 v10, v10, s100
  v_add_u32 v6, v6, v10
  v_bfe_u32 v10, v1, 2, 2
  s_mov_b32 s100, 0x400
  v_mul_lo_u32 v10, v10, s100
  v_add_u32 v6, v6, v10
  v_bfe_u32 v10, v1, 1, 3
  v_lshrrev_b32 v11, 4, v1
  v_xor_b32 v10, v10, v11
  v_lshl_add_u32 v6, v10, 4, v6
  s_lshl_b32 s15, s31, 14
  v_add_u32 v6, s15, v6
  v_xor_b32 v7, 64, v6
  v_add_u32 v8, 65536, v6
  v_add_u32 v20, 65536, v7
  s_cmp_eq_u32 s13, 1
  s_cbranch_scc1 K0_fB
  v_lshrrev_b32 v10, 4, v1
  v_and_b32 v11, 15, v1
  v_xor_b32 v10, v10, v11
  v_lshlrev_b32 v10, 4, v10
  v_lshl_add_u32 v5, v11, 9, v10
  s_lshl_b32 s15, s30, 14
  v_add_u32 v5, s15, v5
  s_waitcnt vmcnt(22)
  s_barrier
  v_xor_b32 v10, 0, v5
  ds_read_b128 v[32:35], v10 offset:0
  ds_read_b128 v[36:39], v10 offset:8192
  v_xor_b32 v10, 64, v5
  ds_read_b128 v[40:43], v10 offset:0
  ds_read_b128 v[44:47], v10 offset:8192
  v_xor_b32 v10, 128, v5
  ds_read_b128 v[48:51], v10 offset:0
  ds_read_b128 v[52:55], v10 offset:8192
  v_xor_b32 v10, 192, v5
  ds_read_b128 v[56:59], v10 offset:0
  ds_read_b128 v[60:63], v10 offset:8192
  v_xor_b32 v10, 256, v5
  ds_read_b128 v[64:67], v10 offset:0
  ds_read_b128 v[68:71], v10 offset:8192
  v_xor_b32 v10, 320, v5
  ds_read_b128 v[72:75], v10 offset:0
  ds_read_b128 v[76:79], v10 offset:8192
  v_xor_b32 v10, 384, v5
  ds_read_b128 v[80:83], v10 offset:0
  ds_read_b128 v[84:87], v10 offset:8192
  v_xor_b32 v10, 448, v5
  ds_read_b128 v[88:91], v10 offset:0
  ds_read_b128 v[92:95], v10 offset:8192
  s_branch K0_mm
K0_fB:
  v_mov_b32 v5, 0x0
  v_bfe_u32 v10, v1, 0, 2
  s_mov_b32 s100, 0x10
  v_mul_lo_u32 v10, v10, s100
  v_add_u32 v5, v5, v10
  v_bfe_u32 v10, v1, 2, 2
  s_mov_b32 s100, 0x80
  v_mul_lo_u32 v10, v10, s100
  v_add_u32 v5, v5, v10
  v_bfe_u32 v10, v1, 4, 2
  s_mov_b32 s100, 0x400
  v_mul_lo_u32 v10, v10, s100
  v_add_u32 v5, v5, v10
  s_lshl_b32 s15, s30, 6
  v_add_u32 v5, s15, v5
  s_waitcnt vmcnt(22)
  s_barrier
  ds_read_b64_tr_b16 v[32:33], v5 offset:0
  ds_read_b64_tr_b16 v[34:35], v5 offset:512
  ds_read_b64_tr_b16 v[36:37], v5 offset:8
  ds_read_b64_tr_b16 v[38:39], v5 offset:520
  ds_read_b64_tr_b16 v[40:41], v5 offset:4096
  ds_read_b64_tr_b16 v[42:43], v5 offset:4608
  ds_read_b64_tr_b16 v[44:45], v5 offset:4104
  ds_read_b64_tr_b16 v[46:47], v5 offset:4616
  ds_read_b64_tr_b16 v[48:49], v5 offset:8192
  ds_read_b64_tr_b16 v[50:51], v5 offset:8704
  ds_read_b64_tr_b16 v[52:53], v5 offset:8200
  ds_read_b64_tr_b16 v[54:55], v5 offset:8712
  ds_read_b64_tr_b16 v[56:57], v5 offset:12288
  ds_read_b64_tr_b16 v[58:59], v5 offset:12800
  ds_read_b64_tr_b16 v[60:61], v5 offset:12296
  ds_read_b64_tr_b16 v[62:63], v5 offset:12808
  ds_read_b64_tr_b16 v[64:65], v5 offset:16384
  ds_read_b64_tr_b16 v[66:67], v5 offset:16896
  ds_read_b64_tr_b16 v[68:69], v5 offset:16392
  ds_read_b64_tr_b16 v[70:71], v5 offset:16904
  ds_read_b64_tr_b16 v[72:73], v5 offset:20480
  ds_read_b64_tr_b16 v[74:75], v5 offset:20992
  ds_read_b64_tr_b16 v[76:77], v5 offset:20488
  ds_read_b64_tr_b16 v[78:79], v5 offset:21000
  ds_read_b64_tr_b16 v[80:81], v5 offset:24576
  ds_read_b64_tr_b16 v[82:83], v5 offset:25088
  ds_read_b64_tr_b16 v[84:85], v5 offset:24584
  ds_read_b64_tr_b16 v[86:87], v5 offset:25096
  ds_read_b64_tr_b16 v[88:89], v5 offset:28672
  ds_read_b64_tr_b16 v[90:91], v5 offset:29184
  ds_read_b64_tr_b16 v[92:93], v5 offset:28680
  ds_read_b64_tr_b16 v[94:95], v5 offset:29192
K0_mm:
  s_mul_i32 s15, s31, 7168
  s_add_u32 s16, s16, s15
  s_add_u32 s17, s16, 14336
  s_mov_b32 s19, s18
  s_waitcnt vmcnt(14)
  s_barrier
  ds_read_b128 v[96:99], v6 offset:0
  ds_read_b128 v[100:103], v6 offset:512
  ds_read_b128 v[104:107], v6 offset:4096
  ds_read_b128 v[108:111], v6 offset:4608
  ds_read_b128 v[112:115], v6 offset:8192
  s_waitcnt lgkmcnt(4)
  v_mfma_f32_16x16x32_bf16 v[128:131], v[96:99], v[32:35], 0
  ds_read_b128 v[116:119], v6 offset:8704
  v_mfma_f32_16x16x32_bf16 v[132:135], v[96:99], v[36:39], 0
  s_waitcnt lgkmcnt(4)
  v_mfma_f32_16x16x32_bf16 v[136:139], v[100:103], v[32:35], 0
  ds_read_b128 v[120:123], v6 offset:12288
  v_mfma_f32_16x16x32_bf16 v[140:143], v[100:103], v[36:39], 0
  s_waitcnt lgkmcnt(4)
  v_mfma_f32_16x16x32_bf16 v[144:147], v[104:107], v[32:35], 0
  ds_read_b128 v[124:127], v6 offset:12800
  v_mfma_f32_16x16x32_bf16 v[148:151], v[104:107], v[36:39], 0
  s_waitcnt lgkmcnt(4)
  v_mfma_f32_16x16x32_bf16 v[152:155], v[108:111], v[32:35], 0
  ds_read_b128 v[96:99], v7 offset:0
  v_mfma_f32_16x16x32_bf16 v[156:159], v[108:111], v[36:39], 0
  s_waitcnt lgkmcnt(4)
  v_mfma_f32_16x16x32_bf16 v[160:163], v[112:115], v[32:35], 0
  ds_read_b128 v[100:103], v7 offset:512
  v_mfma_f32_16x16x32_bf16 v[164:167], v[112:115], v[36:39], 0
  s_waitcnt lgkmcnt(4)
  v_mfma_f32_16x16x32_bf16 v[168:171], v[116:119], v[32:35], 0
  ds_read_b128 v[104:107], v7 offset:4096
  v_mfma_f32_16x16x32_bf16 v[172:175], v[116:119], v[36:39], 0
  s_waitcnt lgkmcnt(4)
  v_mfma_f32_16x16x32_bf16 v[176:179], v[120:123], v[32:35], 0
  ds_read_b128 v[108:111], v7 offset:4608
  v_mfma_f32_16x16x32_bf16 v[180:183], v[120:123], v[36:39], 0
  s_waitcnt lgkmcnt(4)
  v_mfma_f32_16x16x32_bf16 v[184:187], v[124:127], v[32:35], 0
  ds_read_b128 v[112:115], v7 offset:8192
  v_mfma_f32_16x16x32_bf16 v[188:191], v[124:127], v[36:39], 0
  s_waitcnt lgkmcnt(4)
  v_mfma_f32_16x16x32_bf16 v[128:131], v[96:99], v[40:43], v[128:131]
  ds_read_b128 v[116:119], v7 offset:8704
  v_mfma_f32_16x16x32_bf16 v[132:135], v[96:99], v[44:47], v[132:135]
  s_waitcnt lgkmcnt(4)
  v_mfma_f32_16x16x32_bf16 v[136:139], v[100:103], v[40:43], v[136:139]
  ds_read_b128 v[120:123], v7 offset:12288
  v_mfma_f32_16x16x32_bf16 v[140:143], v[100:103], v[44:47], v[140:143]
  s_waitcnt lgkmcnt(4)
  v_mfma_f32_16x16x32_bf16 v[144:147], v[104:107], v[40:43], v[144:147]
  ds_read_b128 v[124:127], v7 offset:12800
  v_mfma_f32_16x16x32_bf16 v[148:151], v[104:107], v[44:47], v[148:151]
  s_waitcnt lgkmcnt(4)
  v_mfma_f32_16x16x32_bf16 v[152:155], v[108:111], v[40:43], v[152:155]
  s_waitcnt vmcnt(8)
  s_barrier
  ds_read_b128 v[96:99], v6 offset:32768
  s_add_u32 s14, s28, 1048704
  v_mfma_f32_16x16x32_bf16 v[156:159], v[108:111], v[44:47], v[156:159]
  s_waitcnt lgkmcnt(4)
  v_mfma_f32_16x16x32_bf16 v[160:163], v[112:115], v[40:43], v[160:163]
  s_add_u32 m0, s29, 98304
  ds_read_b128 v[100:103], v6 offset:33280
  v_mfma_f32_16x16x32_bf16 v[164:167], v[112:115], v[44:47], v[164:167]
  s_waitcnt lgkmcnt(4)
  buffer_load_dwordx4 v3, s[20:23], s14 offen lds
  v_mfma_f32_16x16x32_bf16 v[168:171], v[116:119], v[40:43], v[168:171]
  s_add_u32 s14, s28, 2883712
  ds_read_b128 v[104:107], v6 offset:36864
  s_add_u32 m0, s29, 114688
  v_mfma_f32_16x16x32_bf16 v[172:175], v[116:119], v[44:47], v[172:175]
  s_waitcnt lgkmcnt(4)
  buffer_load_dwordx4 v3, s[20:23], s14 offen lds
  v_mfma_f32_16x16x32_bf16 v[176:179], v[120:123], v[40:43], v[176:179]
  s_add_u32 s14, s28, 1310848
  ds_read_b128 v[108:111], v6 offset:37376
  s_add_u32 m0, s29, 102400
  v_mfma_f32_16x16x32_bf16 v[180:183], v[120:123], v[44:47], v[180:183]
  s_waitcnt lgkmcnt(4)
  buffer_load_dwordx4 v3, s[20:23], s14 offen lds
  v_mfma_f32_16x16x32_bf16 v[184:187], v[124:127], v[40:43], v[184:187]
  s_add_u32 s14, s28, 3145856
  ds_read_b128 v[112:115], v6 offset:40960
  s_add_u32 m0, s29, 118784
  v_mfma_f32_16x16x32_bf16 v[188:191], v[124:127], v[44:47], v[188:191]
  s_waitcnt lgkmcnt(4)
  buffer_load_dwordx4 v3, s[20:23], s14 offen lds
  v_mfma_f32_16x16x32_bf16 v[192:195], v[96:99], v[32:35], 0
  s_add_u32 s14, s28, 1572992
  ds_read_b128 v[116:119], v6 offset:41472
  s_add_u32 m0, s29, 106496
  v_mfma_f32_16x16x32_bf16 v[196:199], v[96:99], v[36:39], 0
  s_waitcnt lgkmcnt(4)
  buffer_load_dwordx4 v3, s[20:23], s14 offen lds
  v_mfma_f32_16x16x32_bf16 v[200:203], v[100:103], v[32:35], 0
  s_add_u32 s14, s28, 3408000
  ds_read_b128 v[120:123], v7 offset:32768
  s_add_u32 m0, s29, 122880
  v_mfma_f32_16x16x32_bf16 v[204:207], v[100:103], v[36:39], 0
  s_waitcnt lgkmcnt(4)
  buffer_load_dwordx4 v3, s[20:23], s14 offen lds
  v_mfma_f32_16x16x32_bf16 v[208:211], v[104:107], v[32:35], 0
  ds_read_b128 v[124:127], v7 offset:33280
  v_mfma_f32_16x16x32_bf16 v[212:215], v[104:107], v[36:39], 0
  s_waitcnt lgkmcnt(4)
  v_mfma_f32_16x16x32_bf16 v[216:219], v[108:111], v[32:35], 0
  ds_read_b128 v[96:99], v7 offset:36864
  v_mfma_f32_16x16x32_bf16 v[220:223], v[108:111], v[36:39], 0
  s_waitcnt lgkmcnt(4)
  v_mfma_f32_16x16x32_bf16 v[224:227], v[112:115], v[32:35], 0
  ds_read_b128 v[100:103], v7 offset:37376
  v_mfma_f32_16x16x32_bf16 v[228:231], v[112:115], v[36:39], 0
  s_waitcnt lgkmcnt(4)
  v_mfma_f32_16x16x32_bf16 v[232:235], v[116:119], v[32:35], 0
  ds_read_b128 v[104:107], v7 offset:40960
  v_mfma_f32_16x16x32_bf16 v[236:239], v[116:119], v[36:39], 0
  s_waitcnt lgkmcnt(4)
  v_mfma_f32_16x16x32_bf16 v[192:195], v[120:123], v[40:43], v[192:195]
  ds_read_b128 v[108:111], v7 offset:41472
  v_mfma_f32_16x16x32_bf16 v[196:199], v[120:123], v[44:47], v[196:199]
  s_waitcnt lgkmcnt(4)
  v_mfma_f32_16x16x32_bf16 v[200:203], v[124:127], v[40:43], v[200:203]
  s_waitcnt vmcnt(6)
  s_barrier
  ds_read_b128 v[112:115], v8 offset:0
  s_add_u32 s14, s28, 256
  v_mfma_f32_16x16x32_bf16 v[204:207], v[124:127], v[44:47], v[204:207]
  s_waitcnt lgkmcnt(4)
  v_mfma_f32_16x16x32_bf16 v[208:211], v[96:99], v[40:43], v[208:211]
  s_add_u32 m0, s29, 0
  ds_read_b128 v[116:119], v8 offset:512
  v_mfma_f32_16x16x32_bf16 v[212:215], v[96:99], v[44:47], v[212:215]
  s_waitcnt lgkmcnt(4)
  buffer_load_dwordx4 v3, s[20:23], s14 offen lds
  v_mfma_f32_16x16x32_bf16 v[216:219], v[100:103], v[40:43], v[216:219]
  s_add_u32 s14, s28, 1835264
  ds_read_b128 v[120:123], v8 offset:4096
  s_add_u32 m0, s29, 16384
  v_mfma_f32_16x16x32_bf16 v[220:223], v[100:103], v[44:47], v[220:223]
  s_waitcnt lgkmcnt(4)
  buffer_load_dwordx4 v3, s[20:23], s14 offen lds
  v_mfma_f32_16x16x32_bf16 v[224:227], v[104:107], v[40:43], v[224:227]
  s_add_u32 s14, s28, 262400
  ds_read_b128 v[124:127], v8 offset:4608
  s_add_u32 m0, s29, 4096
  v_mfma_f32_16x16x32_bf16 v[228:231], v[104:107], v[44:47], v[228:231]
  s_waitcnt lgkmcnt(4)
  buffer_load_dwordx4 v3, s[20:23], s14 offen lds
  v_mfma_f32_16x16x32_bf16 v[232:235], v[108:111], v[40:43], v[232:235]
  s_add_u32 s14, s28, 2097408
  ds_read_b128 v[96:99], v8 offset:8192
  s_add_u32 m0, s29, 20480
  v_mfma_f32_16x16x32_bf16 v[236:239], v[108:111], v[44:47], v[236:239]
  s_waitcnt lgkmcnt(4)
  buffer_load_dwordx4 v3, s[20:23], s14 offen lds
  v_mfma_f32_16x16x32_bf16 v[128:131], v[112:115], v[48:51], v[128:131]
  s_add_u32 s14, s28, 524544
  ds_read_b128 v[100:103], v8 offset:8704
  s_add_u32 m0, s29, 8192
  v_mfma_f32_16x16x32_bf16 v[132:135], v[112:115], v[52:55], v[132:135]
  s_waitcnt lgkmcnt(4)
  buffer_load_dwordx4 v3, s[20:23], s14 offen lds
  v_mfma_f32_16x16x32_bf16 v[136:139], v[116:119], v[48:51], v[136:139]
  s_add_u32 s14, s28, 2359552
  ds_read_b128 v[104:107], v8 offset:12288
  s_add_u32 m0, s29, 24576
  v_mfma_f32_16x16x32_bf16 v[140:143], v[116:119], v[52:55], v[140:143]
  s_waitcnt lgkmcnt(4)
  buffer_load_dwordx4 v3, s[20:23], s14 offen lds
  v_mfma_f32_16x16x32_bf16 v[144:147], v[120:123], v[48:51], v[144:147]
  s_add_u32 s14, s28, 786688
  ds_read_b128 v[108:111], v8 offset:12800
  s_add_u32 m0, s29, 12288
  v_mfma_f32_16x16x32_bf16 v[148:151], v[120:123], v[52:55], v[148:151]
  s_waitcnt lgkmcnt(4)
  buffer_load_dwordx4 v3, s[20:23], s14 offen lds
  v_mfma_f32_16x16x32_bf16 v[152:155], v[124:127], v[48:51], v[152:155]
  s_add_u32 s14, s28, 2621696
  ds_read_b128 v[112:115], v20 offset:0
  s_add_u32 m0, s29, 28672
  v_mfma_f32_16x16x32_bf16 v[156:159], v[124:127], v[52:55], v[156:159]
  s_waitcnt lgkmcnt(4)
  buffer_load_dwordx4 v3, s[20:23], s14 offen lds
  v_mfma_f32_16x16x32_bf16 v[160:163], v[96:99], v[48:51], v[160:163]
  ds_read_b128 v[116:119], v20 offset:512
  v_mfma_f32_16x16x32_bf16 v[164:167], v[96:99], v[52:55], v[164:167]
  s_waitcnt lgkmcnt(4)
  v_mfma_f32_16x16x32_bf16 v[168:171], v[100:103], v[48:51], v[168:171]
  ds_read_b128 v[120:123], v20 offset:4096
  v_mfma_f32_16x16x32_bf16 v[172:175], v[100:103], v[52:55], v[172:175]
  s_waitcnt lgkmcnt(4)
  v_mfma_f32_16x16x32_bf16 v[176:179], v[104:107], v[48:51], v[176:179]
  ds_read_b128 v[124:127], v20 offset:4608
  v_mfma_f32_16x16x32_bf16 v[180:183], v[104:107], v[52:55], v[180:183]
  s_waitcnt lgkmcnt(4)
  v_mfma_f32_16x16x32_bf16 v[184:187], v[108:111], v[48:51], v[184:187]
  ds_read_b128 v[96:99], v20 offset:8192
  v_mfma_f32_16x16x32_bf16 v[188:191], v[108:111], v[52:55], v[188:191]
  s_waitcnt lgkmcnt(4)
  v_mfma_f32_16x16x32_bf16 v[128:131], v[112:115], v[56:59], v[128:131]
  ds_read_b128 v[100:103], v20 offset:8704
  v_mfma_f32_16x16x32_bf16 v[132:135], v[112:115], v[60:63], v[132:135]
  s_waitcnt lgkmcnt(4)
  v_mfma_f32_16x16x32_bf16 v[136:139], v[116:119], v[56:59], v[136:139]
  ds_read_b128 v[104:107], v20 offset:12288
  v_mfma_f32_16x16x32_bf16 v[140:143], v[116:119], v[60:63], v[140:143]
  s_waitcnt lgkmcnt(4)
  v_mfma_f32_16x16x32_bf16 v[144:147], v[120:123], v[56:59], v[144:147]
  ds_read_b128 v[108:111], v20 offset:12800
  v_mfma_f32_16x16x32_bf16 v[148:151], v[120:123], v[60:63], v[148:151]
  s_waitcnt lgkmcnt(4)
  v_mfma_f32_16x16x32_bf16 v[152:155], v[124:127], v[56:59], v[152:155]
  s_waitcnt vmcnt(8)
  s_barrier
  ds_read_b128 v[112:115], v8 offset:32768
  s_add_u32 s14, s28, 1048832
  v_mfma_f32_16x16x32_bf16 v[156:159], v[124:127], v[60:63], v[156:159]
  s_waitcnt lgkmcnt(4)
  v_mfma_f32_16x16x32_bf16 v[160:163], v[96:99], v[56:59], v[160:163]
  s_add_u32 m0, s29, 32768
  ds_read_b128 v[116:119], v8 offset:33280
  v_mfma_f32_16x16x32_bf16 v[164:167], v[96:99], v[60:63], v[164:167]
  s_waitcnt lgkmcnt(4)
  buffer_load_dwordx4 v3, s[20:23], s14 offen lds
  v_mfma_f32_16x16x32_bf16 v[168:171], v[100:103], v[56:59], v[168:171]
  s_add_u32 s14, s28, 2883840
  ds_read_b128 v[120:123], v8 offset:36864
  s_add_u32 m0, s29, 49152
  v_mfma_f32_16x16x32_bf16 v[172:175], v[100:103], v[60:63], v[172:175]
  s_waitcnt lgkmcnt(4)
  buffer_load_dwordx4 v3, s[20:23], s14 offen lds
  v_mfma_f32_16x16x32_bf16 v[176:179], v[104:107], v[56:59], v[176:179]
  s_add_u32 s14, s28, 1310976
  ds_read_b128 v[124:127], v8 offset:37376
  s_add_u32 m0, s29, 36864
  v_mfma_f32_16x16x32_bf16 v[180:183], v[104:107], v[60:63], v[180:183]
  s_waitcnt lgkmcnt(4)
  buffer_load_dwordx4 v3, s[20:23], s14 offen lds
  v_mfma_f32_16x16x32_bf16 v[184:187], v[108:111], v[56:59], v[184:187]
  s_add_u32 s14, s28, 3145984
  ds_read_b128 v[96:99], v8 offset:40960
  s_add_u32 m0, s29, 53248
  v_mfma_f32_16x16x32_bf16 v[188:191], v[108:111], v[60:63], v[188:191]
  s_waitcnt lgkmcnt(4)
  buffer_load_dwordx4 v3, s[20:23], s14 offen lds
  v_mfma_f32_16x16x32_bf16 v[192:195], v[112:115], v[48:51], v[192:195]
  s_add_u32 s14, s28, 1573120
  ds_read_b128 v[100:103], v8 offset:41472
  s_add_u32 m0, s29, 40960
  v_mfma_f32_16x16x32_bf16 v[196:199], v[112:115], v[52:55], v[196:199]
  s_waitcnt lgkmcnt(4)
  buffer_load_dwordx4 v3, s[20:23], s14 offen lds
  v_mfma_f32_16x16x32_bf16 v[200:203], v[116:119], v[48:51], v[200:203]
  s_add_u32 s14, s28, 3408128
  ds_read_b128 v[104:107], v20 offset:32768
  s_add_u32 m0, s29, 57344
  v_mfma_f32_16x16x32_bf16 v[204:207], v[116:119], v[52:55], v[204:207]
  s_waitcnt lgkmcnt(4)
  buffer_load_dwordx4 v3, s[20:23], s14 offen lds
  v_mfma_f32_16x16x32_bf16 v[208:211], v[120:123], v[48:51], v[208:211]
  ds_read_b128 v[108:111], v20 offset:33280
  v_mfma_f32_16x16x32_bf16 v[212:215], v[120:123], v[52:55], v[212:215]
  s_waitcnt lgkmcnt(4)
  v_mfma_f32_16x16x32_bf16 v[216:219], v[124:127], v[48:51], v[216:219]
  ds_read_b128 v[112:115], v20 offset:36864
  v_mfma_f32_16x16x32_bf16 v[220:223], v[124:127], v[52:55], v[220:223]
  s_waitcnt lgkmcnt(4)
  v_mfma_f32_16x16x32_bf16 v[224:227], v[96:99], v[48:51], v[224:227]
  ds_read_b128 v[116:119], v20 offset:37376
  v_mfma_f32_16x16x32_bf16 v[228:231], v[96:99], v[52:55], v[228:231]
  s_waitcnt lgkmcnt(4)
  v_mfma_f32_16x16x32_bf16 v[232:235], v[100:103], v[48:51], v[232:235]
  ds_read_b128 v[120:123], v20 offset:40960
  v_mfma_f32_16x16x32_bf16 v[236:239], v[100:103], v[52:55], v[236:239]
  s_waitcnt lgkmcnt(4)
  v_mfma_f32_16x16x32_bf16 v[192:195], v[104:107], v[56:59], v[192:195]
  ds_read_b128 v[124:127], v20 offset:41472
  v_mfma_f32_16x16x32_bf16 v[196:199], v[104:107], v[60:63], v[196:199]
  s_waitcnt lgkmcnt(4)
  v_mfma_f32_16x16x32_bf16 v[200:203], v[108:111], v[56:59], v[200:203]
  s_waitcnt vmcnt(6)
  s_barrier
  ds_read_b128 v[96:99], v6 offset:0
  s_add_u32 s14, s28, 384
  v_mfma_f32_16x16x32_bf16 v[204:207], v[108:111], v[60:63], v[204:207]
  s_waitcnt lgkmcnt(4)
  v_mfma_f32_16x16x32_bf16 v[208:211], v[112:115], v[56:59], v[208:211]
  s_add_u32 m0, s29, 65536
  ds_read_b128 v[100:103], v6 offset:512
  v_mfma_f32_16x16x32_bf16 v[212:215], v[112:115], v[60:63], v[212:215]
  s_waitcnt lgkmcnt(4)
  buffer_load_dwordx4 v3, s[20:23], s14 offen lds
  v_mfma_f32_16x16x32_bf16 v[216:219], v[116:119], v[56:59], v[216:219]
  s_add_u32 s14, s28, 1835392
  ds_read_b128 v[104:107], v6 offset:4096
  s_add_u32 m0, s29, 81920
  v_mfma_f32_16x16x32_bf16 v[220:223], v[116:119], v[60:63], v[220:223]
  s_waitcnt lgkmcnt(4)
  buffer_load_dwordx4 v3, s[20:23], s14 offen lds
  v_mfma_f32_16x16x32_bf16 v[224:227], v[120:123], v[56:59], v[224:227]
  s_add_u32 s14, s28, 262528
  ds_read_b128 v[108:111], v6 offset:4608
  s_add_u32 m0, s29, 69632
  v_mfma_f32_16x16x32_bf16 v[228:231], v[120:123], v[60:63], v[228:231]
  s_waitcnt lgkmcnt(4)
  buffer_load_dwordx4 v3, s[20:23], s14 offen lds
  v_mfma_f32_16x16x32_bf16 v[232:235], v[124:127], v[56:59], v[232:235]
  s_add_u32 s14, s28, 2097536
  ds_read_b128 v[112:115], v6 offset:8192
  s_add_u32 m0, s29, 86016
  v_mfma_f32_16x16x32_bf16 v[236:239], v[124:127], v[60:63], v[236:239]
  s_waitcnt lgkmcnt(4)
  buffer_load_dwordx4 v3, s[20:23], s14 offen lds
  v_mfma_f32_16x16x32_bf16 v[128:131], v[96:99], v[64:67], v[128:131]
  s_add_u32 s14, s28, 524672
  ds_read_b128 v[116:119], v6 offset:8704
  s_add_u32 m0, s29, 73728
  v_mfma_f32_16x16x32_bf16 v[132:135], v[96:99], v[68:71], v[132:135]
  s_waitcnt lgkmcnt(4)
  buffer_load_dwordx4 v3, s[20:23], s14 offen lds
  v_mfma_f32_16x16x32_bf16 v[136:139], v[100:103], v[64:67], v[136:139]
  s_add_u32 s14, s28, 2359680
  ds_read_b128 v[120:123], v6 offset:12288
  s_add_u32 m0, s29, 90112
  v_mfma_f32_16x16x32_bf16 v[140:143], v[100:103], v[68:71], v[140:143]
  s_waitcnt lgkmcnt(4)
  buffer_load_dwordx4 v3, s[20:23], s14 offen lds
  v_mfma_f32_16x16x32_bf16 v[144:147], v[104:107], v[64:67], v[144:147]
  s_add_u32 s14, s28, 786816
  ds_read_b128 v[124:127], v6 offset:12800
  s_add_u32 m0, s29, 77824
  v_mfma_f32_16x16x32_bf16 v[148:151], v[104:107], v[68:71], v[148:151]
  s_waitcnt lgkmcnt(4)
  buffer_load_dwordx4 v3, s[20:23], s14 offen lds
  v_mfma_f32_16x16x32_bf16 v[152:155], v[108:111], v[64:67], v[152:155]
  s_add_u32 s14, s28, 2621824
  ds_read_b128 v[96:99], v7 offset:0
  s_add_u32 m0, s29, 94208
  v_mfma_f32_16x16x32_bf16 v[156:159], v[108:111], v[68:71], v[156:159]
  s_waitcnt lgkmcnt(4)
  buffer_load_dwordx4 v3, s[20:23], s14 offen lds
  v_mfma_f32_16x16x32_bf16 v[160:163], v[112:115], v[64:67], v[160:163]
  ds_read_b128 v[100:103], v7 offset:512
  v_mfma_f32_16x16x32_bf16 v[164:167], v[112:115], v[68:71], v[164:167]
  s_waitcnt lgkmcnt(4)
  v_mfma_f32_16x16x32_bf16 v[168:171], v[116:119], v[64:67], v[168:171]
  ds_read_b128 v[104:107], v7 offset:4096
  v_mfma_f32_16x16x32_bf16 v[172:175], v[116:119], v[68:71], v[172:175]
  s_waitcnt lgkmcnt(4)
  v_mfma_f32_16x16x32_bf16 v[176:179], v[120:123], v[64:67], v[176:179]
  ds_read_b128 v[108:111], v7 offset:4608
  v_mfma_f32_16x16x32_bf16 v[180:183], v[120:123], v[68:71], v[180:183]
  s_waitcnt lgkmcnt(4)
  v_mfma_f32_16x16x32_bf16 v[184:187], v[124:127], v[64:67], v[184:187]
  ds_read_b128 v[112:115], v7 offset:8192
  v_mfma_f32_16x16x32_bf16 v[188:191], v[124:127], v[68:71], v[188:191]
  s_waitcnt lgkmcnt(4)
  v_mfma_f32_16x16x32_bf16 v[128:131], v[96:99], v[72:75], v[128:131]
  ds_read_b128 v[116:119], v7 offset:8704
  v_mfma_f32_16x16x32_bf16 v[132:135], v[96:99], v[76:79], v[132:135]
  s_waitcnt lgkmcnt(4)
  v_mfma_f32_16x16x32_bf16 v[136:139], v[100:103], v[72:75], v[136:139]
  ds_read_b128 v[120:123], v7 offset:12288
  v_mfma_f32_16x16x32_bf16 v[140:143], v[100:103], v[76:79], v[140:143]
  s_waitcnt lgkmcnt(4)
  v_mfma_f32_16x16x32_bf16 v[144:147], v[104:107], v[72:75], v[144:147]
  ds_read_b128 v[124:127], v7 offset:12800
  v_mfma_f32_16x16x32_bf16 v[148:151], v[104:107], v[76:79], v[148:151]
  s_waitcnt lgkmcnt(4)
  v_mfma_f32_16x16x32_bf16 v[152:155], v[108:111], v[72:75], v[152:155]
  s_waitcnt vmcnt(8)
  s_barrier
  ds_read_b128 v[96:99], v6 offset:32768
  s_add_u32 s14, s28, 1048960
  v_mfma_f32_16x16x32_bf16 v[156:159], v[108:111], v[76:79], v[156:159]
  s_waitcnt lgkmcnt(4)
  v_mfma_f32_16x16x32_bf16 v[160:163], v[112:115], v[72:75], v[160:163]
  s_add_u32 m0, s29, 98304
  ds_read_b128 v[100:103], v6 offset:33280
  v_mfma_f32_16x16x32_bf16 v[164:167], v[112:115], v[76:79], v[164:167]
  s_waitcnt lgkmcnt(4)
  buffer_load_dwordx4 v3, s[20:23], s14 offen lds
  v_mfma_f32_16x16x32_bf16 v[168:171], v[116:119], v[72:75], v[168:171]
  s_add_u32 s14, s28, 2883968
  ds_read_b128 v[104:107], v6 offset:36864
  s_add_u32 m0, s29, 114688
  v_mfma_f32_16x16x32_bf16 v[172:175], v[116:119], v[76:79], v[172:175]
  s_waitcnt lgkmcnt(4)
  buffer_load_dwordx4 v3, s[20:23], s14 offen lds
  v_mfma_f32_16x16x32_bf16 v[176:179], v[120:123], v[72:75], v[176:179]
  s_add_u32 s14, s28, 1311104
  ds_read_b128 v[108:111], v6 offset:37376
  s_add_u32 m0, s29, 102400
  v_mfma_f32_16x16x32_bf16 v[180:183], v[120:123], v[76:79], v[180:183]
  s_waitcnt lgkmcnt(4)
  buffer_load_dwordx4 v3, s[20:23], s14 offen lds
  v_mfma_f32_16x16x32_bf16 v[184:187], v[124:127], v[72:75], v[184:187]
  s_add_u32 s14, s28, 3146112
  ds_read_b128 v[112:115], v6 offset:40960
  s_add_u32 m0, s29, 118784
  v_mfma_f32_16x16x32_bf16 v[188:191], v[124:127], v[76:79], v[188:191]
  s_waitcnt lgkmcnt(4)
  buffer_load_dwordx4 v3, s[20:23], s14 offen lds
  v_mfma_f32_16x16x32_bf16 v[192:195], v[96:99], v[64:67], v[192:195]
  s_add_u32 s14, s28, 1573248
  ds_read_b128 v[116:119], v6 offset:41472
  s_add_u32 m0, s29, 106496
  v_mfma_f32_16x16x32_bf16 v[196:199], v[96:99], v[68:71], v[196:199]
  s_waitcnt lgkmcnt(4)
  buffer_load_dwordx4 v3, s[20:23], s14 offen lds
  v_mfma_f32_16x16x32_bf16 v[200:203], v[100:103], v[64:67], v[200:203]
  s_add_u32 s14, s28, 3408256
  ds_read_b128 v[120:123], v7 offset:32768
  s_add_u32 m0, s29, 122880
  v_mfma_f32_16x16x32_bf16 v[204:207], v[100:103], v[68:71], v[204:207]
  s_waitcnt lgkmcnt(4)
  buffer_load_dwordx4 v3, s[20:23], s14 offen lds
  v_mfma_f32_16x16x32_bf16 v[208:211], v[104:107], v[64:67], v[208:211]
  ds_read_b128 v[124:127], v7 offset:33280
  v_mfma_f32_16x16x32_bf16 v[212:215], v[104:107], v[68:71], v[212:215]
  s_waitcnt lgkmcnt(4)
  v_mfma_f32_16x16x32_bf16 v[216:219], v[108:111], v[64:67], v[216:219]
  ds_read_b128 v[96:99], v7 offset:36864
  v_mfma_f32_16x16x32_bf16 v[220:223], v[108:111], v[68:71], v[220:223]
  s_waitcnt lgkmcnt(4)
  v_mfma_f32_16x16x32_bf16 v[224:227], v[112:115], v[64:67], v[224:227]
  ds_read_b128 v[100:103], v7 offset:37376
  v_mfma_f32_16x16x32_bf16 v[228:231], v[112:115], v[68:71], v[228:231]
  s_waitcnt lgkmcnt(4)
  v_mfma_f32_16x16x32_bf16 v[232:235], v[116:119], v[64:67], v[232:235]
  ds_read_b128 v[104:107], v7 offset:40960
  v_mfma_f32_16x16x32_bf16 v[236:239], v[116:119], v[68:71], v[236:239]
  s_waitcnt lgkmcnt(4)
  v_mfma_f32_16x16x32_bf16 v[192:195], v[120:123], v[72:75], v[192:195]
  ds_read_b128 v[108:111], v7 offset:41472
  v_mfma_f32_16x16x32_bf16 v[196:199], v[120:123], v[76:79], v[196:199]
  s_waitcnt lgkmcnt(4)
  v_mfma_f32_16x16x32_bf16 v[200:203], v[124:127], v[72:75], v[200:203]
  s_waitcnt vmcnt(6)
  s_barrier
  ds_read_b128 v[112:115], v8 offset:0
  v_mfma_f32_16x16x32_bf16 v[204:207], v[124:127], v[76:79], v[204:207]
  s_waitcnt lgkmcnt(4)
  v_mfma_f32_16x16x32_bf16 v[208:211], v[96:99], v[72:75], v[208:211]
  ds_read_b128 v[116:119], v8 offset:512
  v_mfma_f32_16x16x32_bf16 v[212:215], v[96:99], v[76:79], v[212:215]
  s_waitcnt lgkmcnt(4)
  v_mfma_f32_16x16x32_bf16 v[216:219], v[100:103], v[72:75], v[216:219]
  ds_read_b128 v[120:123], v8 offset:4096
  v_mfma_f32_16x16x32_bf16 v[220:223], v[100:103], v[76:79], v[220:223]
  s_waitcnt lgkmcnt(4)
  v_mfma_f32_16x16x32_bf16 v[224:227], v[104:107], v[72:75], v[224:227]
  ds_read_b128 v[124:127], v8 offset:4608
  v_mfma_f32_16x16x32_bf16 v[228:231], v[104:107], v[76:79], v[228:231]
  s_waitcnt lgkmcnt(4)
  v_mfma_f32_16x16x32_bf16 v[232:235], v[108:111], v[72:75], v[232:235]
  ds_read_b128 v[96:99], v8 offset:8192
  v_mfma_f32_16x16x32_bf16 v[236:239], v[108:111], v[76:79], v[236:239]
  s_waitcnt lgkmcnt(4)
  v_mfma_f32_16x16x32_bf16 v[128:131], v[112:115], v[80:83], v[128:131]
  ds_read_b128 v[100:103], v8 offset:8704
  v_mfma_f32_16x16x32_bf16 v[132:135], v[112:115], v[84:87], v[132:135]
  s_waitcnt lgkmcnt(4)
  v_mfma_f32_16x16x32_bf16 v[136:139], v[116:119], v[80:83], v[136:139]
  ds_read_b128 v[104:107], v8 offset:12288
  v_mfma_f32_16x16x32_bf16 v[140:143], v[116:119], v[84:87], v[140:143]
  s_waitcnt lgkmcnt(4)
  v_mfma_f32_16x16x32_bf16 v[144:147], v[120:123], v[80:83], v[144:147]
  ds_read_b128 v[108:111], v8 offset:12800
  v_mfma_f32_16x16x32_bf16 v[148:151], v[120:123], v[84:87], v[148:151]
  s_waitcnt lgkmcnt(4)
  v_mfma_f32_16x16x32_bf16 v[152:155], v[124:127], v[80:83], v[152:155]
  ds_read_b128 v[112:115], v20 offset:0
  v_mfma_f32_16x16x32_bf16 v[156:159], v[124:127], v[84:87], v[156:159]
  s_waitcnt lgkmcnt(4)
  v_mfma_f32_16x16x32_bf16 v[160:163], v[96:99], v[80:83], v[160:163]
  ds_read_b128 v[116:119], v20 offset:512
  v_mfma_f32_16x16x32_bf16 v[164:167], v[96:99], v[84:87], v[164:167]
  s_waitcnt lgkmcnt(4)
  v_mfma_f32_16x16x32_bf16 v[168:171], v[100:103], v[80:83], v[168:171]
  ds_read_b128 v[120:123], v20 offset:4096
  v_mfma_f32_16x16x32_bf16 v[172:175], v[100:103], v[84:87], v[172:175]
  s_waitcnt lgkmcnt(4)
  v_mfma_f32_16x16x32_bf16 v[176:179], v[104:107], v[80:83], v[176:179]
  ds_read_b128 v[124:127], v20 offset:4608
  v_mfma_f32_16x16x32_bf16 v[180:183], v[104:107], v[84:87], v[180:183]
  s_waitcnt lgkmcnt(4)
  v_mfma_f32_16x16x32_bf16 v[184:187], v[108:111], v[80:83], v[184:187]
  ds_read_b128 v[96:99], v20 offset:8192
  v_mfma_f32_16x16x32_bf16 v[188:191], v[108:111], v[84:87], v[188:191]
  s_waitcnt lgkmcnt(4)
  v_mfma_f32_16x16x32_bf16 v[128:131], v[112:115], v[88:91], v[128:131]
  ds_read_b128 v[100:103], v20 offset:8704
  v_mfma_f32_16x16x32_bf16 v[132:135], v[112:115], v[92:95], v[132:135]
  s_waitcnt lgkmcnt(4)
  v_mfma_f32_16x16x32_bf16 v[136:139], v[116:119], v[88:91], v[136:139]
  ds_read_b128 v[104:107], v20 offset:12288
  v_mfma_f32_16x16x32_bf16 v[140:143], v[116:119], v[92:95], v[140:143]
  s_waitcnt lgkmcnt(4)
  v_mfma_f32_16x16x32_bf16 v[144:147], v[120:123], v[88:91], v[144:147]
  ds_read_b128 v[108:111], v20 offset:12800
  v_mfma_f32_16x16x32_bf16 v[148:151], v[120:123], v[92:95], v[148:151]
  s_waitcnt lgkmcnt(4)
  v_mfma_f32_16x16x32_bf16 v[152:155], v[124:127], v[88:91], v[152:155]
  s_waitcnt vmcnt(0)
  s_barrier
  ds_read_b128 v[112:115], v8 offset:32768
  v_mfma_f32_16x16x32_bf16 v[156:159], v[124:127], v[92:95], v[156:159]
  s_waitcnt lgkmcnt(4)
  v_mfma_f32_16x16x32_bf16 v[160:163], v[96:99], v[88:91], v[160:163]
  ds_read_b128 v[116:119], v8 offset:33280
  v_mfma_f32_16x16x32_bf16 v[164:167], v[96:99], v[92:95], v[164:167]
  s_waitcnt lgkmcnt(4)
  v_mfma_f32_16x16x32_bf16 v[168:171], v[100:103], v[88:91], v[168:171]
  ds_read_b128 v[120:123], v8 offset:36864
  v_mfma_f32_16x16x32_bf16 v[172:175], v[100:103], v[92:95], v[172:175]
  s_waitcnt lgkmcnt(4)
  v_mfma_f32_16x16x32_bf16 v[176:179], v[104:107], v[88:91], v[176:179]
  ds_read_b128 v[124:127], v8 offset:37376
  v_mul_f32 v128, s18, v128
  v_mfma_f32_16x16x32_bf16 v[180:183], v[104:107], v[92:95], v[180:183]
  s_waitcnt lgkmcnt(4)
  v_mul_f32 v129, s18, v129
  v_mul_f32 v130, s18, v130
  v_mfma_f32_16x16x32_bf16 v[184:187], v[108:111], v[88:91], v[184:187]
  ds_read_b128 v[96:99], v8 offset:40960
  v_mul_f32 v131, s18, v131
  v_mfma_f32_16x16x32_bf16 v[188:191], v[108:111], v[92:95], v[188:191]
  s_waitcnt lgkmcnt(4)
  v_mul_f32 v136, s18, v136
  v_mul_f32 v137, s18, v137
  v_mfma_f32_16x16x32_bf16 v[192:195], v[112:115], v[80:83], v[192:195]
  ds_read_b128 v[100:103], v8 offset:41472
  v_mul_f32 v138, s18, v138
  v_mfma_f32_16x16x32_bf16 v[196:199], v[112:115], v[84:87], v[196:199]
  s_waitcnt lgkmcnt(4)
  v_mul_f32 v139, s18, v139
  v_cvt_pk_bf16_f32 v128, v128, v129
  v_mfma_f32_16x16x32_bf16 v[200:203], v[116:119], v[80:83], v[200:203]
  ds_read_b128 v[104:107], v20 offset:32768
  v_cvt_pk_bf16_f32 v129, v130, v131
  v_mfma_f32_16x16x32_bf16 v[204:207], v[116:119], v[84:87], v[204:207]
  s_waitcnt lgkmcnt(4)
  v_cvt_pk_bf16_f32 v130, v136, v137
  v_cvt_pk_bf16_f32 v131, v138, v139
  v_mfma_f32_16x16x32_bf16 v[208:211], v[120:123], v[80:83], v[208:211]
  ds_read_b128 v[108:111], v20 offset:33280
  buffer_store_dwordx4 v[128:131], v2, s[4:7], s16 offen offset:0 sc1
  v_mfma_f32_16x16x32_bf16 v[212:215], v[120:123], v[84:87], v[212:215]
  s_waitcnt lgkmcnt(4)
  v_mul_f32 v132, s18, v132
  v_mul_f32 v133, s18, v133
  v_mfma_f32_16x16x32_bf16 v[216:219], v[124:127], v[80:83], v[216:219]
  ds_read_b128 v[112:115], v20 offset:36864
  v_mul_f32 v134, s18, v134
  v_mfma_f32_16x16x32_bf16 v[220:223], v[124:127], v[84:87], v[220:223]
  s_waitcnt lgkmcnt(4)
  v_mul_f32 v135, s18, v135
  v_mul_f32 v140, s18, v140
  v_mfma_f32_16x16x32_bf16 v[224:227], v[96:99], v[80:83], v[224:227]
  ds_read_b128 v[116:119], v20 offset:37376
  v_mul_f32 v141, s18, v141
  v_mfma_f32_16x16x32_bf16 v[228:231], v[96:99], v[84:87], v[228:231]
  s_waitcnt lgkmcnt(4)
  v_mul_f32 v142, s18, v142
  v_mul_f32 v143, s18, v143
  v_mfma_f32_16x16x32_bf16 v[232:235], v[100:103], v[80:83], v[232:235]
  ds_read_b128 v[120:123], v20 offset:40960
  v_cvt_pk_bf16_f32 v132, v132, v133
  v_mfma_f32_16x16x32_bf16 v[236:239], v[100:103], v[84:87], v[236:239]
  s_waitcnt lgkmcnt(4)
  v_cvt_pk_bf16_f32 v133, v134, v135
  v_cvt_pk_bf16_f32 v134, v140, v141
  v_mfma_f32_16x16x32_bf16 v[192:195], v[104:107], v[88:91], v[192:195]
  ds_read_b128 v[124:127], v20 offset:41472
  v_cvt_pk_bf16_f32 v135, v142, v143
  v_mfma_f32_16x16x32_bf16 v[196:199], v[104:107], v[92:95], v[196:199]
  s_waitcnt lgkmcnt(4)
  buffer_store_dwordx4 v[132:135], v2, s[4:7], s17 offen offset:0 sc1
  v_mul_f32 v144, s18, v144
  v_mfma_f32_16x16x32_bf16 v[200:203], v[108:111], v[88:91], v[200:203]
  v_mul_f32 v145, s18, v145
  v_mul_f32 v146, s18, v146
  v_mfma_f32_16x16x32_bf16 v[204:207], v[108:111], v[92:95], v[204:207]
  s_waitcnt lgkmcnt(3)
  v_mul_f32 v147, s18, v147
  v_mul_f32 v152, s18, v152
  v_mfma_f32_16x16x32_bf16 v[208:211], v[112:115], v[88:91], v[208:211]
  v_mul_f32 v153, s18, v153
  v_mul_f32 v154, s18, v154
  v_mfma_f32_16x16x32_bf16 v[212:215], v[112:115], v[92:95], v[212:215]
  s_waitcnt lgkmcnt(2)
  v_mul_f32 v155, s18, v155
  v_cvt_pk_bf16_f32 v144, v144, v145
  v_mfma_f32_16x16x32_bf16 v[216:219], v[116:119], v[88:91], v[216:219]
  v_cvt_pk_bf16_f32 v145, v146, v147
  v_cvt_pk_bf16_f32 v146, v152, v153
  v_mfma_f32_16x16x32_bf16 v[220:223], v[116:119], v[92:95], v[220:223]
  s_waitcnt lgkmcnt(1)
  v_cvt_pk_bf16_f32 v147, v154, v155
  v_mfma_f32_16x16x32_bf16 v[224:227], v[120:123], v[88:91], v[224:227]
  buffer_store_dwordx4 v[144:147], v2, s[4:7], s16 offen offset:1024 sc1
  v_mul_f32 v148, s18, v148
  v_mfma_f32_16x16x32_bf16 v[228:231], v[120:123], v[92:95], v[228:231]
  s_waitcnt lgkmcnt(0)
  v_mul_f32 v149, s18, v149
  v_mul_f32 v150, s18, v150
  v_mfma_f32_16x16x32_bf16 v[232:235], v[124:127], v[88:91], v[232:235]
  v_mul_f32 v151, s18, v151
  v_mul_f32 v156, s18, v156
  v_mfma_f32_16x16x32_bf16 v[236:239], v[124:127], v[92:95], v[236:239]
  v_mul_f32 v157, s18, v157
  v_mul_f32 v158, s18, v158
  v_mul_f32 v159, s18, v159
  v_cvt_pk_bf16_f32 v148, v148, v149
  v_cvt_pk_bf16_f32 v149, v150, v151
  v_cvt_pk_bf16_f32 v150, v156, v157
  v_cvt_pk_bf16_f32 v151, v158, v159
  buffer_store_dwordx4 v[148:151], v2, s[4:7], s17 offen offset:1024 sc1
  v_pk_mul_f32 v[160:161], v[160:161], s[18:19]
  v_pk_mul_f32 v[162:163], v[162:163], s[18:19]
  v_pk_mul_f32 v[168:169], v[168:169], s[18:19]
  v_pk_mul_f32 v[170:171], v[170:171], s[18:19]
  v_cvt_pk_bf16_f32 v160, v160, v161
  v_cvt_pk_bf16_f32 v161, v162, v163
  v_cvt_pk_bf16_f32 v162, v168, v169
  v_cvt_pk_bf16_f32 v163, v170, v171
  buffer_store_dwordx4 v[160:163], v2, s[4:7], s16 offen offset:2048 sc1
  v_pk_mul_f32 v[164:165], v[164:165], s[18:19]
  v_pk_mul_f32 v[166:167], v[166:167], s[18:19]
  v_pk_mul_f32 v[172:173], v[172:173], s[18:19]
  v_pk_mul_f32 v[174:175], v[174:175], s[18:19]
  v_cvt_pk_bf16_f32 v164, v164, v165
  v_cvt_pk_bf16_f32 v165, v166, v167
  v_cvt_pk_bf16_f32 v166, v172, v173
  v_cvt_pk_bf16_f32 v167, v174, v175
  buffer_store_dwordx4 v[164:167], v2, s[4:7], s17 offen offset:2048 sc1
  v_pk_mul_f32 v[176:177], v[176:177], s[18:19]
  v_pk_mul_f32 v[178:179], v[178:179], s[18:19]
  v_pk_mul_f32 v[184:185], v[184:185], s[18:19]
  v_pk_mul_f32 v[186:187], v[186:187], s[18:19]
  v_cvt_pk_bf16_f32 v176, v176, v177
  v_cvt_pk_bf16_f32 v177, v178, v179
  v_cvt_pk_bf16_f32 v178, v184, v185
  v_cvt_pk_bf16_f32 v179, v186, v187
  buffer_store_dwordx4 v[176:179], v2, s[4:7], s16 offen offset:3072 sc1
  v_pk_mul_f32 v[180:181], v[180:181], s[18:19]
  v_pk_mul_f32 v[182:183], v[182:183], s[18:19]
  v_pk_mul_f32 v[188:189], v[188:189], s[18:19]
  v_pk_mul_f32 v[190:191], v[190:191], s[18:19]
  v_cvt_pk_bf16_f32 v180, v180, v181
  v_cvt_pk_bf16_f32 v181, v182, v183
  v_cvt_pk_bf16_f32 v182, v188, v189
  v_cvt_pk_bf16_f32 v183, v190, v191
  buffer_store_dwordx4 v[180:183], v2, s[4:7], s17 offen offset:3072 sc1
  v_pk_mul_f32 v[192:193], v[192:193], s[18:19]
  v_pk_mul_f32 v[194:195], v[194:195], s[18:19]
  v_pk_mul_f32 v[200:201], v[200:201], s[18:19]
  v_pk_mul_f32 v[202:203], v[202:203], s[18:19]
  v_cvt_pk_bf16_f32 v192, v192, v193
  v_cvt_pk_bf16_f32 v193, v194, v195
  v_cvt_pk_bf16_f32 v194, v200, v201
  v_cvt_pk_bf16_f32 v195, v202, v203
  s_add_u32 s16, s16, 4096
  buffer_store_dwordx4 v[192:195], v2, s[4:7], s16 offen offset:0 sc1
  v_pk_mul_f32 v[196:197], v[196:197], s[18:19]
  v_pk_mul_f32 v[198:199], v[198:199], s[18:19]
  v_pk_mul_f32 v[204:205], v[204:205], s[18:19]
  v_pk_mul_f32 v[206:207], v[206:207], s[18:19]
  v_cvt_pk_bf16_f32 v196, v196, v197
  v_cvt_pk_bf16_f32 v197, v198, v199
  v_cvt_pk_bf16_f32 v198, v204, v205
  v_cvt_pk_bf16_f32 v199, v206, v207
  s_add_u32 s17, s17, 4096
  buffer_store_dwordx4 v[196:199], v2, s[4:7], s17 offen offset:0 sc1
  v_pk_mul_f32 v[208:209], v[208:209], s[18:19]
  v_pk_mul_f32 v[210:211], v[210:211], s[18:19]
  v_pk_mul_f32 v[216:217], v[216:217], s[18:19]
  v_pk_mul_f32 v[218:219], v[218:219], s[18:19]
  v_cvt_pk_bf16_f32 v208, v208, v209
  v_cvt_pk_bf16_f32 v209, v210, v211
  v_cvt_pk_bf16_f32 v210, v216, v217
  v_cvt_pk_bf16_f32 v211, v218, v219
  buffer_store_dwordx4 v[208:211], v2, s[4:7], s16 offen offset:1024 sc1
  v_pk_mul_f32 v[212:213], v[212:213], s[18:19]
  v_pk_mul_f32 v[214:215], v[214:215], s[18:19]
  v_pk_mul_f32 v[220:221], v[220:221], s[18:19]
  v_pk_mul_f32 v[222:223], v[222:223], s[18:19]
  v_cvt_pk_bf16_f32 v212, v212, v213
  v_cvt_pk_bf16_f32 v213, v214, v215
  v_cvt_pk_bf16_f32 v214, v220, v221
  v_cvt_pk_bf16_f32 v215, v222, v223
  buffer_store_dwordx4 v[212:215], v2, s[4:7], s17 offen offset:1024 sc1
  v_pk_mul_f32 v[224:225], v[224:225], s[18:19]
  v_pk_mul_f32 v[226:227], v[226:227], s[18:19]
  v_pk_mul_f32 v[232:233], v[232:233], s[18:19]
  v_pk_mul_f32 v[234:235], v[234:235], s[18:19]
  v_cvt_pk_bf16_f32 v224, v224, v225
  v_cvt_pk_bf16_f32 v225, v226, v227
  v_cvt_pk_bf16_f32 v226, v232, v233
  v_cvt_pk_bf16_f32 v227, v234, v235
  buffer_store_dwordx4 v[224:227], v2, s[4:7], s16 offen offset:2048 sc1
  v_pk_mul_f32 v[228:229], v[228:229], s[18:19]
  v_pk_mul_f32 v[230:231], v[230:231], s[18:19]
  v_pk_mul_f32 v[236:237], v[236:237], s[18:19]
  v_pk_mul_f32 v[238:239], v[238:239], s[18:19]
  v_cvt_pk_bf16_f32 v228, v228, v229
  v_cvt_pk_bf16_f32 v229, v230, v231
  v_cvt_pk_bf16_f32 v230, v236, v237
  v_cvt_pk_bf16_f32 v231, v238, v239
  buffer_store_dwordx4 v[228:231], v2, s[4:7], s17 offen offset:2048 sc1
  s_branch K0_done
K0_misc:
  s_lshl_b32 s11, s37, 2
  s_add_u32 s11, s11, s10
  s_sub_u32 s11, s11, 28
  s_lshl_b32 s16, s11, 12
  s_lshl_b32 s17, s8, 10
  s_add_u32 s17, s17, s16
  s_add_u32 s17, s17, 18874368
  s_and_b32 s16, s11, 29
  s_cmp_eq_u32 s16, 0
  s_cselect_b32 s16, 1, 0
  v_and_b32 v10, 15, v1
  v_cmp_gt_u32 vcc, 14, v10
  v_mov_b32 v24, s16
  s_nop 0
  v_cndmask_b32 v24, 0, v24, vcc
  v_mov_b32 v25, v24
  v_mov_b32 v26, v24
  v_mov_b32 v27, v24
  buffer_store_dwordx4 v[24:27], v2, s[4:7], s17 offen sc1
  s_mov_b32 s20, s40
  s_mov_b32 s21, s41
  s_mov_b32 s22, 1835008
  s_mov_b32 s23, 0x20000
  v_mov_b32 v3, 0x0
  v_bfe_u32 v10, v1, 0, 4
  s_mov_b32 s100, 0x380
  v_mul_lo_u32 v10, v10, s100
  v_add_u32 v3, v3, v10
  v_bfe_u32 v10, v1, 4, 2
  s_mov_b32 s100, 0x10
  v_mul_lo_u32 v10, v10, s100
  v_add_u32 v3, v3, v10
  s_lshl_b32 s12, s11, 2
  s_add_u32 s12, s12, s8
  s_mul_i32 s13, s12, 14336
  buffer_load_dwordx4 v[64:67], v3, s[20:23], s13 offen offset:0
  buffer_load_dwordx4 v[68:71], v3, s[20:23], s13 offen offset:64
  buffer_load_dwordx4 v[72:75], v3, s[20:23], s13 offen offset:128
  buffer_load_dwordx4 v[76:79], v3, s[20:23], s13 offen offset:192
  buffer_load_dwordx4 v[80:83], v3, s[20:23], s13 offen offset:256
  buffer_load_dwordx4 v[84:87], v3, s[20:23], s13 offen offset:320
  buffer_load_dwordx4 v[88:91], v3, s[20:23], s13 offen offset:384
  buffer_load_dwordx4 v[92:95], v3, s[20:23], s13 offen offset:448
  buffer_load_dwordx4 v[96:99], v3, s[20:23], s13 offen offset:512
  buffer_load_dwordx4 v[100:103], v3, s[20:23], s13 offen offset:576
  buffer_load_dwordx4 v[104:107], v3, s[20:23], s13 offen offset:640
  buffer_load_dwordx4 v[108:111], v3, s[20:23], s13 offen offset:704
  buffer_load_dwordx4 v[112:115], v3, s[20:23], s13 offen offset:768
  buffer_load_dwordx4 v[116:119], v3, s[20:23], s13 offen offset:832
  s_mov_b32 s24, s42
  s_mov_b32 s25, s43
  s_mov_b32 s26, 7168
  s_mov_b32 s27, 0x20000
  v_mov_b32 v3, 0x0
  v_bfe_u32 v10, v1, 0, 1
  s_mov_b32 s100, 0x4
  v_mul_lo_u32 v10, v10, s100
  v_add_u32 v3, v3, v10
  v_bfe_u32 v10, v1, 1, 3
  s_mov_b32 s100, 0x380
  v_mul_lo_u32 v10, v10, s100
  v_add_u32 v3, v3, v10
  v_bfe_u32 v10, v1, 4, 2
  s_mov_b32 s100, 0x20
  v_mul_lo_u32 v10, v10, s100
  v_add_u32 v3, v3, v10
  v_mov_b32 v4, 0x0
  v_bfe_u32 v10, v1, 0, 3
  s_mov_b32 s100, 0x380
  v_mul_lo_u32 v10, v10, s100
  v_add_u32 v4, v4, v10
  v_bfe_u32 v10, v1, 3, 3
  s_mov_b32 s100, 0x10
  v_mul_lo_u32 v10, v10, s100
  v_add_u32 v4, v4, v10
  s_min_u32 s16, s11, 6
  s_lshl_b32 s16, s16, 7
  buffer_load_dword v56, v3, s[24:27], s16 offen offset:0
  buffer_load_dword v57, v3, s[24:27], s16 offen offset:8
  buffer_load_dword v58, v3, s[24:27], s16 offen offset:16
  buffer_load_dword v59, v3, s[24:27], s16 offen offset:24
  buffer_load_dwordx4 v[60:63], v4, s[24:27], s16 offen
  v_mov_b32 v4, 0x0
  v_bfe_u32 v10, v1, 0, 4
  s_mov_b32 s100, 0x10
  v_mul_lo_u32 v10, v10, s100
  v_add_u32 v4, v4, v10
  v_bfe_u32 v10, v1, 4, 2
  s_mov_b32 s100, 0x200
  v_mul_lo_u32 v10, v10, s100
  v_add_u32 v4, v4, v10
  s_lshr_b32 s14, s12, 1
  s_mul_i32 s14, s14, 28672
  s_and_b32 s15, s12, 1
  s_lshl_b32 s15, s15, 8
  s_add_u32 s14, s14, s15
  s_add_u32 s15, s14, 27000832
  s_add_u32 s14, s14, 25165824
  v_mov_b32 v6, 0
  v_mov_b32 v8, 0
  v_mov_b32 v5, 0x3f803f80
  s_waitcnt vmcnt(19)
  s_barrier
  s_cmp_lg_u32 s8, 0
  s_cbranch_scc1 K0_ng
  s_mov_b32 s16, 1
  s_atomic_add s16, s[92:93], 64 glc
  s_waitcnt lgkmcnt(0)
  s_cmp_lg_u32 s16, 31
  s_cbranch_scc1 K0_ng
  s_mov_b64 exec, 1
  buffer_store_dword v5, off, s[92:95], 0 offset:128 sc1
  s_mov_b64 exec, -1
K0_ng:
  s_waitcnt vmcnt(0)
  v_min_u32 v64, -2, v64
  v_dot2c_f32_bf16 v6, v64, v5
  v_dot2c_f32_bf16 v8, v64, v64
  v_min_u32 v65, -2, v65
  v_dot2c_f32_bf16 v6, v65, v5
  v_dot2c_f32_bf16 v8, v65, v65
  v_min_u32 v66, -2, v66
  v_dot2c_f32_bf16 v6, v66, v5
  v_dot2c_f32_bf16 v8, v66, v66
  v_min_u32 v67, -2, v67
  v_dot2c_f32_bf16 v6, v67, v5
  v_dot2c_f32_bf16 v8, v67, v67
  v_min_u32 v68, -2, v68
  v_dot2c_f32_bf16 v6, v68, v5
  v_dot2c_f32_bf16 v8, v68, v68
  v_min_u32 v69, -2, v69
  v_dot2c_f32_bf16 v6, v69, v5
  v_dot2c_f32_bf16 v8, v69, v69
  v_min_u32 v70, -2, v70
  v_dot2c_f32_bf16 v6, v70, v5
  v_dot2c_f32_bf16 v8, v70, v70
  v_min_u32 v71, -2, v71
  v_dot2c_f32_bf16 v6, v71, v5
  v_dot2c_f32_bf16 v8, v71, v71
  v_min_u32 v72, -2, v72
  v_dot2c_f32_bf16 v6, v72, v5
  v_dot2c_f32_bf16 v8, v72, v72
  v_min_u32 v73, -2, v73
  v_dot2c_f32_bf16 v6, v73, v5
  v_dot2c_f32_bf16 v8, v73, v73
  v_min_u32 v74, -2, v74
  v_dot2c_f32_bf16 v6, v74, v5
  v_dot2c_f32_bf16 v8, v74, v74
  v_min_u32 v75, -2, v75
  v_dot2c_f32_bf16 v6, v75, v5
  v_dot2c_f32_bf16 v8, v75, v75
  v_min_u32 v76, -2, v76
  v_dot2c_f32_bf16 v6, v76, v5
  v_dot2c_f32_bf16 v8, v76, v76
  v_min_u32 v77, -2, v77
  v_dot2c_f32_bf16 v6, v77, v5
  v_dot2c_f32_bf16 v8, v77, v77
  v_min_u32 v78, -2, v78
  v_dot2c_f32_bf16 v6, v78, v5
  v_dot2c_f32_bf16 v8, v78, v78
  v_min_u32 v79, -2, v79
  v_dot2c_f32_bf16 v6, v79, v5
  v_dot2c_f32_bf16 v8, v79, v79
  v_min_u32 v80, -2, v80
  v_dot2c_f32_bf16 v6, v80, v5
  v_dot2c_f32_bf16 v8, v80, v80
  v_min_u32 v81, -2, v81
  v_dot2c_f32_bf16 v6, v81, v5
  v_dot2c_f32_bf16 v8, v81, v81
  v_min_u32 v82, -2, v82
  v_dot2c_f32_bf16 v6, v82, v5
  v_dot2c_f32_bf16 v8, v82, v82
  v_min_u32 v83, -2, v83
  v_dot2c_f32_bf16 v6, v83, v5
  v_dot2c_f32_bf16 v8, v83, v83
  v_min_u32 v84, -2, v84
  v_dot2c_f32_bf16 v6, v84, v5
  v_dot2c_f32_bf16 v8, v84, v84
  v_min_u32 v85, -2, v85
  v_dot2c_f32_bf16 v6, v85, v5
  v_dot2c_f32_bf16 v8, v85, v85
  v_min_u32 v86, -2, v86
  v_dot2c_f32_bf16 v6, v86, v5
  v_dot2c_f32_bf16 v8, v86, v86
  v_min_u32 v87, -2, v87
  v_dot2c_f32_bf16 v6, v87, v5
  v_dot2c_f32_bf16 v8, v87, v87
  v_min_u32 v88, -2, v88
  v_dot2c_f32_bf16 v6, v88, v5
  v_dot2c_f32_bf16 v8, v88, v88
  v_min_u32 v89, -2, v89
  v_dot2c_f32_bf16 v6, v89, v5
  v_dot2c_f32_bf16 v8, v89, v89
  v_min_u32 v90, -2, v90
  v_dot2c_f32_bf16 v6, v90, v5
  v_dot2c_f32_bf16 v8, v90, v90
  v_min_u32 v91, -2, v91
  v_dot2c_f32_bf16 v6, v91, v5
  v_dot2c_f32_bf16 v8, v91, v91
  v_min_u32 v92, -2, v92
  v_dot2c_f32_bf16 v6, v92, v5
  v_dot2c_f32_bf16 v8, v92, v92
  v_min_u32 v93, -2, v93
  v_dot2c_f32_bf16 v6, v93, v5
  v_dot2c_f32_bf16 v8, v93, v93
  v_min_u32 v94, -2, v94
  v_dot2c_f32_bf16 v6, v94, v5
  v_dot2c_f32_bf16 v8, v94, v94
  v_min_u32 v95, -2, v95
  v_dot2c_f32_bf16 v6, v95, v5
  v_dot2c_f32_bf16 v8, v95, v95
  v_min_u32 v96, -2, v96
  v_dot2c_f32_bf16 v6, v96, v5
  v_dot2c_f32_bf16 v8, v96, v96
  v_min_u32 v97, -2, v97
  v_dot2c_f32_bf16 v6, v97, v5
  v_dot2c_f32_bf16 v8, v97, v97
  v_min_u32 v98, -2, v98
  v_dot2c_f32_bf16 v6, v98, v5
  v_dot2c_f32_bf16 v8, v98, v98
  v_min_u32 v99, -2, v99
  v_dot2c_f32_bf16 v6, v99, v5
  v_dot2c_f32_bf16 v8, v99, v99
  v_min_u32 v100, -2, v100
  v_dot2c_f32_bf16 v6, v100, v5
  v_dot2c_f32_bf16 v8, v100, v100
  v_min_u32 v101, -2, v101
  v_dot2c_f32_bf16 v6, v101, v5
  v_dot2c_f32_bf16 v8, v101, v101
  v_min_u32 v102, -2, v102
  v_dot2c_f32_bf16 v6, v102, v5
  v_dot2c_f32_bf16 v8, v102, v102
  v_min_u32 v103, -2, v103
  v_dot2c_f32_bf16 v6, v103, v5
  v_dot2c_f32_bf16 v8, v103, v103
  v_min_u32 v104, -2, v104
  v_dot2c_f32_bf16 v6, v104, v5
  v_dot2c_f32_bf16 v8, v104, v104
  v_min_u32 v105, -2, v105
  v_dot2c_f32_bf16 v6, v105, v5
  v_dot2c_f32_bf16 v8, v105, v105
  v_min_u32 v106, -2, v106
  v_dot2c_f32_bf16 v6, v106, v5
  v_dot2c_f32_bf16 v8, v106, v106
  v_min_u32 v107, -2, v107
  v_dot2c_f32_bf16 v6, v107, v5
  v_dot2c_f32_bf16 v8, v107, v107
  v_min_u32 v108, -2, v108
  v_dot2c_f32_bf16 v6, v108, v5
  v_dot2c_f32_bf16 v8, v108, v108
  v_min_u32 v109, -2, v109
  v_dot2c_f32_bf16 v6, v109, v5
  v_dot2c_f32_bf16 v8, v109, v109
  v_min_u32 v110, -2, v110
  v_dot2c_f32_bf16 v6, v110, v5
  v_dot2c_f32_bf16 v8, v110, v110
  v_min_u32 v111, -2, v111
  v_dot2c_f32_bf16 v6, v111, v5
  v_dot2c_f32_bf16 v8, v111, v111
  v_min_u32 v112, -2, v112
  v_dot2c_f32_bf16 v6, v112, v5
  v_dot2c_f32_bf16 v8, v112, v112
  v_min_u32 v113, -2, v113
  v_dot2c_f32_bf16 v6, v113, v5
  v_dot2c_f32_bf16 v8, v113, v113
  v_min_u32 v114, -2, v114
  v_dot2c_f32_bf16 v6, v114, v5
  v_dot2c_f32_bf16 v8, v114, v114
  v_min_u32 v115, -2, v115
  v_dot2c_f32_bf16 v6, v115, v5
  v_dot2c_f32_bf16 v8, v115, v115
  v_min_u32 v116, -2, v116
  v_dot2c_f32_bf16 v6, v116, v5
  v_dot2c_f32_bf16 v8, v116, v116
  v_min_u32 v117, -2, v117
  v_dot2c_f32_bf16 v6, v117, v5
  v_dot2c_f32_bf16 v8, v117, v117
  v_min_u32 v118, -2, v118
  v_dot2c_f32_bf16 v6, v118, v5
  v_dot2c_f32_bf16 v8, v118, v118
  v_min_u32 v119, -2, v119
  v_dot2c_f32_bf16 v6, v119, v5
  v_dot2c_f32_bf16 v8, v119, v119
  buffer_store_dwordx4 v[64:67], v4, s[4:7], s15 offen offset:0 sc1
  buffer_store_dwordx4 v[68:71], v4, s[4:7], s15 offen offset:2048 sc1
  s_add_u32 s15, s15, 4096
  buffer_store_dwordx4 v[72:75], v4, s[4:7], s15 offen offset:0 sc1
  buffer_store_dwordx4 v[76:79], v4, s[4:7], s15 offen offset:2048 sc1
  s_add_u32 s15, s15, 4096
  buffer_store_dwordx4 v[80:83], v4, s[4:7], s15 offen offset:0 sc1
  buffer_store_dwordx4 v[84:87], v4, s[4:7], s15 offen offset:2048 sc1
  s_add_u32 s15, s15, 4096
  buffer_store_dwordx4 v[88:91], v4, s[4:7], s15 offen offset:0 sc1
  buffer_store_dwordx4 v[92:95], v4, s[4:7], s15 offen offset:2048 sc1
  s_add_u32 s15, s15, 4096
  buffer_store_dwordx4 v[96:99], v4, s[4:7], s15 offen offset:0 sc1
  buffer_store_dwordx4 v[100:103], v4, s[4:7], s15 offen offset:2048 sc1
  s_add_u32 s15, s15, 4096
  buffer_store_dwordx4 v[104:107], v4, s[4:7], s15 offen offset:0 sc1
  buffer_store_dwordx4 v[108:111], v4, s[4:7], s15 offen offset:2048 sc1
  s_add_u32 s15, s15, 4096
  buffer_store_dwordx4 v[112:115], v4, s[4:7], s15 offen offset:0 sc1
  buffer_store_dwordx4 v[116:119], v4, s[4:7], s15 offen offset:2048 sc1
  v_mov_b32 v10, v6
  s_nop 1
  v_permlane16_swap_b32 v10, v6
  v_add_f32 v6, v6, v10
  v_mov_b32 v10, v6
  s_nop 1
  v_permlane32_swap_b32 v10, v6
  v_add_f32 v6, v6, v10
  v_mov_b32 v10, v8
  s_nop 1
  v_permlane16_swap_b32 v10, v8
  v_add_f32 v8, v8, v10
  v_mov_b32 v10, v8
  s_nop 1
  v_permlane32_swap_b32 v10, v8
  v_add_f32 v8, v8, v10
  v_mul_f32 v6, 0xbb124925, v6
  v_mul_f32 v8, 0x3b124925, v8
  v_fma_f32 v8, -v6, v6, v8
  v_max_f32 v8, 0, v8
  v_add_f32 v8, 0x3727c5ac, v8
  v_rsq_f32 v8, v8
  s_nop 0
  v_mul_f32 v6, v6, v8
  v_lshlrev_b32 v10, 16, v64
  v_and_b32 v11, 0xffff0000, v64
  v_pk_fma_f32 v[10:11], v[10:11], v[8:9], v[6:7] op_sel_hi:[1,0,0]
  v_cvt_pk_bf16_f32 v128, v10, v11
  v_min_u32 v128, -2, v128
  v_lshlrev_b32 v10, 16, v65
  v_and_b32 v11, 0xffff0000, v65
  v_pk_fma_f32 v[10:11], v[10:11], v[8:9], v[6:7] op_sel_hi:[1,0,0]
  v_cvt_pk_bf16_f32 v129, v10, v11
  v_min_u32 v129, -2, v129
  v_lshlrev_b32 v10, 16, v66
  v_and_b32 v11, 0xffff0000, v66
  v_pk_fma_f32 v[10:11], v[10:11], v[8:9], v[6:7] op_sel_hi:[1,0,0]
  v_cvt_pk_bf16_f32 v130, v10, v11
  v_min_u32 v130, -2, v130
  v_lshlrev_b32 v10, 16, v67
  v_and_b32 v11, 0xffff0000, v67
  v_pk_fma_f32 v[10:11], v[10:11], v[8:9], v[6:7] op_sel_hi:[1,0,0]
  v_cvt_pk_bf16_f32 v131, v10, v11
  v_min_u32 v131, -2, v131
  buffer_store_dwordx4 v[128:131], v4, s[4:7], s14 offen offset:0 sc1
  v_lshlrev_b32 v10, 16, v68
  v_and_b32 v11, 0xffff0000, v68
  v_pk_fma_f32 v[10:11], v[10:11], v[8:9], v[6:7] op_sel_hi:[1,0,0]
  v_cvt_pk_bf16_f32 v132, v10, v11
  v_min_u32 v132, -2, v132
  v_lshlrev_b32 v10, 16, v69
  v_and_b32 v11, 0xffff0000, v69
  v_pk_fma_f32 v[10:11], v[10:11], v[8:9], v[6:7] op_sel_hi:[1,0,0]
  v_cvt_pk_bf16_f32 v133, v10, v11
  v_min_u32 v133, -2, v133
  v_lshlrev_b32 v10, 16, v70
  v_and_b32 v11, 0xffff0000, v70
  v_pk_fma_f32 v[10:11], v[10:11], v[8:9], v[6:7] op_sel_hi:[1,0,0]
  v_cvt_pk_bf16_f32 v134, v10, v11
  v_min_u32 v134, -2, v134
  v_lshlrev_b32 v10, 16, v71
  v_and_b32 v11, 0xffff0000, v71
  v_pk_fma_f32 v[10:11], v[10:11], v[8:9], v[6:7] op_sel_hi:[1,0,0]
  v_cvt_pk_bf16_f32 v135, v10, v11
  v_min_u32 v135, -2, v135
  buffer_store_dwordx4 v[132:135], v4, s[4:7], s14 offen offset:2048 sc1
  v_lshlrev_b32 v10, 16, v72
  v_and_b32 v11, 0xffff0000, v72
  v_pk_fma_f32 v[10:11], v[10:11], v[8:9], v[6:7] op_sel_hi:[1,0,0]
  v_cvt_pk_bf16_f32 v136, v10, v11
  v_min_u32 v136, -2, v136
  v_lshlrev_b32 v10, 16, v73
  v_and_b32 v11, 0xffff0000, v73
  v_pk_fma_f32 v[10:11], v[10:11], v[8:9], v[6:7] op_sel_hi:[1,0,0]
  v_cvt_pk_bf16_f32 v137, v10, v11
  v_min_u32 v137, -2, v137
  v_lshlrev_b32 v10, 16, v74
  v_and_b32 v11, 0xffff0000, v74
  v_pk_fma_f32 v[10:11], v[10:11], v[8:9], v[6:7] op_sel_hi:[1,0,0]
  v_cvt_pk_bf16_f32 v138, v10, v11
  v_min_u32 v138, -2, v138
  v_lshlrev_b32 v10, 16, v75
  v_and_b32 v11, 0xffff0000, v75
  v_pk_fma_f32 v[10:11], v[10:11], v[8:9], v[6:7] op_sel_hi:[1,0,0]
  v_cvt_pk_bf16_f32 v139, v10, v11
  v_min_u32 v139, -2, v139
  s_add_u32 s14, s14, 4096
  buffer_store_dwordx4 v[136:139], v4, s[4:7], s14 offen offset:0 sc1
  v_lshlrev_b32 v10, 16, v76
  v_and_b32 v11, 0xffff0000, v76
  v_pk_fma_f32 v[10:11], v[10:11], v[8:9], v[6:7] op_sel_hi:[1,0,0]
  v_cvt_pk_bf16_f32 v140, v10, v11
  v_min_u32 v140, -2, v140
  v_lshlrev_b32 v10, 16, v77
  v_and_b32 v11, 0xffff0000, v77
  v_pk_fma_f32 v[10:11], v[10:11], v[8:9], v[6:7] op_sel_hi:[1,0,0]
  v_cvt_pk_bf16_f32 v141, v10, v11
  v_min_u32 v141, -2, v141
  v_lshlrev_b32 v10, 16, v78
  v_and_b32 v11, 0xffff0000, v78
  v_pk_fma_f32 v[10:11], v[10:11], v[8:9], v[6:7] op_sel_hi:[1,0,0]
  v_cvt_pk_bf16_f32 v142, v10, v11
  v_min_u32 v142, -2, v142
  v_lshlrev_b32 v10, 16, v79
  v_and_b32 v11, 0xffff0000, v79
  v_pk_fma_f32 v[10:11], v[10:11], v[8:9], v[6:7] op_sel_hi:[1,0,0]
  v_cvt_pk_bf16_f32 v143, v10, v11
  v_min_u32 v143, -2, v143
  buffer_store_dwordx4 v[140:143], v4, s[4:7], s14 offen offset:2048 sc1
  v_lshlrev_b32 v10, 16, v80
  v_and_b32 v11, 0xffff0000, v80
  v_pk_fma_f32 v[10:11], v[10:11], v[8:9], v[6:7] op_sel_hi:[1,0,0]
  v_cvt_pk_bf16_f32 v144, v10, v11
  v_min_u32 v144, -2, v144
  v_lshlrev_b32 v10, 16, v81
  v_and_b32 v11, 0xffff0000, v81
  v_pk_fma_f32 v[10:11], v[10:11], v[8:9], v[6:7] op_sel_hi:[1,0,0]
  v_cvt_pk_bf16_f32 v145, v10, v11
  v_min_u32 v145, -2, v145
  v_lshlrev_b32 v10, 16, v82
  v_and_b32 v11, 0xffff0000, v82
  v_pk_fma_f32 v[10:11], v[10:11], v[8:9], v[6:7] op_sel_hi:[1,0,0]
  v_cvt_pk_bf16_f32 v146, v10, v11
  v_min_u32 v146, -2, v146
  v_lshlrev_b32 v10, 16, v83
  v_and_b32 v11, 0xffff0000, v83
  v_pk_fma_f32 v[10:11], v[10:11], v[8:9], v[6:7] op_sel_hi:[1,0,0]
  v_cvt_pk_bf16_f32 v147, v10, v11
  v_min_u32 v147, -2, v147
  s_add_u32 s14, s14, 4096
  buffer_store_dwordx4 v[144:147], v4, s[4:7], s14 offen offset:0 sc1
  v_lshlrev_b32 v10, 16, v84
  v_and_b32 v11, 0xffff0000, v84
  v_pk_fma_f32 v[10:11], v[10:11], v[8:9], v[6:7] op_sel_hi:[1,0,0]
  v_cvt_pk_bf16_f32 v148, v10, v11
  v_min_u32 v148, -2, v148
  v_lshlrev_b32 v10, 16, v85
  v_and_b32 v11, 0xffff0000, v85
  v_pk_fma_f32 v[10:11], v[10:11], v[8:9], v[6:7] op_sel_hi:[1,0,0]
  v_cvt_pk_bf16_f32 v149, v10, v11
  v_min_u32 v149, -2, v149
  v_lshlrev_b32 v10, 16, v86
  v_and_b32 v11, 0xffff0000, v86
  v_pk_fma_f32 v[10:11], v[10:11], v[8:9], v[6:7] op_sel_hi:[1,0,0]
  v_cvt_pk_bf16_f32 v150, v10, v11
  v_min_u32 v150, -2, v150
  v_lshlrev_b32 v10, 16, v87
  v_and_b32 v11, 0xffff0000, v87
  v_pk_fma_f32 v[10:11], v[10:11], v[8:9], v[6:7] op_sel_hi:[1,0,0]
  v_cvt_pk_bf16_f32 v151, v10, v11
  v_min_u32 v151, -2, v151
  buffer_store_dwordx4 v[148:151], v4, s[4:7], s14 offen offset:2048 sc1
  v_lshlrev_b32 v10, 16, v88
  v_and_b32 v11, 0xffff0000, v88
  v_pk_fma_f32 v[10:11], v[10:11], v[8:9], v[6:7] op_sel_hi:[1,0,0]
  v_cvt_pk_bf16_f32 v152, v10, v11
  v_min_u32 v152, -2, v152
  v_lshlrev_b32 v10, 16, v89
  v_and_b32 v11, 0xffff0000, v89
  v_pk_fma_f32 v[10:11], v[10:11], v[8:9], v[6:7] op_sel_hi:[1,0,0]
  v_cvt_pk_bf16_f32 v153, v10, v11
  v_min_u32 v153, -2, v153
  v_lshlrev_b32 v10, 16, v90
  v_and_b32 v11, 0xffff0000, v90
  v_pk_fma_f32 v[10:11], v[10:11], v[8:9], v[6:7] op_sel_hi:[1,0,0]
  v_cvt_pk_bf16_f32 v154, v10, v11
  v_min_u32 v154, -2, v154
  v_lshlrev_b32 v10, 16, v91
  v_and_b32 v11, 0xffff0000, v91
  v_pk_fma_f32 v[10:11], v[10:11], v[8:9], v[6:7] op_sel_hi:[1,0,0]
  v_cvt_pk_bf16_f32 v155, v10, v11
  v_min_u32 v155, -2, v155
  s_add_u32 s14, s14, 4096
  buffer_store_dwordx4 v[152:155], v4, s[4:7], s14 offen offset:0 sc1
  v_lshlrev_b32 v10, 16, v92
  v_and_b32 v11, 0xffff0000, v92
  v_pk_fma_f32 v[10:11], v[10:11], v[8:9], v[6:7] op_sel_hi:[1,0,0]
  v_cvt_pk_bf16_f32 v156, v10, v11
  v_min_u32 v156, -2, v156
  v_lshlrev_b32 v10, 16, v93
  v_and_b32 v11, 0xffff0000, v93
  v_pk_fma_f32 v[10:11], v[10:11], v[8:9], v[6:7] op_sel_hi:[1,0,0]
  v_cvt_pk_bf16_f32 v157, v10, v11
  v_min_u32 v157, -2, v157
  v_lshlrev_b32 v10, 16, v94
  v_and_b32 v11, 0xffff0000, v94
  v_pk_fma_f32 v[10:11], v[10:11], v[8:9], v[6:7] op_sel_hi:[1,0,0]
  v_cvt_pk_bf16_f32 v158, v10, v11
  v_min_u32 v158, -2, v158
  v_lshlrev_b32 v10, 16, v95
  v_and_b32 v11, 0xffff0000, v95
  v_pk_fma_f32 v[10:11], v[10:11], v[8:9], v[6:7] op_sel_hi:[1,0,0]
  v_cvt_pk_bf16_f32 v159, v10, v11
  v_min_u32 v159, -2, v159
  buffer_store_dwordx4 v[156:159], v4, s[4:7], s14 offen offset:2048 sc1
  v_lshlrev_b32 v10, 16, v96
  v_and_b32 v11, 0xffff0000, v96
  v_pk_fma_f32 v[10:11], v[10:11], v[8:9], v[6:7] op_sel_hi:[1,0,0]
  v_cvt_pk_bf16_f32 v160, v10, v11
  v_min_u32 v160, -2, v160
  v_lshlrev_b32 v10, 16, v97
  v_and_b32 v11, 0xffff0000, v97
  v_pk_fma_f32 v[10:11], v[10:11], v[8:9], v[6:7] op_sel_hi:[1,0,0]
  v_cvt_pk_bf16_f32 v161, v10, v11
  v_min_u32 v161, -2, v161
  v_lshlrev_b32 v10, 16, v98
  v_and_b32 v11, 0xffff0000, v98
  v_pk_fma_f32 v[10:11], v[10:11], v[8:9], v[6:7] op_sel_hi:[1,0,0]
  v_cvt_pk_bf16_f32 v162, v10, v11
  v_min_u32 v162, -2, v162
  v_lshlrev_b32 v10, 16, v99
  v_and_b32 v11, 0xffff0000, v99
  v_pk_fma_f32 v[10:11], v[10:11], v[8:9], v[6:7] op_sel_hi:[1,0,0]
  v_cvt_pk_bf16_f32 v163, v10, v11
  v_min_u32 v163, -2, v163
  s_add_u32 s14, s14, 4096
  buffer_store_dwordx4 v[160:163], v4, s[4:7], s14 offen offset:0 sc1
  v_lshlrev_b32 v10, 16, v100
  v_and_b32 v11, 0xffff0000, v100
  v_pk_fma_f32 v[10:11], v[10:11], v[8:9], v[6:7] op_sel_hi:[1,0,0]
  v_cvt_pk_bf16_f32 v164, v10, v11
  v_min_u32 v164, -2, v164
  v_lshlrev_b32 v10, 16, v101
  v_and_b32 v11, 0xffff0000, v101
  v_pk_fma_f32 v[10:11], v[10:11], v[8:9], v[6:7] op_sel_hi:[1,0,0]
  v_cvt_pk_bf16_f32 v165, v10, v11
  v_min_u32 v165, -2, v165
  v_lshlrev_b32 v10, 16, v102
  v_and_b32 v11, 0xffff0000, v102
  v_pk_fma_f32 v[10:11], v[10:11], v[8:9], v[6:7] op_sel_hi:[1,0,0]
  v_cvt_pk_bf16_f32 v166, v10, v11
  v_min_u32 v166, -2, v166
  v_lshlrev_b32 v10, 16, v103
  v_and_b32 v11, 0xffff0000, v103
  v_pk_fma_f32 v[10:11], v[10:11], v[8:9], v[6:7] op_sel_hi:[1,0,0]
  v_cvt_pk_bf16_f32 v167, v10, v11
  v_min_u32 v167, -2, v167
  buffer_store_dwordx4 v[164:167], v4, s[4:7], s14 offen offset:2048 sc1
  v_lshlrev_b32 v10, 16, v104
  v_and_b32 v11, 0xffff0000, v104
  v_pk_fma_f32 v[10:11], v[10:11], v[8:9], v[6:7] op_sel_hi:[1,0,0]
  v_cvt_pk_bf16_f32 v168, v10, v11
  v_min_u32 v168, -2, v168
  v_lshlrev_b32 v10, 16, v105
  v_and_b32 v11, 0xffff0000, v105
  v_pk_fma_f32 v[10:11], v[10:11], v[8:9], v[6:7] op_sel_hi:[1,0,0]
  v_cvt_pk_bf16_f32 v169, v10, v11
  v_min_u32 v169, -2, v169
  v_lshlrev_b32 v10, 16, v106
  v_and_b32 v11, 0xffff0000, v106
  v_pk_fma_f32 v[10:11], v[10:11], v[8:9], v[6:7] op_sel_hi:[1,0,0]
  v_cvt_pk_bf16_f32 v170, v10, v11
  v_min_u32 v170, -2, v170
  v_lshlrev_b32 v10, 16, v107
  v_and_b32 v11, 0xffff0000, v107
  v_pk_fma_f32 v[10:11], v[10:11], v[8:9], v[6:7] op_sel_hi:[1,0,0]
  v_cvt_pk_bf16_f32 v171, v10, v11
  v_min_u32 v171, -2, v171
  s_add_u32 s14, s14, 4096
  buffer_store_dwordx4 v[168:171], v4, s[4:7], s14 offen offset:0 sc1
  v_lshlrev_b32 v10, 16, v108
  v_and_b32 v11, 0xffff0000, v108
  v_pk_fma_f32 v[10:11], v[10:11], v[8:9], v[6:7] op_sel_hi:[1,0,0]
  v_cvt_pk_bf16_f32 v172, v10, v11
  v_min_u32 v172, -2, v172
  v_lshlrev_b32 v10, 16, v109
  v_and_b32 v11, 0xffff0000, v109
  v_pk_fma_f32 v[10:11], v[10:11], v[8:9], v[6:7] op_sel_hi:[1,0,0]
  v_cvt_pk_bf16_f32 v173, v10, v11
  v_min_u32 v173, -2, v173
  v_lshlrev_b32 v10, 16, v110
  v_and_b32 v11, 0xffff0000, v110
  v_pk_fma_f32 v[10:11], v[10:11], v[8:9], v[6:7] op_sel_hi:[1,0,0]
  v_cvt_pk_bf16_f32 v174, v10, v11
  v_min_u32 v174, -2, v174
  v_lshlrev_b32 v10, 16, v111
  v_and_b32 v11, 0xffff0000, v111
  v_pk_fma_f32 v[10:11], v[10:11], v[8:9], v[6:7] op_sel_hi:[1,0,0]
  v_cvt_pk_bf16_f32 v175, v10, v11
  v_min_u32 v175, -2, v175
  buffer_store_dwordx4 v[172:175], v4, s[4:7], s14 offen offset:2048 sc1
  v_lshlrev_b32 v10, 16, v112
  v_and_b32 v11, 0xffff0000, v112
  v_pk_fma_f32 v[10:11], v[10:11], v[8:9], v[6:7] op_sel_hi:[1,0,0]
  v_cvt_pk_bf16_f32 v176, v10, v11
  v_min_u32 v176, -2, v176
  v_lshlrev_b32 v10, 16, v113
  v_and_b32 v11, 0xffff0000, v113
  v_pk_fma_f32 v[10:11], v[10:11], v[8:9], v[6:7] op_sel_hi:[1,0,0]
  v_cvt_pk_bf16_f32 v177, v10, v11
  v_min_u32 v177, -2, v177
  v_lshlrev_b32 v10, 16, v114
  v_and_b32 v11, 0xffff0000, v114
  v_pk_fma_f32 v[10:11], v[10:11], v[8:9], v[6:7] op_sel_hi:[1,0,0]
  v_cvt_pk_bf16_f32 v178, v10, v11
  v_min_u32 v178, -2, v178
  v_lshlrev_b32 v10, 16, v115
  v_and_b32 v11, 0xffff0000, v115
  v_pk_fma_f32 v[10:11], v[10:11], v[8:9], v[6:7] op_sel_hi:[1,0,0]
  v_cvt_pk_bf16_f32 v179, v10, v11
  v_min_u32 v179, -2, v179
  s_add_u32 s14, s14, 4096
  buffer_store_dwordx4 v[176:179], v4, s[4:7], s14 offen offset:0 sc1
  v_lshlrev_b32 v10, 16, v116
  v_and_b32 v11, 0xffff0000, v116
  v_pk_fma_f32 v[10:11], v[10:11], v[8:9], v[6:7] op_sel_hi:[1,0,0]
  v_cvt_pk_bf16_f32 v180, v10, v11
  v_min_u32 v180, -2, v180
  v_lshlrev_b32 v10, 16, v117
  v_and_b32 v11, 0xffff0000, v117
  v_pk_fma_f32 v[10:11], v[10:11], v[8:9], v[6:7] op_sel_hi:[1,0,0]
  v_cvt_pk_bf16_f32 v181, v10, v11
  v_min_u32 v181, -2, v181
  v_lshlrev_b32 v10, 16, v118
  v_and_b32 v11, 0xffff0000, v118
  v_pk_fma_f32 v[10:11], v[10:11], v[8:9], v[6:7] op_sel_hi:[1,0,0]
  v_cvt_pk_bf16_f32 v182, v10, v11
  v_min_u32 v182, -2, v182
  v_lshlrev_b32 v10, 16, v119
  v_and_b32 v11, 0xffff0000, v119
  v_pk_fma_f32 v[10:11], v[10:11], v[8:9], v[6:7] op_sel_hi:[1,0,0]
  v_cvt_pk_bf16_f32 v183, v10, v11
  v_min_u32 v183, -2, v183
  buffer_store_dwordx4 v[180:183], v4, s[4:7], s14 offen offset:2048 sc1
  s_add_u32 s36, s11, 224
  v_mov_b32 v24, -1
  v_mov_b32 v25, -1
  v_mov_b32 v26, -1
  v_mov_b32 v27, -1
  s_lshl_b32 s100, s2, 2
  s_add_u32 s100, s100, s8
  s_lshl_b32 s100, s100, 10
  s_add_u32 s100, s100, 28893184
fl_21:
  s_cmp_ge_u32 s100, 29753344
  s_cbranch_scc1 fd_22
  buffer_store_dwordx4 v[24:27], v2, s[4:7], s100 offen sc1
  s_add_u32 s100, s100, 1048576
  s_branch fl_21
fd_22:
  s_add_u32 s100, s100, 2752512
fl_23:
  s_cmp_ge_u32 s100, 32964608
  s_cbranch_scc1 fd_24
  buffer_store_dwordx4 v[24:27], v2, s[4:7], s100 offen sc1
  s_add_u32 s100, s100, 1048576
  s_branch fl_23
fd_24:
  s_add_u32 s100, s100, 1376256
fl_25:
  s_cmp_ge_u32 s100, 34799616
  s_cbranch_scc1 fd_26
  buffer_store_dwordx4 v[24:27], v2, s[4:7], s100 offen sc1
  s_add_u32 s100, s100, 1048576
  s_branch fl_25
fd_26:
  s_add_u32 s100, s100, 1376256
fl_27:
  s_cmp_ge_u32 s100, 36634624
  s_cbranch_scc1 fd_28
  buffer_store_dwordx4 v[24:27], v2, s[4:7], s100 offen sc1
  s_add_u32 s100, s100, 1048576
  s_branch fl_27
fd_28:
  s_add_u32 s100, s100, 1376256
fl_29:
  s_cmp_ge_u32 s100, 38469632
  s_cbranch_scc1 fd_30
  buffer_store_dwordx4 v[24:27], v2, s[4:7], s100 offen sc1
  s_add_u32 s100, s100, 1048576
  s_branch fl_29
fd_30:
  s_add_u32 s100, s100, 1376256
fl_31:
  s_cmp_ge_u32 s100, 40501248
  s_cbranch_scc1 fd_32
  buffer_store_dwordx4 v[24:27], v2, s[4:7], s100 offen sc1
  s_add_u32 s100, s100, 1048576
  s_branch fl_31
fd_32:
  s_add_u32 s100, s100, 1966080
fl_33:
  s_cmp_ge_u32 s100, 43122688
  s_cbranch_scc1 fd_34
  buffer_store_dwordx4 v[24:27], v2, s[4:7], s100 offen sc1
  s_add_u32 s100, s100, 1048576
  s_branch fl_33
fd_34:
  s_add_u32 s100, s100, 1966080
fl_35:
  s_cmp_ge_u32 s100, 45252608
  s_cbranch_scc1 fd_36
  buffer_store_dwordx4 v[24:27], v2, s[4:7], s100 offen sc1
  s_add_u32 s100, s100, 1048576
  s_branch fl_35
fd_36:
  s_add_u32 s100, s100, 491520
fl_37:
  s_cmp_ge_u32 s100, 45907968
  s_cbranch_scc1 fd_38
  buffer_store_dwordx4 v[24:27], v2, s[4:7], s100 offen sc1
  s_add_u32 s100, s100, 1048576
  s_branch fl_37
fd_38:
nf_20:
  s_cmp_ge_u32 s11, 7
  s_cbranch_scc1 K0_nm
  s_mul_i32 s13, s8, 14336
  s_lshl_b32 s12, s11, 10
  s_add_u32 s13, s13, s12
  s_add_u32 s13, s13, 28835840
  s_add_u32 s14, s13, 7168
  v_min_u32 v56, -2, v56
  v_min_u32 v57, -2, v57
  v_min_u32 v58, -2, v58
  v_min_u32 v59, -2, v59
  v_min_u32 v60, -2, v60
  v_min_u32 v61, -2, v61
  v_min_u32 v62, -2, v62
  v_min_u32 v63, -2, v63
  buffer_store_dwordx4 v[56:59], v2, s[4:7], s13 offen sc1
  buffer_store_dwordx4 v[60:63], v2, s[4:7], s14 offen sc1
K0_nm:
K0_done:
  s_waitcnt lgkmcnt(0)
  v_mov_b32 v5, s3
  v_mov_b32 v6, 0
  s_cmp_lg_u32 s8, 0
  s_cbranch_scc1 K1_wt
  ds_write_b32 v6, v5
  s_waitcnt lgkmcnt(0)
K1_wt:
  s_mov_b32 s101, 128
  s_cmp_eq_u32 s8, 0
  s_cbranch_scc1 K1_w0
  s_waitcnt vmcnt(0)
K1_w0:
  v_mbcnt_lo_u32_b32 v11, -1, 0
  v_mbcnt_hi_u32_b32 v11, -1, v11
  s_cmp_lg_u32 s8, 0
  s_cbranch_scc1 wcd_40
  v_min_u32 v11, 0, v11
  v_lshlrev_b32 v11, 7, v11
  s_branch wc_39x
wc_39:
  s_sleep 2
wc_39x:
  buffer_load_dword v10, v11, s[92:95], s101 offen sc1
  s_sub_u32 s99, s99, 1
  s_cbranch_scc1 FAIL
  s_waitcnt vmcnt(0)
  v_cmp_eq_u32 vcc, 0, v10
  s_cbranch_vccnz wc_39
wcd_40:
  s_barrier
  s_cmp_lg_u32 s8, 0
  s_cbranch_scc1 K1_nf
  s_lshl_b32 s36, s36, 7
  s_add_u32 s36, s36, 18907136
  s_mov_b64 exec, 1
  buffer_store_dword v10, off, s[4:7], s36 sc1
  s_mov_b64 exec, -1
K1_nf:
  ds_read_b32 v5, v6
  s_waitcnt lgkmcnt(0)
  v_readfirstlane_b32 s3, v5
  s_barrier
  s_cmp_ge_u32 s3, 32
  s_cbranch_scc1 K1_end
  s_lshl_b32 s12, s9, 5
  s_add_u32 s12, s12, s3
  s_mov_b32 s13, 0x0
  s_cmp_ge_u32 s12, 16
  s_cselect_b32 s13, 0x1001, s13
  s_cmp_ge_u32 s12, 30
  s_cselect_b32 s13, 0x1e02, s13
  s_cmp_ge_u32 s12, 32
  s_cselect_b32 s13, 0x202008, s13
  s_cmp_ge_u32 s12, 48
  s_cselect_b32 s13, 0x203009, s13
  s_cmp_ge_u32 s12, 62
  s_cselect_b32 s13, 0x203e0a, s13
  s_cmp_ge_u32 s12, 64
  s_cselect_b32 s13, 0x4003, s13
  s_cmp_ge_u32 s12, 88
  s_cselect_b32 s13, 0x30005804, s13
  s_cmp_ge_u32 s12, 96
  s_cselect_b32 s13, 0x4803, s13
  s_cmp_ge_u32 s12, 112
  s_cselect_b32 s13, 0x40006804, s13
  s_cmp_ge_u32 s12, 128
  s_cselect_b32 s13, 0x40006804, s13
  s_cmp_ge_u32 s12, 136
  s_cselect_b32 s13, 0x68800c, s13
  s_cmp_ge_u32 s12, 160
  s_cselect_b32 s13, 0xa00c, s13
  s_cmp_ge_u32 s12, 168
  s_cselect_b32 s13, 0xa806, s13
  s_cmp_ge_u32 s12, 171
  s_cselect_b32 s13, 0xab05, s13
  s_cmp_ge_u32 s12, 192
  s_cselect_b32 s13, 0xa10d, s13
  s_cmp_ge_u32 s12, 203
  s_cselect_b32 s13, 0xb605, s13
  s_cmp_ge_u32 s12, 224
  s_cselect_b32 s13, 0xa8e00d, s13
  s_cmp_ge_u32 s12, 255
  s_cselect_b32 s13, 0xa8ff06, s13
  s_and_b32 s17, s13, 7
  s_bfe_u32 s11, s13, 0x10003
  s_bfe_u32 s14, s13, 0x80008
  s_sub_u32 s10, s12, s14
  s_bfe_u32 s14, s13, 0x80010
  s_sub_u32 s97, s12, s14
  s_cmp_eq_u32 s14, 0
  s_cselect_b32 s97, -1, s97
  s_lshr_b32 s14, s13, 24
  s_sub_u32 s96, s12, s14
  s_cmp_eq_u32 s14, 0
  s_cselect_b32 s96, -1, s96
  s_sub_u32 s14, s9, 5
  s_cmp_ge_u32 s14, 2
  s_cbranch_scc1 K1_nl
  s_cmp_ge_u32 s3, 11
  s_cbranch_scc1 K1_nl
  s_mov_b32 s101, 18921472
  v_mbcnt_lo_u32_b32 v11, -1, 0
  v_mbcnt_hi_u32_b32 v11, -1, v11
  s_lshl_b32 s100, s8, 6
  v_add_u32 v11, s100, v11
  v_min_u32 v11, 111, v11
  v_lshlrev_b32 v11, 7, v11
  s_branch wc_41x
wc_41:
  s_sleep 2
wc_41x:
  buffer_load_dword v10, v11, s[4:7], s101 offen sc1
  s_sub_u32 s99, s99, 1
  s_cbranch_scc1 FAIL
  s_waitcnt vmcnt(0)
  v_cmp_eq_u32 vcc, 0, v10
  s_cbranch_vccnz wc_41
wcd_42:
  s_barrier
  s_mul_i32 s14, s14, 3211264
  s_add_u32 s14, s14, 7340032
  s_lshl_b32 s15, s3, 2
  s_add_u32 s15, s15, s8
  v_lshlrev_b32 v3, 3, v2
K1_ld:
  s_mul_i32 s18, s15, 2341
  s_lshr_b32 s18, s18, 16
  s_mul_i32 s19, s18, 28
  s_sub_u32 s19, s15, s19
  s_mul_i32 s19, s19, 114688
  s_lshl_b32 s18, s18, 13
  s_add_u32 s18, s18, s19
  s_add_u32 s18, s18, s14
  buffer_load_dword v4, v3, s[4:7], s18 offen
  s_add_u32 s15, s15, 44
  s_cmp_lt_u32 s15, 392
  s_cbranch_scc1 K1_ld
  s_waitcnt vmcnt(0)
K1_nl:
  s_cmp_eq_u32 s17, 0
  s_cbranch_scc1 K1_ra
  s_cmp_eq_u32 s17, 1
  s_cbranch_scc1 K1_rb
  s_cmp_eq_u32 s17, 2
  s_cbranch_scc1 K1_rh
  s_cmp_eq_u32 s17, 3
  s_cbranch_scc1 K1_rp
  s_cmp_eq_u32 s17, 4
  s_cbranch_scc1 K1_rq
  s_cmp_eq_u32 s17, 5
  s_cbranch_scc1 K1_rv
  s_mov_b32 s10, 0
  s_lshr_b32 s101, s10, 1
  s_lshl_b32 s101, s101, 11
  s_add_u32 s101, s101, 18921472
  v_mbcnt_lo_u32_b32 v13, -1, 0
  v_mbcnt_hi_u32_b32 v13, -1, v13
  s_cmp_lg_u32 s8, 0
  s_cbranch_scc1 wcd_44
  v_min_u32 v13, 15, v13
  v_lshlrev_b32 v13, 7, v13
  s_branch wc_43x
wc_43:
  s_sleep 2
wc_43x:
  buffer_load_dword v12, v13, s[4:7], s101 offen sc1
  s_sub_u32 s99, s99, 1
  s_cbranch_scc1 FAIL
  s_waitcnt vmcnt(0)
  v_cmp_eq_u32 vcc, 0, v12
  s_cbranch_vccnz wc_43
wcd_44:
  s_barrier
  s_cmp_lt_i32 s97, 0
  s_cbranch_scc1 nf_45
  s_mov_b32 s101, 18907136
  v_mbcnt_lo_u32_b32 v13, -1, 0
  v_mbcnt_hi_u32_b32 v13, -1, v13
  s_lshl_b32 s100, s8, 6
  v_add_u32 v13, s100, v13
  v_min_u32 v13, 255, v13
  v_lshlrev_b32 v13, 7, v13
  s_branch wc_46x
wc_46:
  s_sleep 2
wc_46x:
  buffer_load_dword v12, v13, s[4:7], s101 offen sc1
  s_sub_u32 s99, s99, 1
  s_cbranch_scc1 FAIL
  s_waitcnt vmcnt(0)
  v_cmp_eq_u32 vcc, 0, v12
  s_cbranch_vccnz wc_46
wcd_47:
  s_barrier
  v_mov_b32 v12, -1
  v_mov_b32 v13, -1
  v_mov_b32 v14, -1
  v_mov_b32 v15, -1
  s_lshl_b32 s100, s97, 2
  s_add_u32 s100, s100, s8
  s_lshl_b32 s100, s100, 10
  s_add_u32 s100, s100, 29753344
fl_48:
  s_cmp_ge_u32 s100, 32505856
  s_cbranch_scc1 fd_49
  buffer_store_dwordx4 v[12:15], v2, s[4:7], s100 offen sc1
  s_add_u32 s100, s100, 360448
  s_branch fl_48
fd_49:
  s_add_u32 s100, s100, 458752
fl_50:
  s_cmp_ge_u32 s100, 34340864
  s_cbranch_scc1 fd_51
  buffer_store_dwordx4 v[12:15], v2, s[4:7], s100 offen sc1
  s_add_u32 s100, s100, 360448
  s_branch fl_50
fd_51:
  s_add_u32 s100, s100, 458752
fl_52:
  s_cmp_ge_u32 s100, 36175872
  s_cbranch_scc1 fd_53
  buffer_store_dwordx4 v[12:15], v2, s[4:7], s100 offen sc1
  s_add_u32 s100, s100, 360448
  s_branch fl_52
fd_53:
  s_add_u32 s100, s100, 458752
fl_54:
  s_cmp_ge_u32 s100, 38010880
  s_cbranch_scc1 fd_55
  buffer_store_dwordx4 v[12:15], v2, s[4:7], s100 offen sc1
  s_add_u32 s100, s100, 360448
  s_branch fl_54
fd_55:
  s_add_u32 s100, s100, 458752
fl_56:
  s_cmp_ge_u32 s100, 39845888
  s_cbranch_scc1 fd_57
  buffer_store_dwordx4 v[12:15], v2, s[4:7], s100 offen sc1
  s_add_u32 s100, s100, 360448
  s_branch fl_56
fd_57:
  s_add_u32 s100, s100, 655360
fl_58:
  s_cmp_ge_u32 s100, 42467328
  s_cbranch_scc1 fd_59
  buffer_store_dwordx4 v[12:15], v2, s[4:7], s100 offen sc1
  s_add_u32 s100, s100, 360448
  s_branch fl_58
fd_59:
  s_add_u32 s100, s100, 655360
fl_60:
  s_cmp_ge_u32 s100, 45088768
  s_cbranch_scc1 fd_61
  buffer_store_dwordx4 v[12:15], v2, s[4:7], s100 offen sc1
  s_add_u32 s100, s100, 360448
  s_branch fl_60
fd_61:
  s_add_u32 s100, s100, 163840
fl_62:
  s_cmp_ge_u32 s100, 45744128
  s_cbranch_scc1 fd_63
  buffer_store_dwordx4 v[12:15], v2, s[4:7], s100 offen sc1
  s_add_u32 s100, s100, 360448
  s_branch fl_62
fd_63:
  s_add_u32 s100, s100, 163840
fl_64:
  s_cmp_ge_u32 s100, 46399488
  s_cbranch_scc1 fd_65
  buffer_store_dwordx4 v[12:15], v2, s[4:7], s100 offen sc1
  s_add_u32 s100, s100, 360448
  s_branch fl_64
fd_65:
  s_waitcnt vmcnt(0)
  s_barrier
  s_cmp_lg_u32 s8, 0
  s_cbranch_scc1 arr_66
  v_mov_b32 v12, 1
  s_mov_b64 exec, 1
  s_mov_b32 s100, 18903040
  buffer_atomic_add v12, off, s[4:7], s100 sc0
  s_waitcnt vmcnt(0)
  v_readfirstlane_b32 s100, v12
  s_cmp_lg_u32 s100, 87
  s_cbranch_scc1 arr_66x
  s_mov_b32 s100, 18903424
  s_nop 1
  buffer_store_dword v12, off, s[4:7], s100 sc1
arr_66x:
  s_mov_b64 exec, -1
arr_66:
nf_45:
  s_branch K1_end
K1_ra:
  v_and_b32 v16, 63, v0
  v_lshlrev_b32 v1, 4, v16
  s_mul_i32 s101, s10, 896
  s_add_u32 s101, s101, 18907136
  v_mbcnt_lo_u32_b32 v53, -1, 0
  v_mbcnt_hi_u32_b32 v53, -1, v53
  s_cmp_lg_u32 s8, 0
  s_cbranch_scc1 wcd_68
  v_min_u32 v53, 6, v53
  v_lshlrev_b32 v53, 7, v53
  s_branch wc_67x
wc_67:
  s_sleep 2
wc_67x:
  buffer_load_dword v52, v53, s[4:7], s101 offen sc1
  s_sub_u32 s99, s99, 1
  s_cbranch_scc1 FAIL
  s_waitcnt vmcnt(0)
  v_cmp_eq_u32 vcc, 0, v52
  s_cbranch_vccnz wc_67
wcd_68:
  s_barrier
  s_cmp_lt_i32 s97, 0
  s_cbranch_scc1 nf_69
  s_mov_b32 s101, 18907136
  v_mbcnt_lo_u32_b32 v53, -1, 0
  v_mbcnt_hi_u32_b32 v53, -1, v53
  s_lshl_b32 s100, s8, 6
  v_add_u32 v53, s100, v53
  v_min_u32 v53, 255, v53
  v_lshlrev_b32 v53, 7, v53
  s_branch wc_70x
wc_70:
  s_sleep 2
wc_70x:
  buffer_load_dword v52, v53, s[4:7], s101 offen sc1
  s_sub_u32 s99, s99, 1
  s_cbranch_scc1 FAIL
  s_waitcnt vmcnt(0)
  v_cmp_eq_u32 vcc, 0, v52
  s_cbranch_vccnz wc_70
wcd_71:
  s_barrier
  v_mov_b32 v52, -1
  v_mov_b32 v53, -1
  v_mov_b32 v54, -1
  v_mov_b32 v55, -1
  s_lshl_b32 s100, s97, 2
  s_add_u32 s100, s100, s8
  s_lshl_b32 s100, s100, 10
  s_add_u32 s100, s100, 29753344
fl_72:
  s_cmp_ge_u32 s100, 32505856
  s_cbranch_scc1 fd_73
  buffer_store_dwordx4 v[52:55], v1, s[4:7], s100 offen sc1
  s_add_u32 s100, s100, 360448
  s_branch fl_72
fd_73:
  s_add_u32 s100, s100, 458752
fl_74:
  s_cmp_ge_u32 s100, 34340864
  s_cbranch_scc1 fd_75
  buffer_store_dwordx4 v[52:55], v1, s[4:7], s100 offen sc1
  s_add_u32 s100, s100, 360448
  s_branch fl_74
fd_75:
  s_add_u32 s100, s100, 458752
fl_76:
  s_cmp_ge_u32 s100, 36175872
  s_cbranch_scc1 fd_77
  buffer_store_dwordx4 v[52:55], v1, s[4:7], s100 offen sc1
  s_add_u32 s100, s100, 360448
  s_branch fl_76
fd_77:
  s_add_u32 s100, s100, 458752
fl_78:
  s_cmp_ge_u32 s100, 38010880
  s_cbranch_scc1 fd_79
  buffer_store_dwordx4 v[52:55], v1, s[4:7], s100 offen sc1
  s_add_u32 s100, s100, 360448
  s_branch fl_78
fd_79:
  s_add_u32 s100, s100, 458752
fl_80:
  s_cmp_ge_u32 s100, 39845888
  s_cbranch_scc1 fd_81
  buffer_store_dwordx4 v[52:55], v1, s[4:7], s100 offen sc1
  s_add_u32 s100, s100, 360448
  s_branch fl_80
fd_81:
  s_add_u32 s100, s100, 655360
fl_82:
  s_cmp_ge_u32 s100, 42467328
  s_cbranch_scc1 fd_83
  buffer_store_dwordx4 v[52:55], v1, s[4:7], s100 offen sc1
  s_add_u32 s100, s100, 360448
  s_branch fl_82
fd_83:
  s_add_u32 s100, s100, 655360
fl_84:
  s_cmp_ge_u32 s100, 45088768
  s_cbranch_scc1 fd_85
  buffer_store_dwordx4 v[52:55], v1, s[4:7], s100 offen sc1
  s_add_u32 s100, s100, 360448
  s_branch fl_84
fd_85:
  s_add_u32 s100, s100, 163840
fl_86:
  s_cmp_ge_u32 s100, 45744128
  s_cbranch_scc1 fd_87
  buffer_store_dwordx4 v[52:55], v1, s[4:7], s100 offen sc1
  s_add_u32 s100, s100, 360448
  s_branch fl_86
fd_87:
  s_add_u32 s100, s100, 163840
fl_88:
  s_cmp_ge_u32 s100, 46399488
  s_cbranch_scc1 fd_89
  buffer_store_dwordx4 v[52:55], v1, s[4:7], s100 offen sc1
  s_add_u32 s100, s100, 360448
  s_branch fl_88
fd_89:
  s_waitcnt vmcnt(0)
  s_barrier
  s_cmp_lg_u32 s8, 0
  s_cbranch_scc1 arr_90
  v_mov_b32 v52, 1
  s_mov_b64 exec, 1
  s_mov_b32 s100, 18903040
  buffer_atomic_add v52, off, s[4:7], s100 sc0
  s_waitcnt vmcnt(0)
  v_readfirstlane_b32 s100, v52
  s_cmp_lg_u32 s100, 87
  s_cbranch_scc1 arr_90x
  s_mov_b32 s100, 18903424
  s_nop 1
  buffer_store_dword v52, off, s[4:7], s100 sc1
arr_90x:
  s_mov_b64 exec, -1
arr_90:
nf_69:
  s_lshl_b32 s19, s10, 2
  s_add_u32 s19, s19, s8
  s_mul_i32 s19, s19, 100352
  s_lshl_b32 s20, s10, 2
  s_add_u32 s20, s20, s8
  s_mul_i32 s20, s20, 1
  s_mul_i32 s47, s20, 9363
  s_lshr_b32 s47, s47, 16
  s_mul_i32 s47, s47, 7
  s_sub_u32 s20, s20, s47
  s_lshl_b32 s40, s20, 11
  s_add_u32 s40, s40, s19
  s_add_u32 s20, s20, 1
  s_cmp_eq_u32 s20, 7
  s_cselect_b32 s20, 0, s20
  s_lshl_b32 s41, s20, 11
  s_add_u32 s41, s41, s19
  s_add_u32 s20, s20, 1
  s_cmp_eq_u32 s20, 7
  s_cselect_b32 s20, 0, s20
  s_lshl_b32 s42, s20, 11
  s_add_u32 s42, s42, s19
  s_add_u32 s20, s20, 1
  s_cmp_eq_u32 s20, 7
  s_cselect_b32 s20, 0, s20
  s_lshl_b32 s43, s20, 11
  s_add_u32 s43, s43, s19
  s_add_u32 s20, s20, 1
  s_cmp_eq_u32 s20, 7
  s_cselect_b32 s20, 0, s20
  s_lshl_b32 s44, s20, 11
  s_add_u32 s44, s44, s19
  s_add_u32 s20, s20, 1
  s_cmp_eq_u32 s20, 7
  s_cselect_b32 s20, 0, s20
  s_lshl_b32 s45, s20, 11
  s_add_u32 s45, s45, s19
  s_add_u32 s20, s20, 1
  s_cmp_eq_u32 s20, 7
  s_cselect_b32 s20, 0, s20
  s_lshl_b32 s46, s20, 11
  s_add_u32 s46, s46, s19
  s_add_u32 s20, s20, 1
  s_cmp_eq_u32 s20, 7
  s_cselect_b32 s20, 0, s20
  v_mov_b32 v2, v1
  buffer_load_dwordx4 a[0:3], v2, s[4:7], s40 offen offset:0
  buffer_load_dwordx4 a[4:7], v2, s[4:7], s40 offen offset:1024
  buffer_load_dwordx4 a[8:11], v2, s[4:7], s41 offen offset:0
  buffer_load_dwordx4 a[12:15], v2, s[4:7], s41 offen offset:1024
  buffer_load_dwordx4 a[16:19], v2, s[4:7], s42 offen offset:0
  buffer_load_dwordx4 a[20:23], v2, s[4:7], s42 offen offset:1024
  buffer_load_dwordx4 a[24:27], v2, s[4:7], s43 offen offset:0
  buffer_load_dwordx4 a[28:31], v2, s[4:7], s43 offen offset:1024
  buffer_load_dwordx4 a[32:35], v2, s[4:7], s44 offen offset:0
  buffer_load_dwordx4 a[36:39], v2, s[4:7], s44 offen offset:1024
  buffer_load_dwordx4 a[40:43], v2, s[4:7], s45 offen offset:0
  buffer_load_dwordx4 a[44:47], v2, s[4:7], s45 offen offset:1024
  buffer_load_dwordx4 a[48:51], v2, s[4:7], s46 offen offset:0
  buffer_load_dwordx4 a[52:55], v2, s[4:7], s46 offen offset:1024
  v_add_u32 v2, 14336, v2
  buffer_load_dwordx4 a[56:59], v2, s[4:7], s40 offen offset:0
  buffer_load_dwordx4 a[60:63], v2, s[4:7], s40 offen offset:1024
  buffer_load_dwordx4 a[64:67], v2, s[4:7], s41 offen offset:0
  buffer_load_dwordx4 a[68:71], v2, s[4:7], s41 offen offset:1024
  buffer_load_dwordx4 a[72:75], v2, s[4:7], s42 offen offset:0
  buffer_load_dwordx4 a[76:79], v2, s[4:7], s42 offen offset:1024
  buffer_load_dwordx4 a[80:83], v2, s[4:7], s43 offen offset:0
  buffer_load_dwordx4 a[84:87], v2, s[4:7], s43 offen offset:1024
  buffer_load_dwordx4 a[88:91], v2, s[4:7], s44 offen offset:0
  buffer_load_dwordx4 a[92:95], v2, s[4:7], s44 offen offset:1024
  buffer_load_dwordx4 a[96:99], v2, s[4:7], s45 offen offset:0
  buffer_load_dwordx4 a[100:103], v2, s[4:7], s45 offen offset:1024
  buffer_load_dwordx4 a[104:107], v2, s[4:7], s46 offen offset:0
  buffer_load_dwordx4 a[108:111], v2, s[4:7], s46 offen offset:1024
  v_add_u32 v2, 14336, v2
  buffer_load_dwordx4 a[112:115], v2, s[4:7], s40 offen offset:0
  buffer_load_dwordx4 a[116:119], v2, s[4:7], s40 offen offset:1024
  buffer_load_dwordx4 a[120:123], v2, s[4:7], s41 offen offset:0
  buffer_load_dwordx4 a[124:127], v2, s[4:7], s41 offen offset:1024
  buffer_load_dwordx4 a[128:131], v2, s[4:7], s42 offen offset:0
  buffer_load_dwordx4 a[132:135], v2, s[4:7], s42 offen offset:1024
  buffer_load_dwordx4 a[136:139], v2, s[4:7], s43 offen offset:0
  buffer_load_dwordx4 a[140:143], v2, s[4:7], s43 offen offset:1024
  buffer_load_dwordx4 a[144:147], v2, s[4:7], s44 offen offset:0
  buffer_load_dwordx4 a[148:151], v2, s[4:7], s44 offen offset:1024
  buffer_load_dwordx4 a[152:155], v2, s[4:7], s45 offen offset:0
  buffer_load_dwordx4 a[156:159], v2, s[4:7], s45 offen offset:1024
  buffer_load_dwordx4 a[160:163], v2, s[4:7], s46 offen offset:0
  buffer_load_dwordx4 a[164:167], v2, s[4:7], s46 offen offset:1024
  v_add_u32 v2, 14336, v2
  buffer_load_dwordx4 a[168:171], v2, s[4:7], s40 offen offset:0
  buffer_load_dwordx4 a[172:175], v2, s[4:7], s40 offen offset:1024
  buffer_load_dwordx4 a[176:179], v2, s[4:7], s41 offen offset:0
  buffer_load_dwordx4 a[180:183], v2, s[4:7], s41 offen offset:1024
  buffer_load_dwordx4 a[184:187], v2, s[4:7], s42 offen offset:0
  buffer_load_dwordx4 a[188:191], v2, s[4:7], s42 offen offset:1024
  buffer_load_dwordx4 a[192:195], v2, s[4:7], s43 offen offset:0
  buffer_load_dwordx4 a[196:199], v2, s[4:7], s43 offen offset:1024
  buffer_load_dwordx4 a[200:203], v2, s[4:7], s44 offen offset:0
  buffer_load_dwordx4 a[204:207], v2, s[4:7], s44 offen offset:1024
  buffer_load_dwordx4 a[208:211], v2, s[4:7], s45 offen offset:0
  buffer_load_dwordx4 a[212:215], v2, s[4:7], s45 offen offset:1024
  buffer_load_dwordx4 a[216:219], v2, s[4:7], s46 offen offset:0
  buffer_load_dwordx4 a[220:223], v2, s[4:7], s46 offen offset:1024
  v_add_u32 v2, 14336, v2
  buffer_load_dwordx4 a[224:227], v2, s[4:7], s40 offen offset:0
  buffer_load_dwordx4 a[228:231], v2, s[4:7], s40 offen offset:1024
  buffer_load_dwordx4 a[232:235], v2, s[4:7], s41 offen offset:0
  buffer_load_dwordx4 a[236:239], v2, s[4:7], s41 offen offset:1024
  buffer_load_dwordx4 a[240:243], v2, s[4:7], s42 offen offset:0
  buffer_load_dwordx4 a[244:247], v2, s[4:7], s42 offen offset:1024
  buffer_load_dwordx4 a[248:251], v2, s[4:7], s43 offen offset:0
  buffer_load_dwordx4 a[252:255], v2, s[4:7], s43 offen offset:1024
  buffer_load_dwordx4 v[120:123], v2, s[4:7], s44 offen offset:0
  buffer_load_dwordx4 v[124:127], v2, s[4:7], s44 offen offset:1024
  buffer_load_dwordx4 v[128:131], v2, s[4:7], s45 offen offset:0
  buffer_load_dwordx4 v[132:135], v2, s[4:7], s45 offen offset:1024
  buffer_load_dwordx4 v[136:139], v2, s[4:7], s46 offen offset:0
  buffer_load_dwordx4 v[140:143], v2, s[4:7], s46 offen offset:1024
  v_add_u32 v2, 14336, v2
  buffer_load_dwordx4 v[144:147], v2, s[4:7], s40 offen offset:0
  buffer_load_dwordx4 v[148:151], v2, s[4:7], s40 offen offset:1024
  buffer_load_dwordx4 v[152:155], v2, s[4:7], s41 offen offset:0
  buffer_load_dwordx4 v[156:159], v2, s[4:7], s41 offen offset:1024
  buffer_load_dwordx4 v[160:163], v2, s[4:7], s42 offen offset:0
  buffer_load_dwordx4 v[164:167], v2, s[4:7], s42 offen offset:1024
  buffer_load_dwordx4 v[168:171], v2, s[4:7], s43 offen offset:0
  buffer_load_dwordx4 v[172:175], v2, s[4:7], s43 offen offset:1024
  buffer_load_dwordx4 v[176:179], v2, s[4:7], s44 offen offset:0
  buffer_load_dwordx4 v[180:183], v2, s[4:7], s44 offen offset:1024
  buffer_load_dwordx4 v[184:187], v2, s[4:7], s45 offen offset:0
  buffer_load_dwordx4 v[188:191], v2, s[4:7], s45 offen offset:1024
  buffer_load_dwordx4 v[192:195], v2, s[4:7], s46 offen offset:0
  buffer_load_dwordx4 v[196:199], v2, s[4:7], s46 offen offset:1024
  v_add_u32 v2, 14336, v2
  buffer_load_dwordx4 v[200:203], v2, s[4:7], s40 offen offset:0
  buffer_load_dwordx4 v[204:207], v2, s[4:7], s40 offen offset:1024
  buffer_load_dwordx4 v[208:211], v2, s[4:7], s41 offen offset:0
  buffer_load_dwordx4 v[212:215], v2, s[4:7], s41 offen offset:1024
  buffer_load_dwordx4 v[216:219], v2, s[4:7], s42 offen offset:0
  buffer_load_dwordx4 v[220:223], v2, s[4:7], s42 offen offset:1024
  buffer_load_dwordx4 v[224:227], v2, s[4:7], s43 offen offset:0
  buffer_load_dwordx4 v[228:231], v2, s[4:7], s43 offen offset:1024
  buffer_load_dwordx4 v[232:235], v2, s[4:7], s44 offen offset:0
  buffer_load_dwordx4 v[236:239], v2, s[4:7], s44 offen offset:1024
  buffer_load_dwordx4 v[240:243], v2, s[4:7], s45 offen offset:0
  buffer_load_dwordx4 v[244:247], v2, s[4:7], s45 offen offset:1024
  buffer_load_dwordx4 v[248:251], v2, s[4:7], s46 offen offset:0
  buffer_load_dwordx4 v[252:255], v2, s[4:7], s46 offen offset:1024
  s_mul_i32 s20, s11, 28672
  s_add_u32 s20, s20, 28835840
  s_sub_u32 s40, s40, s19
  s_lshr_b32 s40, s40, 1
  s_add_u32 s40, s40, s20
  s_sub_u32 s41, s41, s19
  s_lshr_b32 s41, s41, 1
  s_add_u32 s41, s41, s20
  s_sub_u32 s42, s42, s19
  s_lshr_b32 s42, s42, 1
  s_add_u32 s42, s42, s20
  s_sub_u32 s43, s43, s19
  s_lshr_b32 s43, s43, 1
  s_add_u32 s43, s43, s20
  s_sub_u32 s44, s44, s19
  s_lshr_b32 s44, s44, 1
  s_add_u32 s44, s44, s20
  s_sub_u32 s45, s45, s19
  s_lshr_b32 s45, s45, 1
  s_add_u32 s45, s45, s20
  s_sub_u32 s46, s46, s19
  s_lshr_b32 s46, s46, 1
  s_add_u32 s46, s46, s20
  v_mov_b32 v2, 0x0
  v_bfe_u32 v52, v16, 0, 3
  s_mov_b32 s100, 0x10
  v_mul_lo_u32 v52, v52, s100
  v_add_u32 v2, v2, v52
  v_bfe_u32 v52, v16, 4, 2
  s_mov_b32 s100, 0x80
  v_mul_lo_u32 v52, v52, s100
  v_add_u32 v2, v2, v52
  v_mov_b32 v53, 0x400
  v_bfe_u32 v52, v16, 0, 3
  s_mov_b32 s100, 0x10
  v_mul_lo_u32 v52, v52, s100
  v_add_u32 v53, v53, v52
  v_bfe_u32 v52, v16, 4, 1
  s_mov_b32 s100, 0x200
  v_mul_lo_u32 v52, v52, s100
  v_add_u32 v53, v53, v52
  v_bfe_u32 v52, v16, 5, 1
  s_mov_b32 s100, 0x80
  v_mul_lo_u32 v52, v52, s100
  v_add_u32 v53, v53, v52
  v_and_b32 v52, 8, v16
  v_cmp_ne_u32 vcc, 0, v52
  s_nop 1
  v_cndmask_b32 v2, v2, v53, vcc
  v_mov_b32 v3, 0x200
  v_bfe_u32 v52, v16, 0, 3
  s_mov_b32 s100, 0x10
  v_mul_lo_u32 v52, v52, s100
  v_add_u32 v3, v3, v52
  v_bfe_u32 v52, v16, 4, 2
  s_mov_b32 s100, 0x80
  v_mul_lo_u32 v52, v52, s100
  v_add_u32 v3, v3, v52
  v_mov_b32 v53, 0x500
  v_bfe_u32 v52, v16, 0, 3
  s_mov_b32 s100, 0x10
  v_mul_lo_u32 v52, v52, s100
  v_add_u32 v53, v53, v52
  v_bfe_u32 v52, v16, 4, 1
  s_mov_b32 s100, 0x100
  v_mul_lo_u32 v52, v52, s100
  v_add_u32 v53, v53, v52
  v_bfe_u32 v52, v16, 5, 1
  s_mov_b32 s100, 0x80
  v_mul_lo_u32 v52, v52, s100
  v_add_u32 v53, v53, v52
  v_and_b32 v52, 8, v16
  v_cmp_ne_u32 vcc, 0, v52
  s_nop 1
  v_cndmask_b32 v3, v3, v53, vcc
  v_mov_b32 v4, 0x0
  v_bfe_u32 v52, v16, 0, 4
  s_mov_b32 s100, 0x10
  v_mul_lo_u32 v52, v52, s100
  v_add_u32 v4, v4, v52
  v_bfe_u32 v52, v16, 4, 2
  s_mov_b32 s100, 0x200
  v_mul_lo_u32 v52, v52, s100
  v_add_u32 v4, v4, v52
  v_mov_b32 v5, 0x1000
  v_bfe_u32 v52, v16, 0, 4
  s_mov_b32 s100, 0x10
  v_mul_lo_u32 v52, v52, s100
  v_add_u32 v5, v5, v52
  v_bfe_u32 v52, v16, 4, 1
  s_mov_b32 s100, 0x800
  v_mul_lo_u32 v52, v52, s100
  v_add_u32 v5, v5, v52
  v_bfe_u32 v52, v16, 5, 1
  s_mov_b32 s100, 0x200
  v_mul_lo_u32 v52, v52, s100
  v_add_u32 v5, v5, v52
  v_mov_b32 v6, 0x1400
  v_bfe_u32 v52, v16, 0, 4
  s_mov_b32 s100, 0x10
  v_mul_lo_u32 v52, v52, s100
  v_add_u32 v6, v6, v52
  v_bfe_u32 v52, v16, 4, 1
  s_mov_b32 s100, 0x400
  v_mul_lo_u32 v52, v52, s100
  v_add_u32 v6, v6, v52
  v_bfe_u32 v52, v16, 5, 1
  s_mov_b32 s100, 0x200
  v_mul_lo_u32 v52, v52, s100
  v_add_u32 v6, v6, v52
  s_mul_i32 s19, s8, 1792
  v_add_u32 v2, s19, v2
  v_add_u32 v3, s19, v3
  s_mul_i32 s19, s8, 7168
  v_add_u32 v4, s19, v4
  v_add_u32 v5, s19, v5
  v_add_u32 v6, s19, v6
  s_mov_b32 vcc_lo, 0xaaaaaaaa
  s_mov_b32 vcc_hi, 0xaaaaaaaa
  v_mov_b32 v7, 0x44444444
  v_mov_b32 v52, 0xeeeeeeee
  v_cndmask_b32 v7, v7, v52, vcc
  v_mov_b32 v8, 0x44444444
  v_bfe_u32 v52, v16, 5, 1
  s_mov_b32 s100, 0xaa00aa00
  v_mul_lo_u32 v52, v52, s100
  v_add_u32 v8, v8, v52
  v_mov_b32 v53, 0xeeeeeeee
  v_and_b32 v52, 1, v16
  v_cmp_ne_u32 vcc, 0, v52
  s_nop 1
  v_cndmask_b32 v8, v8, v53, vcc
  s_mov_b32 vcc_lo, 0x100001
  s_mov_b32 vcc_hi, 0x10000100
  v_mov_b32 v18, 0x0
  v_mov_b32 v52, 0x3f803f80
  v_cndmask_b32 v18, v18, v52, vcc
  s_mov_b32 vcc_lo, 0x400004
  s_mov_b32 vcc_hi, 0x40000400
  v_mov_b32 v19, 0x0
  v_mov_b32 v52, 0x3f803f80
  v_cndmask_b32 v19, v19, v52, vcc
  s_mov_b32 vcc_lo, 0x200002
  s_mov_b32 vcc_hi, 0x20000200
  v_mov_b32 v20, 0x0
  v_mov_b32 v52, 0x3f803f80
  v_cndmask_b32 v20, v20, v52, vcc
  s_mov_b32 vcc_lo, 0x800008
  s_mov_b32 vcc_hi, 0x80000800
  v_mov_b32 v21, 0x0
  v_mov_b32 v52, 0x3f803f80
  v_cndmask_b32 v21, v21, v52, vcc
  v_lshlrev_b32 v10, 2, v16
  s_mul_i32 s19, s8, 768
  v_add_u32 v9, s19, v10
  v_mov_b32 v10, 0x0
  v_bfe_u32 v52, v16, 0, 2
  s_mov_b32 s100, 0x8
  v_mul_lo_u32 v52, v52, s100
  v_add_u32 v10, v10, v52
  v_bfe_u32 v52, v16, 2, 1
  s_mov_b32 s100, 0x4
  v_mul_lo_u32 v52, v52, s100
  v_add_u32 v10, v10, v52
  v_bfe_u32 v52, v16, 3, 1
  s_mov_b32 s100, 0x20
  v_mul_lo_u32 v52, v52, s100
  v_add_u32 v10, v10, v52
  v_bfe_u32 v52, v16, 4, 1
  s_mov_b32 s100, 0xc00
  v_mul_lo_u32 v52, v52, s100
  v_add_u32 v10, v10, v52
  v_bfe_u32 v52, v16, 5, 1
  s_mov_b32 s100, 0x40
  v_mul_lo_u32 v52, v52, s100
  v_add_u32 v10, v10, v52
  s_and_b32 s19, s8, 1
  s_lshl_b32 s20, s19, 7
  v_add_u32 v10, s20, v10
  v_mov_b32 v12, 0x0
  v_bfe_u32 v52, v16, 0, 2
  s_mov_b32 s100, 0x4
  v_mul_lo_u32 v52, v52, s100
  v_add_u32 v12, v12, v52
  v_bfe_u32 v52, v16, 4, 2
  s_mov_b32 s100, 0x10
  v_mul_lo_u32 v52, v52, s100
  v_add_u32 v12, v12, v52
  v_mov_b32 v53, 0x7ff00000
  v_and_b32 v52, 8, v16
  v_cmp_ne_u32 vcc, 0, v52
  s_nop 1
  v_cndmask_b32 v12, v12, v53, vcc
  v_mov_b32 v53, 0x7ff00000
  v_and_b32 v52, 4, v16
  v_cmp_ne_u32 vcc, 0, v52
  s_nop 1
  v_cndmask_b32 v12, v12, v53, vcc
  v_mov_b32 v11, 0x0
  v_bfe_u32 v52, v16, 0, 3
  s_mov_b32 s100, 0x4
  v_mul_lo_u32 v52, v52, s100
  v_add_u32 v11, v11, v52
  v_bfe_u32 v52, v16, 3, 1
  s_mov_b32 s100, 0x100
  v_mul_lo_u32 v52, v52, s100
  v_add_u32 v11, v11, v52
  v_bfe_u32 v52, v16, 4, 2
  s_mov_b32 s100, 0x20
  v_mul_lo_u32 v52, v52, s100
  v_add_u32 v11, v11, v52
  s_lshl_b32 s20, s19, 7
  v_add_u32 v11, s20, v11
  s_lshl_b32 s20, s19, 6
  v_add_u32 v12, s20, v12
  s_and_b32 s21, s10, 3
  s_lshr_b32 s19, s10, 2
  s_mul_i32 s19, s19, 2560
  s_lshl_b32 s20, s21, 9
  s_add_u32 s20, s20, s19
  v_add_u32 v11, s20, v11
  s_lshl_b32 s20, s21, 7
  s_add_u32 s20, s20, s19
  s_add_u32 s20, s20, 2048
  v_add_u32 v12, s20, v12
  v_min_u32 v13, 55, v16
  v_lshlrev_b32 v13, 2, v13
  s_and_b32 s19, s10, 7
  s_lshl_b32 s19, s19, 8
  v_add_u32 v13, s19, v13
  v_mov_b32 v14, 0x0
  v_bfe_u32 v52, v16, 0, 3
  s_mov_b32 s100, 0x100
  v_mul_lo_u32 v52, v52, s100
  v_add_u32 v14, v14, v52
  v_mov_b32 v53, 0x7ff00000
  v_and_b32 v52, 32, v16
  v_cmp_ne_u32 vcc, 0, v52
  s_nop 1
  v_cndmask_b32 v14, v14, v53, vcc
  v_mov_b32 v53, 0x7ff00000
  v_and_b32 v52, 16, v16
  v_cmp_ne_u32 vcc, 0, v52
  s_nop 1
  v_cndmask_b32 v14, v14, v53, vcc
  v_mov_b32 v53, 0x7ff00000
  v_and_b32 v52, 8, v16
  v_cmp_ne_u32 vcc, 0, v52
  s_nop 1
  v_cndmask_b32 v14, v14, v53, vcc
  s_lshl_b32 s19, s10, 1
  s_and_b32 s20, s8, 1
  s_add_u32 s19, s19, s20
  s_lshl_b32 s19, s19, 2
  v_add_u32 v14, s19, v14
  s_mul_i32 s19, s11, 28672
  s_add_u32 s13, s19, 28835840
  s_add_u32 s14, s13, 7168
  s_mul_i32 s19, s11, 655360
  s_add_u32 s15, s19, 45088768
  s_lshl_b32 s19, s11, 13
  s_add_u32 s17, s19, 18874368
  s_add_u32 s18, s17, 4096
  s_mul_i32 s12, s11, 7340032
  s_add_u32 s12, s12, 25165824
  s_mov_b32 s16, 1
  s_mov_b32 s22, 0
  s_mov_b32 s101, 18907136
  v_mbcnt_lo_u32_b32 v53, -1, 0
  v_mbcnt_hi_u32_b32 v53, -1, v53
  s_lshl_b32 s100, s8, 6
  v_add_u32 v53, s100, v53
  v_min_u32 v53, 255, v53
  v_lshlrev_b32 v53, 7, v53
  s_branch wc_91x
wc_91:
  s_sleep 2
wc_91x:
  buffer_load_dword v52, v53, s[4:7], s101 offen sc1
  s_sub_u32 s99, s99, 1
  s_cbranch_scc1 FAIL
  s_waitcnt vmcnt(0)
  v_cmp_eq_u32 vcc, 0, v52
  s_cbranch_vccnz wc_91
wcd_92:
  s_barrier
  buffer_load_dwordx4 v[80:83], v4, s[4:7], s12 offen offset:0 sc1
  buffer_load_dwordx4 v[84:87], v4, s[4:7], s12 offen offset:2048 sc1
  buffer_load_dwordx4 v[88:91], v5, s[4:7], s12 offen offset:0 sc1
  buffer_load_dwordx4 v[92:95], v6, s[4:7], s12 offen offset:0 sc1
  buffer_load_dwordx4 v[96:99], v4, s[4:7], s12 offen offset:256 sc1
  buffer_load_dwordx4 v[100:103], v4, s[4:7], s12 offen offset:2304 sc1
  buffer_load_dwordx4 v[104:107], v5, s[4:7], s12 offen offset:256 sc1
  buffer_load_dwordx4 v[108:111], v6, s[4:7], s12 offen offset:256 sc1
  s_lshl_b32 s21, s8, 13
  s_add_u32 s21, s21, 8192
  v_add_u32 v17, s21, v1
  v_mov_b32 v15, -1
  ds_write2st64_b32 v10, v15, v15 offset0:0 offset1:1
  ds_write2st64_b32 v10, v15, v15 offset0:2 offset1:3
  ds_write2st64_b32 v10, v15, v15 offset0:4 offset1:5
  ds_write2st64_b32 v10, v15, v15 offset0:6 offset1:7
  ds_write2st64_b32 v10, v15, v15 offset0:8 offset1:9
  ds_write2st64_b32 v10, v15, v15 offset0:10 offset1:11
  s_waitcnt lgkmcnt(0)
A_loop:
  v_mov_b64 v[52:53], 0
  v_mov_b64 v[54:55], 0
  v_mov_b64 v[56:57], 0
  v_mov_b64 v[58:59], 0
  v_mov_b64 v[60:61], 0
  v_mov_b64 v[62:63], 0
  v_mov_b64 v[64:65], 0
  v_mov_b64 v[66:67], 0
  v_mov_b64 v[68:69], 0
  v_mov_b64 v[70:71], 0
  v_mov_b64 v[72:73], 0
  v_mov_b64 v[74:75], 0
  v_mov_b64 v[76:77], 0
  v_mov_b64 v[78:79], 0
A_xchk:
  s_waitcnt vmcnt(0) lgkmcnt(0)
  v_max3_u32 v15, v80, v81, v82
  v_max3_u32 v15, v15, v83, v84
  v_max3_u32 v15, v15, v85, v86
  v_max3_u32 v15, v15, v87, v88
  v_max3_u32 v15, v15, v89, v90
  v_max3_u32 v15, v15, v91, v92
  v_max3_u32 v15, v15, v93, v94
  v_max3_u32 v15, v15, v95, v96
  v_max3_u32 v15, v15, v97, v98
  v_max3_u32 v15, v15, v99, v100
  v_max3_u32 v15, v15, v101, v102
  v_max3_u32 v15, v15, v103, v104
  v_max3_u32 v15, v15, v105, v106
  v_max3_u32 v15, v15, v107, v108
  v_max3_u32 v15, v15, v109, v110
  v_max_u32 v15, v15, v111
  v_cmp_eq_u32 vcc, -1, v15
  s_cbranch_vccnz A_xbad
  s_add_u32 s12, s12, 28672
  v_mov_b32 v0, s16
  s_add_u32 s19, s13, 4096
  s_cmp_lg_u32 s8, 3
  s_cbranch_scc1 A_go
  buffer_load_dword v22, v13, s[4:7], s17 offen sc1
  s_nop 7
  buffer_load_dword v23, v13, s[4:7], s17 offen sc1
  s_nop 7
  buffer_load_dword v16, v13, s[4:7], s17 offen sc1
  s_nop 7
sp_93:
  buffer_load_dword v15, v13, s[4:7], s17 offen sc1
  s_waitcnt vmcnt(3)
  v_cmp_gt_u32 vcc, s16, v22
  s_cbranch_vccz spd_94
  buffer_load_dword v22, v13, s[4:7], s17 offen sc1
  s_waitcnt vmcnt(3)
  v_cmp_gt_u32 vcc, s16, v23
  s_cbranch_vccz spd_94
  buffer_load_dword v23, v13, s[4:7], s17 offen sc1
  s_waitcnt vmcnt(3)
  v_cmp_gt_u32 vcc, s16, v16
  s_cbranch_vccz spd_94
  buffer_load_dword v16, v13, s[4:7], s17 offen sc1
  s_waitcnt vmcnt(3)
  v_cmp_gt_u32 vcc, s16, v15
  s_cbranch_vccz spd_94
  s_sub_u32 s99, s99, 1
  s_cbranch_scc1 FAIL
  s_branch sp_93
spd_94:
  s_nop 7
A_go:
  s_barrier
A_retry:
  buffer_load_dwordx4 v[24:27], v1, s[4:7], s40 offen sc1
  s_nop 2
  buffer_load_dwordx4 v[28:31], v1, s[4:7], s41 offen sc1
  s_nop 2
  buffer_load_dwordx4 v[32:35], v1, s[4:7], s42 offen sc1
  s_nop 2
  buffer_load_dwordx4 v[36:39], v1, s[4:7], s43 offen sc1
  s_waitcnt vmcnt(3)
  v_smfmac_f32_16x16x64_bf16 v[52:55], v[24:27], a[0:7], v7
  buffer_load_dwordx4 v[40:43], v1, s[4:7], s44 offen sc1
  v_smfmac_f32_16x16x64_bf16 v[56:59], v[24:27], a[56:63], v7
  v_smfmac_f32_16x16x64_bf16 v[60:63], v[24:27], a[112:119], v7
  buffer_load_dwordx4 v[44:47], v1, s[4:7], s45 offen sc1
  v_smfmac_f32_16x16x64_bf16 v[64:67], v[24:27], a[168:175], v7
  v_smfmac_f32_16x16x64_bf16 v[68:71], v[24:27], a[224:231], v7
  buffer_load_dwordx4 v[48:51], v1, s[4:7], s46 offen sc1
  v_smfmac_f32_16x16x64_bf16 v[72:75], v[24:27], v[144:151], v7
  v_smfmac_f32_16x16x64_bf16 v[76:79], v[24:27], v[200:207], v7
  s_waitcnt vmcnt(5)
  v_smfmac_f32_16x16x64_bf16 v[52:55], v[28:31], a[8:15], v7
  buffer_load_dwordx4 v[112:115], v2, s[4:7], s14 offen sc1
  v_smfmac_f32_16x16x64_bf16 v[56:59], v[28:31], a[64:71], v7
  v_smfmac_f32_16x16x64_bf16 v[60:63], v[28:31], a[120:127], v7
  v_smfmac_f32_16x16x64_bf16 v[64:67], v[28:31], a[176:183], v7
  buffer_load_dwordx4 v[116:119], v3, s[4:7], s14 offen sc1
  v_smfmac_f32_16x16x64_bf16 v[68:71], v[28:31], a[232:239], v7
  v_smfmac_f32_16x16x64_bf16 v[72:75], v[28:31], v[152:159], v7
  v_smfmac_f32_16x16x64_bf16 v[76:79], v[28:31], v[208:215], v7
  s_waitcnt vmcnt(6)
  v_smfmac_f32_16x16x64_bf16 v[52:55], v[32:35], a[16:23], v7
  v_mov_b64 v[24:25], 0
  v_smfmac_f32_16x16x64_bf16 v[56:59], v[32:35], a[72:79], v7
  v_mov_b64 v[26:27], 0
  v_smfmac_f32_16x16x64_bf16 v[60:63], v[32:35], a[128:135], v7
  v_mov_b64 v[28:29], 0
  v_smfmac_f32_16x16x64_bf16 v[64:67], v[32:35], a[184:191], v7
  v_mov_b64 v[30:31], 0
  v_smfmac_f32_16x16x64_bf16 v[68:71], v[32:35], a[240:247], v7
  v_smfmac_f32_16x16x64_bf16 v[72:75], v[32:35], v[160:167], v7
  v_smfmac_f32_16x16x64_bf16 v[76:79], v[32:35], v[216:223], v7
  s_waitcnt vmcnt(5)
  v_smfmac_f32_16x16x64_bf16 v[52:55], v[36:39], a[24:31], v7
  v_mov_b64 v[32:33], 0
  v_smfmac_f32_16x16x64_bf16 v[56:59], v[36:39], a[80:87], v7
  v_mov_b64 v[34:35], 0
  v_smfmac_f32_16x16x64_bf16 v[60:63], v[36:39], a[136:143], v7
  v_smfmac_f32_16x16x64_bf16 v[64:67], v[36:39], a[192:199], v7
  v_smfmac_f32_16x16x64_bf16 v[68:71], v[36:39], a[248:255], v7
  v_smfmac_f32_16x16x64_bf16 v[72:75], v[36:39], v[168:175], v7
  v_smfmac_f32_16x16x64_bf16 v[76:79], v[36:39], v[224:231], v7
  s_waitcnt vmcnt(2)
  v_smfmac_f32_16x16x64_bf16 v[76:79], v[40:43], v[232:239], v7
  v_mov_b64 v[36:37], 0
  v_smfmac_f32_16x16x64_bf16 v[76:79], v[44:47], v[240:247], v7
  v_mov_b64 v[38:39], 0
  s_add_i32 m0, s21, 0
  v_smfmac_f32_16x16x64_bf16 v[76:79], v[48:51], v[248:255], v7
  buffer_load_dwordx4 v4, s[4:7], s12 offen offset:0 sc1 lds
  v_smfmac_f32_16x16x64_bf16 v[68:71], v[40:43], v[120:127], v7
  v_smfmac_f32_16x16x64_bf16 v[68:71], v[44:47], v[128:135], v7
  v_cvt_pk_bf16_f32 v76, v76, v77
  v_smfmac_f32_16x16x64_bf16 v[68:71], v[48:51], v[136:143], v7
  v_cvt_pk_bf16_f32 v77, v78, v79
  s_add_i32 m0, s21, -1024
  v_smfmac_f32_16x16x64_bf16 v[72:75], v[40:43], v[176:183], v7
  buffer_load_dwordx4 v4, s[4:7], s12 offen offset:2048 sc1 lds
  v_mfma_f32_16x16x16_bf16 v[76:79], v[76:77], v[18:19], 0
  v_cvt_pk_bf16_f32 v68, v68, v69
  v_cvt_pk_bf16_f32 v69, v70, v71
  v_smfmac_f32_16x16x64_bf16 v[72:75], v[44:47], v[184:191], v7
  v_smfmac_f32_16x16x64_bf16 v[72:75], v[48:51], v[192:199], v7
  s_add_i32 m0, s21, 2048
  v_smfmac_f32_16x16x64_bf16 v[52:55], v[40:43], a[32:39], v7
  buffer_load_dwordx4 v5, s[4:7], s12 offen offset:0 sc1 lds
  v_smfmac_f32_16x16x64_bf16 v[52:55], v[44:47], a[40:47], v7
  v_cvt_pk_bf16_f32 v70, v72, v73
  v_smfmac_f32_16x16x64_bf16 v[52:55], v[48:51], a[48:55], v7
  v_cvt_pk_bf16_f32 v71, v74, v75
  s_add_i32 m0, s21, 3072
  v_smfmac_f32_16x16x64_bf16 v[56:59], v[40:43], a[88:95], v7
  buffer_load_dwordx4 v6, s[4:7], s12 offen offset:0 sc1 lds
  v_mfma_f32_16x16x32_bf16 v[72:75], v[68:71], v[18:21], 0
  v_cvt_pk_bf16_f32 v70, v76, v77
  v_cvt_pk_bf16_f32 v71, v78, v79
  v_smfmac_f32_16x16x64_bf16 v[56:59], v[44:47], a[96:103], v7
  v_cvt_pk_bf16_f32 v52, v52, v53
  v_smfmac_f32_16x16x64_bf16 v[56:59], v[48:51], a[104:111], v7
  v_cvt_pk_bf16_f32 v68, v72, v73
  v_smfmac_f32_16x16x64_bf16 v[60:63], v[40:43], a[144:151], v7
  v_cvt_pk_bf16_f32 v69, v74, v75
  v_smfmac_f32_16x16x64_bf16 v[60:63], v[44:47], a[152:159], v7
  v_cvt_pk_bf16_f32 v53, v54, v55
  v_smfmac_f32_16x16x64_bf16 v[60:63], v[48:51], a[160:167], v7
  v_cvt_pk_bf16_f32 v54, v56, v57
  v_smfmac_f32_16x16x64_bf16 v[64:67], v[40:43], a[200:207], v7
  v_cvt_pk_bf16_f32 v55, v58, v59
  v_smfmac_f32_16x16x64_bf16 v[64:67], v[44:47], a[208:215], v7
  v_cvt_pk_bf16_f32 v60, v60, v61
  v_smfmac_f32_16x16x64_bf16 v[64:67], v[48:51], a[216:223], v7
  v_cvt_pk_bf16_f32 v61, v62, v63
  v_mfma_f32_16x16x32_bf16 v[56:59], v[52:55], v[18:21], 0
  s_waitcnt vmcnt(4)
  v_smfmac_f32_16x16x64_bf16 v[36:39], v[68:71], v[112:119], v8
  v_cvt_pk_bf16_f32 v62, v64, v65
  v_cvt_pk_bf16_f32 v63, v66, v67
  v_smfmac_f32_16x16x64_bf16 v[24:27], v[68:71], v[88:95], v8
  v_cvt_pk_bf16_f32 v52, v56, v57
  v_mfma_f32_16x16x32_bf16 v[64:67], v[60:63], v[18:21], 0
  v_cvt_pk_bf16_f32 v53, v58, v59
  v_add_f32 v36, v36, v37
  v_smfmac_f32_16x16x64_bf16 v[28:31], v[68:71], v[104:111], v8
  v_add_f32 v38, v38, v39
  s_mov_b32 vcc_lo, 0xff00ff00
  s_mov_b32 vcc_hi, 0xff00ff00
  s_nop 0
  v_cvt_pk_bf16_f32 v54, v64, v65
  v_cvt_pk_bf16_f32 v55, v66, v67
  s_nop 1
  v_smfmac_f32_16x16x64_bf16 v[32:35], v[52:55], v[112:119], v7
  v_smfmac_f32_16x16x64_bf16 v[24:27], v[52:55], v[80:87], v7
  v_smfmac_f32_16x16x64_bf16 v[28:31], v[52:55], v[96:103], v7
  v_add_f32 v32, v32, v33
  v_add_f32 v34, v34, v35
  v_cndmask_b32 v32, v32, v36, vcc
  v_cndmask_b32 v34, v34, v38, vcc
  v_add_f32 v24, v24, v25
  ds_write2st64_b32 v9, v32, v34 offset0:2 offset1:14
  v_add_f32 v26, v26, v27
  v_cmp_u_f32 vcc, v32, v34
  v_add_f32 v28, v28, v29
  ds_write2st64_b32 v9, v24, v26 offset0:0 offset1:12
  v_add_f32 v30, v30, v31
  ds_write2st64_b32 v9, v28, v30 offset0:1 offset1:13
  s_cbranch_vccnz A_bad
A_ok:
  s_cmp_ge_u32 s8, 2
  s_barrier
  s_cbranch_scc1 A_other
  ds_read2st64_b32 v[54:55], v10 offset0:2 offset1:5
  ds_read2st64_b32 v[58:59], v10 offset0:8 offset1:11
  ds_read2st64_b32 v[60:61], v10 offset0:0 offset1:1
  ds_read2st64_b32 v[62:63], v10 offset0:3 offset1:4
  ds_read2st64_b32 v[64:65], v10 offset0:6 offset1:7
  ds_read2st64_b32 v[66:67], v10 offset0:9 offset1:10
  s_waitcnt lgkmcnt(4)
  v_pk_add_f32 v[54:55], v[54:55], v[58:59]
  s_waitcnt lgkmcnt(2)
  v_add_f32 v54, v54, v55
  v_pk_add_f32 v[60:61], v[60:61], v[62:63]
  s_waitcnt lgkmcnt(0)
  v_pk_add_f32 v[64:65], v[64:65], v[66:67]
  v_add_f32_dpp v54, v54, v54 row_ror:8 row_mask:0xf bank_mask:0xf
  v_pk_add_f32 v[52:53], v[60:61], v[64:65]
  v_max3_f32 v56, v52, v53, v54
  buffer_store_dword v0, v14, s[4:7], s18 offen
  s_nop 0
  v_max_f32_dpp v56, v56, v56 row_ror:1 row_mask:0xf bank_mask:0xf
  s_nop 1
  v_max_f32_dpp v56, v56, v56 row_ror:2 row_mask:0xf bank_mask:0xf
  s_nop 1
  v_max_f32_dpp v56, v56, v56 row_ror:4 row_mask:0xf bank_mask:0xf
  s_nop 1
  v_max_f32_dpp v56, v56, v56 row_ror:8 row_mask:0xf bank_mask:0xf
  v_sub_f32 v54, v54, v56
  v_pk_add_f32 v[52:53], v[52:53], v[56:57] op_sel_hi:[1,0] neg_lo:[0,1] neg_hi:[0,1]
  v_exp_f32 v54, v54
  v_exp_f32 v52, v52
  v_exp_f32 v53, v53
  v_fma_f32 v56, v54, 0.5, v52
  v_add_f32 v56, v56, v53
  v_mov_b32_dpp v55, v54 row_ror:12 row_mask:0xf bank_mask:0xf
  s_nop 0
  v_add_f32_dpp v56, v56, v56 row_ror:1 row_mask:0xf bank_mask:0xf
  s_nop 1
  v_add_f32_dpp v56, v56, v56 row_ror:2 row_mask:0xf bank_mask:0xf
  s_nop 1
  v_add_f32_dpp v56, v56, v56 row_ror:4 row_mask:0xf bank_mask:0xf
  s_nop 1
  v_add_f32_dpp v56, v56, v56 row_ror:8 row_mask:0xf bank_mask:0xf
  v_rcp_f32 v58, v56
  v_cmpx_o_f32 vcc, v56, v56
  v_pk_mul_f32 v[52:53], v[52:53], v[58:59] op_sel_hi:[1,0]
  v_cvt_pk_bf16_f32 v52, |v52|, |v53|
  v_pk_mul_f32 v[54:55], v[54:55], v[58:59] op_sel_hi:[1,0]
  buffer_store_dword v52, v11, s[4:7], s15 offen
  v_cvt_pk_bf16_f32 v54, |v54|, |v55|
  buffer_store_dword v54, v12, s[4:7], s15 offen
  s_cmp_lg_u64 exec, -1
  s_mov_b64 exec, -1
  s_barrier
  s_cbranch_scc1 A_sbad
A_sok:
  v_mov_b32 v15, -1
  ds_write2st64_b32 v10, v15, v15 offset0:0 offset1:1
  ds_write2st64_b32 v10, v15, v15 offset0:2 offset1:3
  ds_write2st64_b32 v10, v15, v15 offset0:4 offset1:5
  ds_write2st64_b32 v10, v15, v15 offset0:6 offset1:7
  ds_write2st64_b32 v10, v15, v15 offset0:8 offset1:9
  ds_write2st64_b32 v10, v15, v15 offset0:10 offset1:11
  s_waitcnt lgkmcnt(0)
  s_branch A_next
A_sbad:
  s_add_u32 s98, s98, 0x10000
  s_nop 4
  ds_read2st64_b32 v[54:55], v10 offset0:2 offset1:5
  ds_read2st64_b32 v[58:59], v10 offset0:8 offset1:11
  ds_read2st64_b32 v[60:61], v10 offset0:0 offset1:1
  ds_read2st64_b32 v[62:63], v10 offset0:3 offset1:4
  ds_read2st64_b32 v[64:65], v10 offset0:6 offset1:7
  ds_read2st64_b32 v[66:67], v10 offset0:9 offset1:10
  s_waitcnt lgkmcnt(4)
  v_pk_add_f32 v[54:55], v[54:55], v[58:59]
  s_waitcnt lgkmcnt(2)
  v_add_f32 v54, v54, v55
  v_pk_add_f32 v[60:61], v[60:61], v[62:63]
  s_waitcnt lgkmcnt(0)
  v_pk_add_f32 v[64:65], v[64:65], v[66:67]
  v_add_f32_dpp v54, v54, v54 row_ror:8 row_mask:0xf bank_mask:0xf
  v_pk_add_f32 v[52:53], v[60:61], v[64:65]
  v_max3_f32 v56, v52, v53, v54
  s_nop 1
  v_max_f32_dpp v56, v56, v56 row_ror:1 row_mask:0xf bank_mask:0xf
  s_nop 1
  v_max_f32_dpp v56, v56, v56 row_ror:2 row_mask:0xf bank_mask:0xf
  s_nop 1
  v_max_f32_dpp v56, v56, v56 row_ror:4 row_mask:0xf bank_mask:0xf
  s_nop 1
  v_max_f32_dpp v56, v56, v56 row_ror:8 row_mask:0xf bank_mask:0xf
  v_sub_f32 v54, v54, v56
  v_pk_add_f32 v[52:53], v[52:53], v[56:57] op_sel_hi:[1,0] neg_lo:[0,1] neg_hi:[0,1]
  v_exp_f32 v54, v54
  v_exp_f32 v52, v52
  v_exp_f32 v53, v53
  v_fma_f32 v56, v54, 0.5, v52
  v_add_f32 v56, v56, v53
  v_mov_b32_dpp v55, v54 row_ror:12 row_mask:0xf bank_mask:0xf
  s_nop 0
  v_add_f32_dpp v56, v56, v56 row_ror:1 row_mask:0xf bank_mask:0xf
  s_nop 1
  v_add_f32_dpp v56, v56, v56 row_ror:2 row_mask:0xf bank_mask:0xf
  s_nop 1
  v_add_f32_dpp v56, v56, v56 row_ror:4 row_mask:0xf bank_mask:0xf
  s_nop 1
  v_add_f32_dpp v56, v56, v56 row_ror:8 row_mask:0xf bank_mask:0xf
  v_rcp_f32 v58, v56
  s_nop 0
  v_pk_mul_f32 v[52:53], v[52:53], v[58:59] op_sel_hi:[1,0]
  v_cvt_pk_bf16_f32 v52, |v52|, |v53|
  v_pk_mul_f32 v[54:55], v[54:55], v[58:59] op_sel_hi:[1,0]
  buffer_store_dword v52, v11, s[4:7], s15 offen
  v_cvt_pk_bf16_f32 v54, |v54|, |v55|
  buffer_store_dword v54, v12, s[4:7], s15 offen
  s_branch A_sok
A_other:
  s_waitcnt lgkmcnt(0)
  s_barrier
A_next:
  buffer_load_dwordx4 v[96:99], v4, s[4:7], s12 offen offset:256 sc1
  buffer_load_dwordx4 v[100:103], v4, s[4:7], s12 offen offset:2304 sc1
  buffer_load_dwordx4 v[104:107], v5, s[4:7], s12 offen offset:256 sc1
  buffer_load_dwordx4 v[108:111], v6, s[4:7], s12 offen offset:256 sc1
  s_waitcnt vmcnt(4)
  ds_read_b128 v[80:83], v17 offset:0
  ds_read_b128 v[84:87], v17 offset:1024
  ds_read_b128 v[88:91], v17 offset:2048
  ds_read_b128 v[92:95], v17 offset:3072
  s_add_u32 s40, s40, 57344
  s_add_u32 s41, s41, 57344
  s_add_u32 s42, s42, 57344
  s_add_u32 s43, s43, 57344
  s_add_u32 s44, s44, 57344
  s_add_u32 s45, s45, 57344
  s_add_u32 s46, s46, 57344
  s_add_u32 s14, s14, 57344
  s_add_u32 s15, s15, 10240
  s_add_u32 s16, s16, 1
  s_cmp_le_u32 s16, 63
  s_cbranch_scc1 A_loop
  s_branch RDONE
A_xbad:
  buffer_load_dwordx4 v[80:83], v4, s[4:7], s12 offen offset:0 sc1
  buffer_load_dwordx4 v[84:87], v4, s[4:7], s12 offen offset:2048 sc1
  buffer_load_dwordx4 v[88:91], v5, s[4:7], s12 offen offset:0 sc1
  buffer_load_dwordx4 v[92:95], v6, s[4:7], s12 offen offset:0 sc1
  buffer_load_dwordx4 v[96:99], v4, s[4:7], s12 offen offset:256 sc1
  buffer_load_dwordx4 v[100:103], v4, s[4:7], s12 offen offset:2304 sc1
  buffer_load_dwordx4 v[104:107], v5, s[4:7], s12 offen offset:256 sc1
  buffer_load_dwordx4 v[108:111], v6, s[4:7], s12 offen offset:256 sc1
  s_sub_u32 s99, s99, 1
  s_cbranch_scc1 FAIL
  s_branch A_xchk
A_bad:
  s_cmp_eq_u32 s22, s16
  s_cbranch_scc1 A_ok
  s_add_u32 s98, s98, 1
A_bad1:
  buffer_load_dwordx4 v[24:27], v1, s[4:7], s40 offen sc1
  buffer_load_dwordx4 v[28:31], v1, s[4:7], s41 offen sc1
  buffer_load_dwordx4 v[32:35], v1, s[4:7], s42 offen sc1
  buffer_load_dwordx4 v[36:39], v1, s[4:7], s43 offen sc1
  buffer_load_dwordx4 v[40:43], v1, s[4:7], s44 offen sc1
  buffer_load_dwordx4 v[44:47], v1, s[4:7], s45 offen sc1
  buffer_load_dwordx4 v[48:51], v1, s[4:7], s46 offen sc1
  buffer_load_dwordx4 v[112:115], v2, s[4:7], s14 offen sc1
  buffer_load_dwordx4 v[116:119], v3, s[4:7], s14 offen sc1
  s_sub_u32 s99, s99, 1
  s_cbranch_scc1 FAIL
  s_waitcnt vmcnt(0)
  v_max3_u32 v15, v24, v25, v26
  v_max3_u32 v15, v15, v27, v28
  v_max3_u32 v15, v15, v29, v30
  v_max3_u32 v15, v15, v31, v32
  v_max3_u32 v15, v15, v33, v34
  v_max3_u32 v15, v15, v35, v36
  v_max3_u32 v15, v15, v37, v38
  v_max3_u32 v15, v15, v39, v40
  v_max3_u32 v15, v15, v41, v42
  v_max3_u32 v15, v15, v43, v44
  v_max3_u32 v15, v15, v45, v46
  v_max3_u32 v15, v15, v47, v48
  v_max3_u32 v15, v15, v49, v50
  v_max3_u32 v15, v15, v51, v112
  v_max3_u32 v15, v15, v113, v114
  v_max3_u32 v15, v15, v115, v116
  v_max3_u32 v15, v15, v117, v118
  v_max_u32 v15, v15, v119
  v_cmp_eq_u32 vcc, -1, v15
  s_cbranch_vccnz A_bad1
  s_mov_b32 s22, s16
  v_mov_b64 v[52:53], 0
  v_mov_b64 v[54:55], 0
  v_mov_b64 v[56:57], 0
  v_mov_b64 v[58:59], 0
  v_mov_b64 v[60:61], 0
  v_mov_b64 v[62:63], 0
  v_mov_b64 v[64:65], 0
  v_mov_b64 v[66:67], 0
  v_mov_b64 v[68:69], 0
  v_mov_b64 v[70:71], 0
  v_mov_b64 v[72:73], 0
  v_mov_b64 v[74:75], 0
  v_mov_b64 v[76:77], 0
  v_mov_b64 v[78:79], 0
  s_branch A_retry
K1_rb:
  v_and_b32 v11, 63, v0
  v_lshlrev_b32 v1, 4, v11
  s_lshr_b32 s101, s10, 1
  s_lshl_b32 s101, s101, 11
  s_add_u32 s101, s101, 18921472
  v_mbcnt_lo_u32_b32 v45, -1, 0
  v_mbcnt_hi_u32_b32 v45, -1, v45
  s_cmp_lg_u32 s8, 0
  s_cbranch_scc1 wcd_96
  v_min_u32 v45, 15, v45
  v_lshlrev_b32 v45, 7, v45
  s_branch wc_95x
wc_95:
  s_sleep 2
wc_95x:
  buffer_load_dword v44, v45, s[4:7], s101 offen sc1
  s_sub_u32 s99, s99, 1
  s_cbranch_scc1 FAIL
  s_waitcnt vmcnt(0)
  v_cmp_eq_u32 vcc, 0, v44
  s_cbranch_vccnz wc_95
wcd_96:
  s_barrier
  s_cmp_lt_i32 s97, 0
  s_cbranch_scc1 nf_97
  s_mov_b32 s101, 18907136
  v_mbcnt_lo_u32_b32 v45, -1, 0
  v_mbcnt_hi_u32_b32 v45, -1, v45
  s_lshl_b32 s100, s8, 6
  v_add_u32 v45, s100, v45
  v_min_u32 v45, 255, v45
  v_lshlrev_b32 v45, 7, v45
  s_branch wc_98x
wc_98:
  s_sleep 2
wc_98x:
  buffer_load_dword v44, v45, s[4:7], s101 offen sc1
  s_sub_u32 s99, s99, 1
  s_cbranch_scc1 FAIL
  s_waitcnt vmcnt(0)
  v_cmp_eq_u32 vcc, 0, v44
  s_cbranch_vccnz wc_98
wcd_99:
  s_barrier
  v_mov_b32 v44, -1
  v_mov_b32 v45, -1
  v_mov_b32 v46, -1
  v_mov_b32 v47, -1
  s_lshl_b32 s100, s97, 2
  s_add_u32 s100, s100, s8
  s_lshl_b32 s100, s100, 10
  s_add_u32 s100, s100, 29753344
fl_100:
  s_cmp_ge_u32 s100, 32505856
  s_cbranch_scc1 fd_101
  buffer_store_dwordx4 v[44:47], v1, s[4:7], s100 offen sc1
  s_add_u32 s100, s100, 360448
  s_branch fl_100
fd_101:
  s_add_u32 s100, s100, 458752
fl_102:
  s_cmp_ge_u32 s100, 34340864
  s_cbranch_scc1 fd_103
  buffer_store_dwordx4 v[44:47], v1, s[4:7], s100 offen sc1
  s_add_u32 s100, s100, 360448
  s_branch fl_102
fd_103:
  s_add_u32 s100, s100, 458752
fl_104:
  s_cmp_ge_u32 s100, 36175872
  s_cbranch_scc1 fd_105
  buffer_store_dwordx4 v[44:47], v1, s[4:7], s100 offen sc1
  s_add_u32 s100, s100, 360448
  s_branch fl_104
fd_105:
  s_add_u32 s100, s100, 458752
fl_106:
  s_cmp_ge_u32 s100, 38010880
  s_cbranch_scc1 fd_107
  buffer_store_dwordx4 v[44:47], v1, s[4:7], s100 offen sc1
  s_add_u32 s100, s100, 360448
  s_branch fl_106
fd_107:
  s_add_u32 s100, s100, 458752
fl_108:
  s_cmp_ge_u32 s100, 39845888
  s_cbranch_scc1 fd_109
  buffer_store_dwordx4 v[44:47], v1, s[4:7], s100 offen sc1
  s_add_u32 s100, s100, 360448
  s_branch fl_108
fd_109:
  s_add_u32 s100, s100, 655360
fl_110:
  s_cmp_ge_u32 s100, 42467328
  s_cbranch_scc1 fd_111
  buffer_store_dwordx4 v[44:47], v1, s[4:7], s100 offen sc1
  s_add_u32 s100, s100, 360448
  s_branch fl_110
fd_111:
  s_add_u32 s100, s100, 655360
fl_112:
  s_cmp_ge_u32 s100, 45088768
  s_cbranch_scc1 fd_113
  buffer_store_dwordx4 v[44:47], v1, s[4:7], s100 offen sc1
  s_add_u32 s100, s100, 360448
  s_branch fl_112
fd_113:
  s_add_u32 s100, s100, 163840
fl_114:
  s_cmp_ge_u32 s100, 45744128
  s_cbranch_scc1 fd_115
  buffer_store_dwordx4 v[44:47], v1, s[4:7], s100 offen sc1
  s_add_u32 s100, s100, 360448
  s_branch fl_114
fd_115:
  s_add_u32 s100, s100, 163840
fl_116:
  s_cmp_ge_u32 s100, 46399488
  s_cbranch_scc1 fd_117
  buffer_store_dwordx4 v[44:47], v1, s[4:7], s100 offen sc1
  s_add_u32 s100, s100, 360448
  s_branch fl_116
fd_117:
  s_waitcnt vmcnt(0)
  s_barrier
  s_cmp_lg_u32 s8, 0
  s_cbranch_scc1 arr_118
  v_mov_b32 v44, 1
  s_mov_b64 exec, 1
  s_mov_b32 s100, 18903040
  buffer_atomic_add v44, off, s[4:7], s100 sc0
  s_waitcnt vmcnt(0)
  v_readfirstlane_b32 s100, v44
  s_cmp_lg_u32 s100, 87
  s_cbranch_scc1 arr_118x
  s_mov_b32 s100, 18903424
  s_nop 1
  buffer_store_dword v44, off, s[4:7], s100 sc1
arr_118x:
  s_mov_b64 exec, -1
arr_118:
nf_97:
  s_lshl_b32 s19, s10, 2
  s_add_u32 s19, s19, s8
  s_mul_i32 s19, s19, 114688
  s_add_u32 s19, s19, 7340032
  buffer_load_dwordx4 a[0:3], v1, s[4:7], s19 offen offset:0
  buffer_load_dwordx4 a[4:7], v1, s[4:7], s19 offen offset:1024
  buffer_load_dwordx4 a[8:11], v1, s[4:7], s19 offen offset:2048
  buffer_load_dwordx4 a[12:15], v1, s[4:7], s19 offen offset:3072
  s_add_u32 s19, s19, 4096
  buffer_load_dwordx4 a[16:19], v1, s[4:7], s19 offen offset:0
  buffer_load_dwordx4 a[20:23], v1, s[4:7], s19 offen offset:1024
  buffer_load_dwordx4 a[24:27], v1, s[4:7], s19 offen offset:2048
  buffer_load_dwordx4 a[28:31], v1, s[4:7], s19 offen offset:3072
  s_add_u32 s19, s19, 4096
  buffer_load_dwordx4 a[32:35], v1, s[4:7], s19 offen offset:0
  buffer_load_dwordx4 a[36:39], v1, s[4:7], s19 offen offset:1024
  buffer_load_dwordx4 a[40:43], v1, s[4:7], s19 offen offset:2048
  buffer_load_dwordx4 a[44:47], v1, s[4:7], s19 offen offset:3072
  s_add_u32 s19, s19, 4096
  buffer_load_dwordx4 a[48:51], v1, s[4:7], s19 offen offset:0
  buffer_load_dwordx4 a[52:55], v1, s[4:7], s19 offen offset:1024
  buffer_load_dwordx4 a[56:59], v1, s[4:7], s19 offen offset:2048
  buffer_load_dwordx4 a[60:63], v1, s[4:7], s19 offen offset:3072
  s_add_u32 s19, s19, 4096
  buffer_load_dwordx4 a[64:67], v1, s[4:7], s19 offen offset:0
  buffer_load_dwordx4 a[68:71], v1, s[4:7], s19 offen offset:1024
  buffer_load_dwordx4 a[72:75], v1, s[4:7], s19 offen offset:2048
  buffer_load_dwordx4 a[76:79], v1, s[4:7], s19 offen offset:3072
  s_add_u32 s19, s19, 4096
  buffer_load_dwordx4 a[80:83], v1, s[4:7], s19 offen offset:0
  buffer_load_dwordx4 a[84:87], v1, s[4:7], s19 offen offset:1024
  buffer_load_dwordx4 a[88:91], v1, s[4:7], s19 offen offset:2048
  buffer_load_dwordx4 a[92:95], v1, s[4:7], s19 offen offset:3072
  s_add_u32 s19, s19, 4096
  buffer_load_dwordx4 a[96:99], v1, s[4:7], s19 offen offset:0
  buffer_load_dwordx4 a[100:103], v1, s[4:7], s19 offen offset:1024
  buffer_load_dwordx4 a[104:107], v1, s[4:7], s19 offen offset:2048
  buffer_load_dwordx4 a[108:111], v1, s[4:7], s19 offen offset:3072
  s_add_u32 s19, s19, 4096
  buffer_load_dwordx4 a[112:115], v1, s[4:7], s19 offen offset:0
  buffer_load_dwordx4 a[116:119], v1, s[4:7], s19 offen offset:1024
  buffer_load_dwordx4 a[120:123], v1, s[4:7], s19 offen offset:2048
  buffer_load_dwordx4 a[124:127], v1, s[4:7], s19 offen offset:3072
  s_add_u32 s19, s19, 4096
  buffer_load_dwordx4 a[128:131], v1, s[4:7], s19 offen offset:0
  buffer_load_dwordx4 a[132:135], v1, s[4:7], s19 offen offset:1024
  buffer_load_dwordx4 a[136:139], v1, s[4:7], s19 offen offset:2048
  buffer_load_dwordx4 a[140:143], v1, s[4:7], s19 offen offset:3072
  s_add_u32 s19, s19, 4096
  buffer_load_dwordx4 a[144:147], v1, s[4:7], s19 offen offset:0
  buffer_load_dwordx4 a[148:151], v1, s[4:7], s19 offen offset:1024
  buffer_load_dwordx4 a[152:155], v1, s[4:7], s19 offen offset:2048
  buffer_load_dwordx4 a[156:159], v1, s[4:7], s19 offen offset:3072
  s_add_u32 s19, s19, 4096
  buffer_load_dwordx4 a[160:163], v1, s[4:7], s19 offen offset:0
  buffer_load_dwordx4 a[164:167], v1, s[4:7], s19 offen offset:1024
  buffer_load_dwordx4 a[168:171], v1, s[4:7], s19 offen offset:2048
  buffer_load_dwordx4 a[172:175], v1, s[4:7], s19 offen offset:3072
  s_add_u32 s19, s19, 4096
  buffer_load_dwordx4 a[176:179], v1, s[4:7], s19 offen offset:0
  buffer_load_dwordx4 a[180:183], v1, s[4:7], s19 offen offset:1024
  buffer_load_dwordx4 a[184:187], v1, s[4:7], s19 offen offset:2048
  buffer_load_dwordx4 a[188:191], v1, s[4:7], s19 offen offset:3072
  s_add_u32 s19, s19, 4096
  buffer_load_dwordx4 a[192:195], v1, s[4:7], s19 offen offset:0
  buffer_load_dwordx4 a[196:199], v1, s[4:7], s19 offen offset:1024
  buffer_load_dwordx4 a[200:203], v1, s[4:7], s19 offen offset:2048
  buffer_load_dwordx4 a[204:207], v1, s[4:7], s19 offen offset:3072
  s_add_u32 s19, s19, 4096
  buffer_load_dwordx4 a[208:211], v1, s[4:7], s19 offen offset:0
  buffer_load_dwordx4 a[212:215], v1, s[4:7], s19 offen offset:1024
  buffer_load_dwordx4 a[216:219], v1, s[4:7], s19 offen offset:2048
  buffer_load_dwordx4 a[220:223], v1, s[4:7], s19 offen offset:3072
  s_add_u32 s19, s19, 4096
  buffer_load_dwordx4 a[224:227], v1, s[4:7], s19 offen offset:0
  buffer_load_dwordx4 a[228:231], v1, s[4:7], s19 offen offset:1024
  buffer_load_dwordx4 a[232:235], v1, s[4:7], s19 offen offset:2048
  buffer_load_dwordx4 a[236:239], v1, s[4:7], s19 offen offset:3072
  s_add_u32 s19, s19, 4096
  buffer_load_dwordx4 a[240:243], v1, s[4:7], s19 offen offset:0
  buffer_load_dwordx4 a[244:247], v1, s[4:7], s19 offen offset:1024
  buffer_load_dwordx4 a[248:251], v1, s[4:7], s19 offen offset:2048
  buffer_load_dwordx4 a[252:255], v1, s[4:7], s19 offen offset:3072
  s_add_u32 s19, s19, 4096
  buffer_load_dwordx4 v[120:123], v1, s[4:7], s19 offen offset:0
  buffer_load_dwordx4 v[124:127], v1, s[4:7], s19 offen offset:1024
  buffer_load_dwordx4 v[128:131], v1, s[4:7], s19 offen offset:2048
  buffer_load_dwordx4 v[132:135], v1, s[4:7], s19 offen offset:3072
  s_add_u32 s19, s19, 4096
  buffer_load_dwordx4 v[136:139], v1, s[4:7], s19 offen offset:0
  buffer_load_dwordx4 v[140:143], v1, s[4:7], s19 offen offset:1024
  buffer_load_dwordx4 v[144:147], v1, s[4:7], s19 offen offset:2048
  buffer_load_dwordx4 v[148:151], v1, s[4:7], s19 offen offset:3072
  s_add_u32 s19, s19, 4096
  buffer_load_dwordx4 v[152:155], v1, s[4:7], s19 offen offset:0
  buffer_load_dwordx4 v[156:159], v1, s[4:7], s19 offen offset:1024
  buffer_load_dwordx4 v[160:163], v1, s[4:7], s19 offen offset:2048
  buffer_load_dwordx4 v[164:167], v1, s[4:7], s19 offen offset:3072
  s_add_u32 s19, s19, 4096
  buffer_load_dwordx4 v[168:171], v1, s[4:7], s19 offen offset:0
  buffer_load_dwordx4 v[172:175], v1, s[4:7], s19 offen offset:1024
  buffer_load_dwordx4 v[176:179], v1, s[4:7], s19 offen offset:2048
  buffer_load_dwordx4 v[180:183], v1, s[4:7], s19 offen offset:3072
  s_add_u32 s19, s19, 4096
  buffer_load_dwordx4 v[184:187], v1, s[4:7], s19 offen offset:0
  buffer_load_dwordx4 v[188:191], v1, s[4:7], s19 offen offset:1024
  buffer_load_dwordx4 v[192:195], v1, s[4:7], s19 offen offset:2048
  buffer_load_dwordx4 v[196:199], v1, s[4:7], s19 offen offset:3072
  s_add_u32 s19, s19, 4096
  buffer_load_dwordx4 v[200:203], v1, s[4:7], s19 offen offset:0
  buffer_load_dwordx4 v[204:207], v1, s[4:7], s19 offen offset:1024
  buffer_load_dwordx4 v[208:211], v1, s[4:7], s19 offen offset:2048
  buffer_load_dwordx4 v[212:215], v1, s[4:7], s19 offen offset:3072
  s_add_u32 s19, s19, 4096
  buffer_load_dwordx4 v[216:219], v1, s[4:7], s19 offen offset:0
  buffer_load_dwordx4 v[220:223], v1, s[4:7], s19 offen offset:1024
  buffer_load_dwordx4 v[224:227], v1, s[4:7], s19 offen offset:2048
  buffer_load_dwordx4 v[228:231], v1, s[4:7], s19 offen offset:3072
  s_add_u32 s19, s19, 4096
  buffer_load_dwordx4 v[232:235], v1, s[4:7], s19 offen offset:0
  buffer_load_dwordx4 v[236:239], v1, s[4:7], s19 offen offset:1024
  buffer_load_dwordx4 v[240:243], v1, s[4:7], s19 offen offset:2048
  buffer_load_dwordx4 v[244:247], v1, s[4:7], s19 offen offset:3072
  s_add_u32 s19, s19, 4096
  buffer_load_dwordx4 v[248:251], v1, s[4:7], s19 offen offset:0
  buffer_load_dwordx4 v[252:255], v1, s[4:7], s19 offen offset:1024
  s_add_u32 s19, s19, 2048
  s_mul_i32 s20, s8, 14336
  s_add_u32 m0, s20, 0
  s_nop 0
  buffer_load_dwordx4 v1, s[4:7], s19 offen lds
  s_add_u32 s19, s19, 1024
  s_add_u32 m0, s20, 1024
  s_nop 0
  buffer_load_dwordx4 v1, s[4:7], s19 offen lds
  s_add_u32 s19, s19, 1024
  s_add_u32 m0, s20, 2048
  s_nop 0
  buffer_load_dwordx4 v1, s[4:7], s19 offen lds
  s_add_u32 s19, s19, 1024
  s_add_u32 m0, s20, 3072
  s_nop 0
  buffer_load_dwordx4 v1, s[4:7], s19 offen lds
  s_add_u32 s19, s19, 1024
  s_add_u32 m0, s20, 4096
  s_nop 0
  buffer_load_dwordx4 v1, s[4:7], s19 offen lds
  s_add_u32 s19, s19, 1024
  s_add_u32 m0, s20, 5120
  s_nop 0
  buffer_load_dwordx4 v1, s[4:7], s19 offen lds
  s_add_u32 s19, s19, 1024
  s_add_u32 m0, s20, 6144
  s_nop 0
  buffer_load_dwordx4 v1, s[4:7], s19 offen lds
  s_add_u32 s19, s19, 1024
  s_add_u32 m0, s20, 7168
  s_nop 0
  buffer_load_dwordx4 v1, s[4:7], s19 offen lds
  s_add_u32 s19, s19, 1024
  s_add_u32 m0, s20, 8192
  s_nop 0
  buffer_load_dwordx4 v1, s[4:7], s19 offen lds
  s_add_u32 s19, s19, 1024
  s_add_u32 m0, s20, 9216
  s_nop 0
  buffer_load_dwordx4 v1, s[4:7], s19 offen lds
  s_add_u32 s19, s19, 1024
  s_add_u32 m0, s20, 10240
  s_nop 0
  buffer_load_dwordx4 v1, s[4:7], s19 offen lds
  s_add_u32 s19, s19, 1024
  s_add_u32 m0, s20, 11264
  s_nop 0
  buffer_load_dwordx4 v1, s[4:7], s19 offen lds
  s_add_u32 s19, s19, 1024
  s_add_u32 m0, s20, 12288
  s_nop 0
  buffer_load_dwordx4 v1, s[4:7], s19 offen lds
  s_add_u32 s19, s19, 1024
  s_add_u32 m0, s20, 13312
  s_nop 0
  buffer_load_dwordx4 v1, s[4:7], s19 offen lds
  s_add_u32 s19, s19, 1024
  v_add_u32 v12, s20, v1
  s_mov_b32 vcc_lo, 0xaaaaaaaa
  s_mov_b32 vcc_hi, 0xaaaaaaaa
  v_mov_b32 v3, 0x44444444
  v_mov_b32 v44, 0xeeeeeeee
  v_cndmask_b32 v3, v3, v44, vcc
  v_lshlrev_b32 v5, 2, v11
  s_lshl_b32 s19, s8, 9
  s_add_u32 s19, s19, 65536
  v_add_u32 v4, s19, v5
  v_mov_b32 v5, 0x10000
  v_bfe_u32 v44, v11, 0, 1
  s_mov_b32 s100, 0x100
  v_mul_lo_u32 v44, v44, s100
  v_add_u32 v5, v5, v44
  v_bfe_u32 v44, v11, 1, 1
  s_mov_b32 s100, 0x10
  v_mul_lo_u32 v44, v44, s100
  v_add_u32 v5, v5, v44
  v_bfe_u32 v44, v11, 2, 1
  s_mov_b32 s100, 0x8
  v_mul_lo_u32 v44, v44, s100
  v_add_u32 v5, v5, v44
  v_bfe_u32 v44, v11, 3, 1
  s_mov_b32 s100, 0x800
  v_mul_lo_u32 v44, v44, s100
  v_add_u32 v5, v5, v44
  v_bfe_u32 v44, v11, 4, 2
  s_mov_b32 s100, 0x40
  v_mul_lo_u32 v44, v44, s100
  v_add_u32 v5, v5, v44
  s_and_b32 s19, s8, 1
  s_lshl_b32 s20, s19, 5
  v_add_u32 v5, s20, v5
  v_mov_b32 v7, 0x0
  v_bfe_u32 v44, v11, 0, 1
  s_mov_b32 s100, 0x8
  v_mul_lo_u32 v44, v44, s100
  v_add_u32 v7, v7, v44
  v_bfe_u32 v44, v11, 1, 1
  s_mov_b32 s100, 0x80
  v_mul_lo_u32 v44, v44, s100
  v_add_u32 v7, v7, v44
  v_bfe_u32 v44, v11, 2, 1
  s_mov_b32 s100, 0x4
  v_mul_lo_u32 v44, v44, s100
  v_add_u32 v7, v7, v44
  v_bfe_u32 v44, v11, 3, 3
  s_mov_b32 s100, 0x10
  v_mul_lo_u32 v44, v44, s100
  v_add_u32 v7, v7, v44
  s_lshl_b32 s20, s10, 1
  s_add_u32 s20, s20, s19
  s_lshl_b32 s20, s20, 8
  v_add_u32 v7, s20, v7
  v_lshl_add_u32 v6, v11, 2, s20
  v_lshlrev_b32 v2, 3, v11
  s_and_b32 s19, s10, 7
  s_lshl_b32 s19, s19, 8
  v_min_u32 v8, 31, v11
  v_lshl_add_u32 v8, v8, 2, s19
  v_min_u32 v109, 56, v11
  v_lshl_add_u32 v109, v109, 2, s19
  v_mov_b32 v9, 0x0
  v_bfe_u32 v44, v11, 0, 3
  s_mov_b32 s100, 0x100
  v_mul_lo_u32 v44, v44, s100
  v_add_u32 v9, v9, v44
  v_mov_b32 v45, 0x7ff00000
  v_and_b32 v44, 32, v11
  v_cmp_ne_u32 vcc, 0, v44
  s_nop 1
  v_cndmask_b32 v9, v9, v45, vcc
  v_mov_b32 v45, 0x7ff00000
  v_and_b32 v44, 16, v11
  v_cmp_ne_u32 vcc, 0, v44
  s_nop 1
  v_cndmask_b32 v9, v9, v45, vcc
  v_mov_b32 v45, 0x7ff00000
  v_and_b32 v44, 8, v11
  v_cmp_ne_u32 vcc, 0, v44
  s_nop 1
  v_cndmask_b32 v9, v9, v45, vcc
  s_lshl_b32 s19, s10, 2
  s_add_u32 s19, s19, s8
  s_lshl_b32 s19, s19, 2
  v_add_u32 v9, s19, v9
  s_mul_i32 s19, s11, 28672
  s_add_u32 s13, s19, 28835840
  s_add_u32 s14, s13, 7168
  s_mul_i32 s19, s11, 655360
  s_add_u32 s15, s19, 45088768
  s_mul_i32 s19, s8, 2560
  s_add_u32 s15, s15, s19
  s_lshl_b32 s19, s11, 13
  s_add_u32 s18, s19, 18874368
  s_add_u32 s17, s18, 4096
  s_mul_i32 s12, s11, 33554432
  s_add_u32 s12, s12, 67108864
  s_lshl_b32 s19, s10, 2
  s_add_u32 s19, s19, s8
  s_lshl_b32 s19, s19, 13
  s_add_u32 s12, s12, s19
  s_mov_b32 s16, 1
  s_mov_b32 s101, 18907136
  v_mbcnt_lo_u32_b32 v45, -1, 0
  v_mbcnt_hi_u32_b32 v45, -1, v45
  s_lshl_b32 s100, s8, 6
  v_add_u32 v45, s100, v45
  v_min_u32 v45, 255, v45
  v_lshlrev_b32 v45, 7, v45
  s_branch wc_119x
wc_119:
  s_sleep 2
wc_119x:
  buffer_load_dword v44, v45, s[4:7], s101 offen sc1
  s_sub_u32 s99, s99, 1
  s_cbranch_scc1 FAIL
  s_waitcnt vmcnt(0)
  v_cmp_eq_u32 vcc, 0, v44
  s_cbranch_vccnz wc_119
wcd_120:
  s_barrier
  s_waitcnt vmcnt(0)
  v_mov_b64 v[76:77], -1
  ds_write2st64_b64 v5, v[76:77], v[76:77] offset0:0 offset1:1
  ds_write2st64_b64 v5, v[76:77], v[76:77] offset0:2 offset1:3
  s_waitcnt lgkmcnt(0)
B_loop:
  s_add_u32 s20, s12, 4096
  s_add_u32 s19, s13, 4096
  s_cmp_lg_u32 s8, 3
  s_cbranch_scc1 B_w012
  s_mov_b32 m0, 57344
  buffer_load_dword v13, v109, s[4:7], s18 offen sc1
  s_nop 7
  buffer_load_dword v14, v109, s[4:7], s18 offen sc1
  s_nop 7
sp_121:
  buffer_load_dword v15, v109, s[4:7], s18 offen sc1
  s_waitcnt vmcnt(2)
  v_cmp_gt_u32 vcc, s16, v13
  s_cbranch_vccz spd_122
  buffer_load_dword v13, v109, s[4:7], s18 offen sc1
  s_waitcnt vmcnt(2)
  v_cmp_gt_u32 vcc, s16, v14
  s_cbranch_vccz spd_122
  buffer_load_dword v14, v109, s[4:7], s18 offen sc1
  s_waitcnt vmcnt(2)
  v_cmp_gt_u32 vcc, s16, v15
  s_cbranch_vccz spd_122
  s_sub_u32 s99, s99, 1
  s_cbranch_scc1 FAIL
  s_branch sp_121
spd_122:
  s_nop 1
  buffer_load_dwordx4 v1, s[4:7], s13 offen offset:0 sc1 lds
  buffer_load_dwordx4 v1, s[4:7], s13 offen offset:1024 sc1 lds
  buffer_load_dwordx4 v1, s[4:7], s13 offen offset:2048 sc1 lds
  buffer_load_dwordx4 v1, s[4:7], s13 offen offset:3072 sc1 lds
  s_mov_b32 m0, 61440
  s_nop 0
  buffer_load_dwordx4 v1, s[4:7], s19 offen offset:0 sc1 lds
  buffer_load_dwordx4 v1, s[4:7], s19 offen offset:1024 sc1 lds
  buffer_load_dwordx4 v1, s[4:7], s19 offen offset:2048 sc1 lds
B_w012:
  s_barrier
  buffer_load_dwordx4 v[44:47], v1, s[4:7], s12 offen offset:0 sc1
  buffer_load_dwordx4 v[48:51], v1, s[4:7], s12 offen offset:1024 sc1
  buffer_load_dwordx4 v[52:55], v1, s[4:7], s12 offen offset:2048 sc1
  buffer_load_dwordx4 v[56:59], v1, s[4:7], s12 offen offset:3072 sc1
  buffer_load_dwordx4 v[60:63], v1, s[4:7], s20 offen offset:0 sc1
  buffer_load_dwordx4 v[64:67], v1, s[4:7], s20 offen offset:1024 sc1
  buffer_load_dwordx4 v[68:71], v1, s[4:7], s20 offen offset:2048 sc1
  buffer_load_dwordx4 v[72:75], v1, s[4:7], s20 offen offset:3072 sc1
  ds_read_b128 v[92:95], v12 offset:0
  ds_read_b128 v[96:99], v12 offset:1024
  ds_read_b128 v[100:103], v12 offset:2048
  ds_read_b128 v[104:107], v12 offset:3072
  v_mov_b64 v[76:77], 0
  v_mov_b64 v[78:79], 0
  v_mov_b64 v[80:81], 0
  v_mov_b64 v[82:83], 0
  v_mov_b64 v[110:111], 0
  v_mov_b64 v[112:113], 0
  s_waitcnt vmcnt(8)
  s_barrier
  ds_read_b128 v[16:19], v1 offset:57344
  ds_read_b128 v[20:23], v1 offset:58368
  ds_read_b128 v[24:27], v1 offset:59392
  ds_read_b128 v[28:31], v1 offset:60416
  ds_read_b128 v[32:35], v1 offset:61440
  ds_read_b128 v[36:39], v1 offset:62464
  ds_read_b128 v[40:43], v1 offset:63488
B_m1:
  s_waitcnt lgkmcnt(6)
  v_smfmac_f32_16x16x64_bf16 v[110:113], v[16:19], v[92:99], v3
  v_smfmac_f32_16x16x64_bf16 v[76:79], v[16:19], a[0:7], v3
  s_waitcnt lgkmcnt(5)
  v_smfmac_f32_16x16x64_bf16 v[76:79], v[20:23], a[8:15], v3
  s_waitcnt lgkmcnt(4)
  v_smfmac_f32_16x16x64_bf16 v[76:79], v[24:27], a[16:23], v3
  s_waitcnt lgkmcnt(3)
  v_smfmac_f32_16x16x64_bf16 v[76:79], v[28:31], a[24:31], v3
  s_waitcnt lgkmcnt(2)
  v_smfmac_f32_16x16x64_bf16 v[76:79], v[32:35], a[32:39], v3
  s_waitcnt lgkmcnt(1)
  v_smfmac_f32_16x16x64_bf16 v[76:79], v[36:39], a[40:47], v3
  ds_read_b128 v[92:95], v12 offset:4096
  s_waitcnt lgkmcnt(1)
  v_smfmac_f32_16x16x64_bf16 v[76:79], v[40:43], a[48:55], v3
  ds_read_b128 v[96:99], v12 offset:5120
  s_waitcnt lgkmcnt(2)
  v_smfmac_f32_16x16x64_bf16 v[110:113], v[20:23], v[100:107], v3
  v_smfmac_f32_16x16x64_bf16 v[80:83], v[16:19], a[56:63], v3
  v_add_f32 v76, v76, v77
  v_smfmac_f32_16x16x64_bf16 v[80:83], v[20:23], a[64:71], v3
  v_add_f32 v78, v78, v79
  v_cmp_u_f32 vcc, v76, v78
  v_smfmac_f32_16x16x64_bf16 v[80:83], v[24:27], a[72:79], v3
  v_cvt_pk_bf16_f32 v84, v76, v78
  v_smfmac_f32_16x16x64_bf16 v[80:83], v[28:31], a[80:87], v3
  v_mov_b64 v[76:77], 0
  v_smfmac_f32_16x16x64_bf16 v[80:83], v[32:35], a[88:95], v3
  v_mov_b64 v[78:79], 0
  v_smfmac_f32_16x16x64_bf16 v[80:83], v[36:39], a[96:103], v3
  ds_read_b128 v[100:103], v12 offset:6144
  v_smfmac_f32_16x16x64_bf16 v[80:83], v[40:43], a[104:111], v3
  ds_read_b128 v[104:107], v12 offset:7168
  s_waitcnt lgkmcnt(2)
  v_smfmac_f32_16x16x64_bf16 v[110:113], v[24:27], v[92:99], v3
  s_cbranch_vccnz B_mbad
B_mok:
  v_smfmac_f32_16x16x64_bf16 v[76:79], v[16:19], a[112:119], v3
  v_add_f32 v80, v80, v81
  v_smfmac_f32_16x16x64_bf16 v[76:79], v[20:23], a[120:127], v3
  v_add_f32 v82, v82, v83
  v_smfmac_f32_16x16x64_bf16 v[76:79], v[24:27], a[128:135], v3
  v_cvt_pk_bf16_f32 v88, v80, v82
  v_smfmac_f32_16x16x64_bf16 v[76:79], v[28:31], a[136:143], v3
  v_mov_b64 v[80:81], 0
  v_smfmac_f32_16x16x64_bf16 v[76:79], v[32:35], a[144:151], v3
  v_mov_b64 v[82:83], 0
  v_smfmac_f32_16x16x64_bf16 v[76:79], v[36:39], a[152:159], v3
  ds_read_b128 v[92:95], v12 offset:8192
  v_smfmac_f32_16x16x64_bf16 v[76:79], v[40:43], a[160:167], v3
  ds_read_b128 v[96:99], v12 offset:9216
  s_waitcnt lgkmcnt(2)
  v_smfmac_f32_16x16x64_bf16 v[110:113], v[28:31], v[100:107], v3
  v_smfmac_f32_16x16x64_bf16 v[80:83], v[16:19], a[168:175], v3
  v_add_f32 v76, v76, v77
  v_smfmac_f32_16x16x64_bf16 v[80:83], v[20:23], a[176:183], v3
  v_add_f32 v78, v78, v79
  v_smfmac_f32_16x16x64_bf16 v[80:83], v[24:27], a[184:191], v3
  v_cvt_pk_bf16_f32 v86, v76, v78
  v_smfmac_f32_16x16x64_bf16 v[80:83], v[28:31], a[192:199], v3
  v_mov_b64 v[76:77], 0
  v_smfmac_f32_16x16x64_bf16 v[80:83], v[32:35], a[200:207], v3
  v_mov_b64 v[78:79], 0
  v_smfmac_f32_16x16x64_bf16 v[80:83], v[36:39], a[208:215], v3
  ds_read_b128 v[100:103], v12 offset:10240
  v_smfmac_f32_16x16x64_bf16 v[80:83], v[40:43], a[216:223], v3
  ds_read_b128 v[104:107], v12 offset:11264
  s_waitcnt lgkmcnt(2)
  v_smfmac_f32_16x16x64_bf16 v[110:113], v[32:35], v[92:99], v3
  v_smfmac_f32_16x16x64_bf16 v[76:79], v[16:19], a[224:231], v3
  v_add_f32 v80, v80, v81
  v_smfmac_f32_16x16x64_bf16 v[76:79], v[20:23], a[232:239], v3
  v_add_f32 v82, v82, v83
  v_smfmac_f32_16x16x64_bf16 v[76:79], v[24:27], a[240:247], v3
  v_cvt_pk_bf16_f32 v90, v80, v82
  v_smfmac_f32_16x16x64_bf16 v[76:79], v[28:31], a[248:255], v3
  v_mov_b64 v[80:81], 0
  v_smfmac_f32_16x16x64_bf16 v[76:79], v[32:35], v[120:127], v3
  v_mov_b64 v[82:83], 0
  v_smfmac_f32_16x16x64_bf16 v[76:79], v[36:39], v[128:135], v3
  ds_read_b128 v[92:95], v12 offset:12288
  v_smfmac_f32_16x16x64_bf16 v[76:79], v[40:43], v[136:143], v3
  ds_read_b128 v[96:99], v12 offset:13312
  s_waitcnt lgkmcnt(2)
  v_smfmac_f32_16x16x64_bf16 v[110:113], v[36:39], v[100:107], v3
  v_smfmac_f32_16x16x64_bf16 v[80:83], v[16:19], v[144:151], v3
  v_add_f32 v76, v76, v77
  v_smfmac_f32_16x16x64_bf16 v[80:83], v[20:23], v[152:159], v3
  v_add_f32 v78, v78, v79
  v_smfmac_f32_16x16x64_bf16 v[80:83], v[24:27], v[160:167], v3
  v_cvt_pk_bf16_f32 v85, v76, v78
  v_smfmac_f32_16x16x64_bf16 v[80:83], v[28:31], v[168:175], v3
  v_mov_b64 v[76:77], 0
  v_smfmac_f32_16x16x64_bf16 v[80:83], v[32:35], v[176:183], v3
  v_mov_b64 v[78:79], 0
  v_smfmac_f32_16x16x64_bf16 v[80:83], v[36:39], v[184:191], v3
  v_smfmac_f32_16x16x64_bf16 v[80:83], v[40:43], v[192:199], v3
  s_waitcnt lgkmcnt(0)
  v_smfmac_f32_16x16x64_bf16 v[110:113], v[40:43], v[92:99], v3
  v_smfmac_f32_16x16x64_bf16 v[76:79], v[16:19], v[200:207], v3
  v_add_f32 v80, v80, v81
  v_smfmac_f32_16x16x64_bf16 v[76:79], v[20:23], v[208:215], v3
  v_add_f32 v82, v82, v83
  v_smfmac_f32_16x16x64_bf16 v[76:79], v[24:27], v[216:223], v3
  v_cvt_pk_bf16_f32 v89, v80, v82
  v_smfmac_f32_16x16x64_bf16 v[76:79], v[28:31], v[224:231], v3
  v_mov_b64 v[80:81], 0
  v_smfmac_f32_16x16x64_bf16 v[76:79], v[32:35], v[232:239], v3
  v_mov_b64 v[82:83], 0
  v_smfmac_f32_16x16x64_bf16 v[76:79], v[36:39], v[240:247], v3
  v_smfmac_f32_16x16x64_bf16 v[76:79], v[40:43], v[248:255], v3
  s_add_u32 s13, s13, 57344
  s_add_u32 s14, s14, 57344
  s_cmp_lg_u32 s8, 3
  s_cbranch_scc1 B_go
  buffer_load_dword v13, v8, s[4:7], s17 offen sc1
  s_nop 7
  buffer_load_dword v14, v8, s[4:7], s17 offen sc1
  s_nop 7
  buffer_load_dword v15, v8, s[4:7], s17 offen sc1
  s_nop 7
sp_123:
  buffer_load_dword v0, v8, s[4:7], s17 offen sc1
  s_waitcnt vmcnt(3)
  v_cmp_gt_u32 vcc, s16, v13
  s_cbranch_vccz spd_124
  buffer_load_dword v13, v8, s[4:7], s17 offen sc1
  s_waitcnt vmcnt(3)
  v_cmp_gt_u32 vcc, s16, v14
  s_cbranch_vccz spd_124
  buffer_load_dword v14, v8, s[4:7], s17 offen sc1
  s_waitcnt vmcnt(3)
  v_cmp_gt_u32 vcc, s16, v15
  s_cbranch_vccz spd_124
  buffer_load_dword v15, v8, s[4:7], s17 offen sc1
  s_waitcnt vmcnt(3)
  v_cmp_gt_u32 vcc, s16, v0
  s_cbranch_vccz spd_124
  s_sub_u32 s99, s99, 1
  s_cbranch_scc1 FAIL
  s_branch sp_123
spd_124:
B_go:
  s_barrier
  buffer_load_dwordx4 v[16:19], v1, s[4:7], s15 offen sc1
  s_nop 2
  buffer_load_dwordx4 v[20:23], v1, s[4:7], s15 offen offset:1024 sc1
  s_nop 2
  buffer_load_dwordx2 v[24:25], v2, s[4:7], s15 offen offset:2048 sc1
  v_add_f32 v76, v76, v77
  v_add_f32 v78, v78, v79
  v_cvt_pk_bf16_f32 v87, v76, v78
  v_mov_b64 v[76:77], 0
  v_mov_b64 v[78:79], 0
  v_add_f32 v110, v110, v111
  v_add_f32 v112, v112, v113
  v_cvt_pk_bf16_f32 v91, v110, v112
  s_add_u32 s19, s16, 1
  v_mov_b32 v108, s19
  v_permlane32_swap_b32 v84, v85
  v_permlane32_swap_b32 v86, v87
  v_permlane32_swap_b32 v88, v89
  v_permlane32_swap_b32 v90, v91
  v_permlane16_swap_b32 v84, v86
  v_permlane16_swap_b32 v85, v87
  v_permlane16_swap_b32 v88, v90
  v_permlane16_swap_b32 v89, v91
B_retry:
  s_waitcnt vmcnt(2)
  v_smfmac_f32_16x16x64_bf16 v[76:79], v[16:19], v[44:51], v3
  v_smfmac_f32_16x16x64_bf16 v[80:83], v[16:19], v[52:59], v3
  s_waitcnt vmcnt(1)
  v_smfmac_f32_16x16x64_bf16 v[76:79], v[20:23], v[60:67], v3
  v_smfmac_f32_16x16x64_bf16 v[80:83], v[20:23], v[68:75], v3
  s_waitcnt vmcnt(0)
  s_nop 0
  v_smfmac_f32_16x16x32_bf16 v[76:79], v[24:25], v[84:87], v3
  s_nop 1
  v_smfmac_f32_16x16x32_bf16 v[80:83], v[24:25], v[88:91], v3
  s_nop 3
  v_add_f32 v96, v76, v77
  v_add_f32 v98, v78, v79
  ds_write2st64_b32 v4, v96, v98 offset0:0 offset1:8
  v_cmp_u_f32 vcc, v96, v98
  v_add_f32 v97, v80, v81
  v_add_f32 v99, v82, v83
  ds_write2st64_b32 v4, v97, v99 offset0:1 offset1:9
  s_cbranch_vccnz B_bad
B_ok:
  buffer_store_dword v108, v9, s[4:7], s18 offen
  s_cmp_ge_u32 s8, 2
  s_barrier
  s_cbranch_scc1 B_oth
  ds_read2st64_b64 v[76:79], v5 offset0:0 offset1:1
  ds_read2st64_b64 v[80:83], v5 offset0:2 offset1:3
  s_waitcnt lgkmcnt(1)
  v_pk_add_f32 v[76:77], v[76:77], v[78:79]
  s_waitcnt lgkmcnt(0)
  v_pk_add_f32 v[80:81], v[80:81], v[82:83]
  v_pk_add_f32 v[76:77], v[76:77], v[80:81]
  v_cvt_pk_bf16_f32 v96, v76, v77
  v_cmpx_o_f32 vcc, v76, v77
  buffer_store_dword v96, v6, s[4:7], s13 offen
  buffer_store_dword v96, v7, s[4:7], s14 offen
  s_cmp_lg_u64 exec, -1
  s_mov_b64 exec, -1
  s_barrier
  s_cbranch_scc0 B_fok
  s_add_u32 s98, s98, 0x1000000
  ds_read2st64_b64 v[76:79], v5 offset0:0 offset1:1
  ds_read2st64_b64 v[80:83], v5 offset0:2 offset1:3
  s_waitcnt lgkmcnt(1)
  v_pk_add_f32 v[76:77], v[76:77], v[78:79]
  s_waitcnt lgkmcnt(0)
  v_pk_add_f32 v[80:81], v[80:81], v[82:83]
  v_pk_add_f32 v[76:77], v[76:77], v[80:81]
  v_cvt_pk_bf16_f32 v96, v76, v77
  v_min_u32 v96, -2, v96
  buffer_store_dword v96, v6, s[4:7], s13 offen
  buffer_store_dword v96, v7, s[4:7], s14 offen
B_fok:
  v_mov_b64 v[76:77], -1
  ds_write2st64_b64 v5, v[76:77], v[76:77] offset0:0 offset1:1
  ds_write2st64_b64 v5, v[76:77], v[76:77] offset0:2 offset1:3
  s_waitcnt lgkmcnt(0)
  s_branch B_next
B_oth:
  s_waitcnt lgkmcnt(0)
  s_barrier
B_next:
  s_add_u32 s15, s15, 10240
  s_add_u32 s12, s12, 458752
  s_and_b32 s19, s16, 63
  s_cselect_b32 s19, 0, 29360128
  s_sub_u32 s12, s12, s19
  s_add_u32 s16, s16, 1
  s_cmp_le_u32 s16, 63
  s_cbranch_scc1 B_loop
  s_branch RDONE
B_bad:
  v_max3_u32 v10, v16, v17, v18
  v_max3_u32 v10, v10, v19, v20
  v_max3_u32 v10, v10, v21, v22
  v_max3_u32 v10, v10, v23, v24
  v_max_u32 v10, v10, v25
  v_cmp_eq_u32 vcc, -1, v10
  s_cbranch_vccz B_ok
  s_add_u32 s98, s98, 1
  buffer_load_dwordx4 v[16:19], v1, s[4:7], s15 offen sc1
  s_nop 2
  buffer_load_dwordx4 v[20:23], v1, s[4:7], s15 offen offset:1024 sc1
  s_nop 2
  buffer_load_dwordx2 v[24:25], v2, s[4:7], s15 offen offset:2048 sc1
  v_mov_b64 v[76:77], 0
  v_mov_b64 v[78:79], 0
  v_mov_b64 v[80:81], 0
  v_mov_b64 v[82:83], 0
  s_sub_u32 s99, s99, 1
  s_cbranch_scc1 FAIL
  s_branch B_retry
B_mbad:
  v_max3_u32 v10, v16, v17, v18
  v_max3_u32 v10, v10, v19, v20
  v_max3_u32 v10, v10, v21, v22
  v_max3_u32 v10, v10, v23, v24
  v_max3_u32 v10, v10, v25, v26
  v_max3_u32 v10, v10, v27, v28
  v_max3_u32 v10, v10, v29, v30
  v_max3_u32 v10, v10, v31, v32
  v_max3_u32 v10, v10, v33, v34
  v_max3_u32 v10, v10, v35, v36
  v_max3_u32 v10, v10, v37, v38
  v_max3_u32 v10, v10, v39, v40
  v_max3_u32 v10, v10, v41, v42
  v_max_u32 v10, v10, v43
  v_cmp_eq_u32 vcc, -1, v10
  s_cbranch_vccz B_mok
  s_add_u32 s98, s98, 0x10000
  buffer_load_dwordx4 v[16:19], v1, s[4:7], s13 offen offset:0 sc1
  buffer_load_dwordx4 v[20:23], v1, s[4:7], s13 offen offset:1024 sc1
  buffer_load_dwordx4 v[24:27], v1, s[4:7], s13 offen offset:2048 sc1
  buffer_load_dwordx4 v[28:31], v1, s[4:7], s13 offen offset:3072 sc1
  buffer_load_dwordx4 v[32:35], v1, s[4:7], s19 offen offset:0 sc1
  buffer_load_dwordx4 v[36:39], v1, s[4:7], s19 offen offset:1024 sc1
  buffer_load_dwordx4 v[40:43], v1, s[4:7], s19 offen offset:2048 sc1
  s_waitcnt lgkmcnt(0)
  ds_read_b128 v[92:95], v12 offset:0
  ds_read_b128 v[96:99], v12 offset:1024
  ds_read_b128 v[100:103], v12 offset:2048
  ds_read_b128 v[104:107], v12 offset:3072
  v_mov_b64 v[76:77], 0
  v_mov_b64 v[78:79], 0
  v_mov_b64 v[80:81], 0
  v_mov_b64 v[82:83], 0
  v_mov_b64 v[110:111], 0
  v_mov_b64 v[112:113], 0
  s_sub_u32 s99, s99, 1
  s_cbranch_scc1 FAIL
  s_waitcnt vmcnt(0) lgkmcnt(0)
  s_branch B_m1
K1_rh:
  v_and_b32 v1, 63, v0
  v_lshlrev_b32 v4, 4, v1
  s_mov_b32 s101, 18907136
  v_mbcnt_lo_u32_b32 v11, -1, 0
  v_mbcnt_hi_u32_b32 v11, -1, v11
  s_lshl_b32 s100, s8, 6
  v_add_u32 v11, s100, v11
  v_min_u32 v11, 255, v11
  v_lshlrev_b32 v11, 7, v11
  s_branch wc_125x
wc_125:
  s_sleep 2
wc_125x:
  buffer_load_dword v10, v11, s[4:7], s101 offen sc1
  s_sub_u32 s99, s99, 1
  s_cbranch_scc1 FAIL
  s_waitcnt vmcnt(0)
  v_cmp_eq_u32 vcc, 0, v10
  s_cbranch_vccnz wc_125
wcd_126:
  s_barrier
  s_cmp_lt_i32 s97, 0
  s_cbranch_scc1 nf_127
  s_mov_b32 s101, 18907136
  v_mbcnt_lo_u32_b32 v13, -1, 0
  v_mbcnt_hi_u32_b32 v13, -1, v13
  s_lshl_b32 s100, s8, 6
  v_add_u32 v13, s100, v13
  v_min_u32 v13, 255, v13
  v_lshlrev_b32 v13, 7, v13
  s_branch wc_128x
wc_128:
  s_sleep 2
wc_128x:
  buffer_load_dword v12, v13, s[4:7], s101 offen sc1
  s_sub_u32 s99, s99, 1
  s_cbranch_scc1 FAIL
  s_waitcnt vmcnt(0)
  v_cmp_eq_u32 vcc, 0, v12
  s_cbranch_vccnz wc_128
wcd_129:
  s_barrier
  v_mov_b32 v12, -1
  v_mov_b32 v13, -1
  v_mov_b32 v14, -1
  v_mov_b32 v15, -1
  s_lshl_b32 s100, s97, 2
  s_add_u32 s100, s100, s8
  s_lshl_b32 s100, s100, 10
  s_add_u32 s100, s100, 29753344
fl_130:
  s_cmp_ge_u32 s100, 32505856
  s_cbranch_scc1 fd_131
  buffer_store_dwordx4 v[12:15], v4, s[4:7], s100 offen sc1
  s_add_u32 s100, s100, 360448
  s_branch fl_130
fd_131:
  s_add_u32 s100, s100, 458752
fl_132:
  s_cmp_ge_u32 s100, 34340864
  s_cbranch_scc1 fd_133
  buffer_store_dwordx4 v[12:15], v4, s[4:7], s100 offen sc1
  s_add_u32 s100, s100, 360448
  s_branch fl_132
fd_133:
  s_add_u32 s100, s100, 458752
fl_134:
  s_cmp_ge_u32 s100, 36175872
  s_cbranch_scc1 fd_135
  buffer_store_dwordx4 v[12:15], v4, s[4:7], s100 offen sc1
  s_add_u32 s100, s100, 360448
  s_branch fl_134
fd_135:
  s_add_u32 s100, s100, 458752
fl_136:
  s_cmp_ge_u32 s100, 38010880
  s_cbranch_scc1 fd_137
  buffer_store_dwordx4 v[12:15], v4, s[4:7], s100 offen sc1
  s_add_u32 s100, s100, 360448
  s_branch fl_136
fd_137:
  s_add_u32 s100, s100, 458752
fl_138:
  s_cmp_ge_u32 s100, 39845888
  s_cbranch_scc1 fd_139
  buffer_store_dwordx4 v[12:15], v4, s[4:7], s100 offen sc1
  s_add_u32 s100, s100, 360448
  s_branch fl_138
fd_139:
  s_add_u32 s100, s100, 655360
fl_140:
  s_cmp_ge_u32 s100, 42467328
  s_cbranch_scc1 fd_141
  buffer_store_dwordx4 v[12:15], v4, s[4:7], s100 offen sc1
  s_add_u32 s100, s100, 360448
  s_branch fl_140
fd_141:
  s_add_u32 s100, s100, 655360
fl_142:
  s_cmp_ge_u32 s100, 45088768
  s_cbranch_scc1 fd_143
  buffer_store_dwordx4 v[12:15], v4, s[4:7], s100 offen sc1
  s_add_u32 s100, s100, 360448
  s_branch fl_142
fd_143:
  s_add_u32 s100, s100, 163840
fl_144:
  s_cmp_ge_u32 s100, 45744128
  s_cbranch_scc1 fd_145
  buffer_store_dwordx4 v[12:15], v4, s[4:7], s100 offen sc1
  s_add_u32 s100, s100, 360448
  s_branch fl_144
fd_145:
  s_add_u32 s100, s100, 163840
fl_146:
  s_cmp_ge_u32 s100, 46399488
  s_cbranch_scc1 fd_147
  buffer_store_dwordx4 v[12:15], v4, s[4:7], s100 offen sc1
  s_add_u32 s100, s100, 360448
  s_branch fl_146
fd_147:
  s_waitcnt vmcnt(0)
  s_barrier
  s_cmp_lg_u32 s8, 0
  s_cbranch_scc1 arr_148
  v_mov_b32 v12, 1
  s_mov_b64 exec, 1
  s_mov_b32 s100, 18903040
  buffer_atomic_add v12, off, s[4:7], s100 sc0
  s_waitcnt vmcnt(0)
  v_readfirstlane_b32 s100, v12
  s_cmp_lg_u32 s100, 87
  s_cbranch_scc1 arr_148x
  s_mov_b32 s100, 18903424
  s_nop 1
  buffer_store_dword v12, off, s[4:7], s100 sc1
arr_148x:
  s_mov_b64 exec, -1
arr_148:
nf_127:
  s_lshl_b32 s13, s11, 13
  s_add_u32 s13, s13, 18874368
  s_cmp_eq_u32 s10, 1
  s_cbranch_scc1 H_fwd
  s_cmp_lg_u32 s8, 0
  s_cbranch_scc1 RDONE
  v_min_u32 v2, 55, v1
  v_lshlrev_b32 v2, 7, v2
  s_mul_i32 s14, s11, 7340032
  s_add_u32 s14, s14, 25194496
  v_min_u32 v3, 55, v1
  v_lshlrev_b32 v3, 7, v3
  v_lshlrev_b32 v5, 8, v1
  s_mul_i32 s12, s11, 24576
  s_add_u32 s12, s12, 18956288
  s_mov_b32 s17, s12
  s_add_u32 s18, s12, 24576
  s_mov_b32 s16, 1
H_loop:
  s_cmp_lg_u32 s16, 9
  s_cbranch_scc1 H_l1
  s_mov_b32 s101, 18903424
  v_mbcnt_lo_u32_b32 v15, -1, 0
  v_mbcnt_hi_u32_b32 v15, -1, v15
  s_cmp_lg_u32 s8, 0
  s_cbranch_scc1 wcd_150
  v_min_u32 v15, 0, v15
  v_lshlrev_b32 v15, 7, v15
  s_branch wc_149x
wc_149:
  s_sleep 2
wc_149x:
  buffer_load_dword v14, v15, s[4:7], s101 offen sc1
  s_sub_u32 s99, s99, 1
  s_cbranch_scc1 FAIL
  s_waitcnt vmcnt(0)
  v_cmp_eq_u32 vcc, 0, v14
  s_cbranch_vccnz wc_149
wcd_150:
  s_barrier
H_l1:
  buffer_load_dword v11, v3, s[4:7], s12 offen sc1
  s_sub_u32 s99, s99, 1
  s_cbranch_scc1 FAIL
  s_waitcnt vmcnt(0)
  v_cmp_gt_u32 vcc, s16, v11
  s_cbranch_vccnz H_l1
  v_mov_b32 v12, s16
  s_mov_b64 exec, 255
  buffer_store_dword v12, v5, s[4:7], s13 offen offset:224
  s_mov_b64 exec, -1
  buffer_load_dword v10, v2, s[4:7], s14 offen sc1
  s_add_u32 s14, s14, 7168
  buffer_load_dword v10, v2, s[4:7], s14 offen sc1
  s_add_u32 s14, s14, 7168
  buffer_load_dword v10, v2, s[4:7], s14 offen sc1
  s_add_u32 s14, s14, 7168
  buffer_load_dword v10, v2, s[4:7], s14 offen sc1
  s_add_u32 s14, s14, 7168
  s_add_u32 s12, s12, 8192
  s_cmp_eq_u32 s12, s18
  s_cselect_b32 s12, s17, s12
  s_add_u32 s16, s16, 1
  s_cmp_le_u32 s16, 63
  s_cbranch_scc1 H_loop
  s_branch RDONE
H_fwd:
  v_min_u32 v3, 55, v1
  v_lshlrev_b32 v2, 7, v3
  v_lshlrev_b32 v3, 2, v3
  v_add_u32 v3, 1792, v3
  s_mul_i32 s19, s8, 3584
  v_add_u32 v4, s19, v4
  s_mul_i32 s15, s11, 28672
  s_add_u32 s15, s15, 28893184
  s_mov_b32 s16, 2
  s_mul_i32 s19, s8, 3072
  s_mul_i32 s21, s11, 655360
  s_add_u32 s21, s21, 45088768
  s_add_u32 s21, s21, s19
  s_mov_b32 s22, 10240
  s_cmp_lt_u32 s8, 2
  s_cbranch_scc1 H_t0
  s_sub_u32 s19, s8, 2
  s_mul_i32 s19, s19, 7168
  s_add_u32 s21, s15, s19
  s_mov_b32 s22, 57344
H_t0:
  s_add_u32 s101, s13, 2016
  v_mbcnt_lo_u32_b32 v15, -1, 0
  v_mbcnt_hi_u32_b32 v15, -1, v15
  s_cmp_lg_u32 s8, 0
  s_cbranch_scc1 wcd_152
  v_min_u32 v15, 0, v15
  v_lshlrev_b32 v15, 7, v15
  s_branch wc_151x
wc_151:
  s_sleep 2
wc_151x:
  buffer_load_dword v14, v15, s[4:7], s101 offen sc1
  s_sub_u32 s99, s99, 1
  s_cbranch_scc1 FAIL
  s_waitcnt vmcnt(0)
  v_cmp_eq_u32 vcc, 0, v14
  s_cbranch_vccnz wc_151
wcd_152:
  s_barrier
  buffer_load_dword v10, v2, s[4:7], s21 offen sc1
  s_add_u32 s21, s21, s22
H_f0:
  buffer_load_dword v10, v2, s[4:7], s21 offen sc1
  s_add_u32 s21, s21, s22
  buffer_load_dword v6, v3, s[4:7], s13 offen sc1
  s_nop 7
sp_153:
  buffer_load_dword v7, v3, s[4:7], s13 offen sc1
  s_waitcnt vmcnt(1)
  v_cmp_gt_u32 vcc, s16, v6
  s_cbranch_vccz spd_154
  buffer_load_dword v6, v3, s[4:7], s13 offen sc1
  s_waitcnt vmcnt(1)
  v_cmp_gt_u32 vcc, s16, v7
  s_cbranch_vccz spd_154
  s_sub_u32 s99, s99, 1
  s_cbranch_scc1 FAIL
  s_branch sp_153
spd_154:
  s_nop 7
H_f1:
  buffer_load_dwordx4 v[12:15], v4, s[4:7], s15 offen offset:0 sc1
  buffer_load_dwordx4 v[16:19], v4, s[4:7], s15 offen offset:1024 sc1
  buffer_load_dwordx4 v[20:23], v4, s[4:7], s15 offen offset:2048 sc1
  buffer_load_dwordx4 v[24:27], v4, s[4:7], s15 offen offset:2560 sc1
  s_add_u32 s19, s15, 14336
  s_sub_u32 s99, s99, 1
  s_cbranch_scc1 FAIL
  s_waitcnt vmcnt(0)
  v_max3_u32 v9, v12, v13, v14
  v_max3_u32 v9, v9, v15, v16
  v_max3_u32 v9, v9, v17, v18
  v_max3_u32 v9, v9, v19, v20
  v_max3_u32 v9, v9, v21, v22
  v_max3_u32 v9, v9, v23, v24
  v_max3_u32 v9, v9, v25, v26
  v_max_u32 v9, v9, v27
  v_cmp_eq_u32 vcc, -1, v9
  s_cbranch_vccnz H_f1
  buffer_store_dwordx4 v[12:15], v4, s[4:7], s19 offen offset:0 sc1
  buffer_store_dwordx4 v[16:19], v4, s[4:7], s19 offen offset:1024 sc1
  buffer_store_dwordx4 v[20:23], v4, s[4:7], s19 offen offset:2048 sc1
  s_mov_b32 exec_lo, 0
  buffer_store_dwordx4 v[24:27], v4, s[4:7], s19 offen offset:2560 sc1
  s_mov_b32 exec_lo, -1
  s_barrier
  s_add_u32 s15, s15, 57344
  s_add_u32 s16, s16, 1
  s_cmp_le_u32 s16, 64
  s_cbranch_scc1 H_f0
  s_branch RDONE
K1_rp:
  s_lshr_b32 s23, s10, 3
  s_and_b32 s10, s10, 7
  v_mbcnt_lo_u32_b32 v0, -1, 0
  v_mbcnt_hi_u32_b32 v0, -1, v0
  v_lshlrev_b32 v1, 4, v0
  s_lshr_b32 s19, s8, 1
  s_mul_i32 s19, s19, 7
  s_add_u32 s25, s19, 3
  s_and_b32 s20, s8, 1
  s_lshl_b32 s20, s20, 2
  s_add_u32 s24, s19, s20
  s_load_dwordx2 s[52:53], s[0:1], 64
  s_load_dwordx2 s[56:57], s[0:1], 80
  s_load_dwordx2 s[32:33], s[0:1], 72
  s_load_dwordx2 s[36:37], s[0:1], 88
  s_load_dwordx2 s[28:29], s[0:1], 96
  s_mov_b32 s30, 1835008
  s_mov_b32 s31, 0x20000
  s_mov_b32 s34, 3584
  s_mov_b32 s35, 0x20000
  s_mov_b32 s38, 896
  s_mov_b32 s39, 0x20000
  s_mov_b32 s54, 1605632
  s_mov_b32 s55, 0x20000
  v_cmp_le_u32 vcc, 28, v0
  v_mov_b32 v10, 3136
  s_nop 0
  v_cndmask_b32 v10, 0, v10, vcc
  v_add_u32 v10, v10, v1
  v_mov_b32 v11, 0x0
  v_bfe_u32 v30, v0, 0, 2
  s_mov_b32 s100, 0x8
  v_mul_lo_u32 v30, v30, s100
  v_add_u32 v11, v11, v30
  v_bfe_u32 v30, v0, 2, 1
  s_mov_b32 s100, 0x1c0
  v_mul_lo_u32 v30, v30, s100
  v_add_u32 v11, v11, v30
  v_bfe_u32 v30, v0, 3, 1
  s_mov_b32 s100, 0x3a0
  v_mul_lo_u32 v30, v30, s100
  v_add_u32 v11, v11, v30
  v_bfe_u32 v30, v0, 4, 2
  s_mov_b32 s100, 0xe80
  v_mul_lo_u32 v30, v30, s100
  v_add_u32 v11, v11, v30
  s_lshl_b32 s19, s25, 5
  v_add_u32 v12, s19, v11
  s_lshl_b32 s19, s24, 5
  v_add_u32 v11, s19, v11
  v_mov_b32 v13, 0x0
  v_bfe_u32 v30, v0, 0, 2
  s_mov_b32 s100, 0x10
  v_mul_lo_u32 v30, v30, s100
  v_add_u32 v13, v13, v30
  v_bfe_u32 v30, v0, 2, 4
  s_mov_b32 s100, 0x3a0
  v_mul_lo_u32 v30, v30, s100
  v_add_u32 v13, v13, v30
  v_mov_b32 v14, 0xc0
  v_bfe_u32 v30, v0, 0, 2
  s_mov_b32 s100, 0x8
  v_mul_lo_u32 v30, v30, s100
  v_add_u32 v14, v14, v30
  v_bfe_u32 v30, v0, 2, 4
  s_mov_b32 s100, 0x3a0
  v_mul_lo_u32 v30, v30, s100
  v_add_u32 v14, v14, v30
  s_mul_i32 s19, s8, 224
  v_add_u32 v13, s19, v13
  v_add_u32 v14, s19, v14
  s_waitcnt lgkmcnt(0)
  s_mov_b32 s58, 1605632
  s_mov_b32 s59, 0x20000
  s_mul_i32 s19, s23, 8
  s_add_u32 s19, s19, s10
  s_lshl_b32 s19, s19, 2
  s_add_u32 s19, s19, s8
  s_lshl_b32 s19, s19, 13
  s_add_u32 s20, s19, 1310720
  v_lshlrev_b32 v15, 3, v1
  buffer_load_dword v17, v15, s[52:55], s19 offen
  buffer_load_dword v17, v15, s[52:55], s20 offen
  buffer_load_dword v17, v15, s[56:59], s19 offen
  buffer_load_dword v17, v15, s[56:59], s20 offen
  s_mul_i32 s26, s8, 7168
  s_mul_i32 s19, s10, 448
  s_add_u32 s26, s26, s19
  s_mul_i32 m0, s8, 928
  s_mov_b32 s20, 28
  s_mov_b32 exec_hi, 0xffffff
wl_155:
  buffer_load_dwordx4 v10, s[52:55], s26 offen lds
  s_add_u32 m0, m0, 3712
  s_add_u32 s26, s26, 28672
  s_sub_u32 s20, s20, 1
  s_cmp_lg_u32 s20, 0
  s_cbranch_scc1 wl_155
  s_mov_b32 exec_hi, -1
  s_waitcnt vmcnt(0)
  s_barrier
  v_mov_b32 v15, v11
  v_mov_b32 v16, v12
  ds_read_b64_tr_b16 a[0:1], v15 offset:0
  ds_read_b64_tr_b16 a[2:3], v15 offset:1856
  ds_read_b64_tr_b16 a[56:57], v15 offset:32
  ds_read_b64_tr_b16 a[58:59], v15 offset:1888
  ds_read_b64_tr_b16 a[112:113], v15 offset:64
  ds_read_b64_tr_b16 a[114:115], v15 offset:1920
  ds_read_b64_tr_b16 a[168:169], v16 offset:0
  ds_read_b64_tr_b16 a[170:171], v16 offset:1856
  ds_read_b64_tr_b16 a[4:5], v15 offset:14848
  ds_read_b64_tr_b16 a[6:7], v15 offset:16704
  ds_read_b64_tr_b16 a[60:61], v15 offset:14880
  ds_read_b64_tr_b16 a[62:63], v15 offset:16736
  ds_read_b64_tr_b16 a[116:117], v15 offset:14912
  ds_read_b64_tr_b16 a[118:119], v15 offset:16768
  ds_read_b64_tr_b16 a[172:173], v16 offset:14848
  ds_read_b64_tr_b16 a[174:175], v16 offset:16704
  ds_read_b64_tr_b16 a[8:9], v15 offset:29696
  ds_read_b64_tr_b16 a[10:11], v15 offset:31552
  ds_read_b64_tr_b16 a[64:65], v15 offset:29728
  ds_read_b64_tr_b16 a[66:67], v15 offset:31584
  ds_read_b64_tr_b16 a[120:121], v15 offset:29760
  ds_read_b64_tr_b16 a[122:123], v15 offset:31616
  ds_read_b64_tr_b16 a[176:177], v16 offset:29696
  ds_read_b64_tr_b16 a[178:179], v16 offset:31552
  ds_read_b64_tr_b16 a[12:13], v15 offset:44544
  ds_read_b64_tr_b16 a[14:15], v15 offset:46400
  ds_read_b64_tr_b16 a[68:69], v15 offset:44576
  ds_read_b64_tr_b16 a[70:71], v15 offset:46432
  ds_read_b64_tr_b16 a[124:125], v15 offset:44608
  ds_read_b64_tr_b16 a[126:127], v15 offset:46464
  ds_read_b64_tr_b16 a[180:181], v16 offset:44544
  ds_read_b64_tr_b16 a[182:183], v16 offset:46400
  v_add_u32 v15, 59392, v15
  v_add_u32 v16, 59392, v16
  ds_read_b64_tr_b16 a[16:17], v15 offset:0
  ds_read_b64_tr_b16 a[18:19], v15 offset:1856
  ds_read_b64_tr_b16 a[72:73], v15 offset:32
  ds_read_b64_tr_b16 a[74:75], v15 offset:1888
  ds_read_b64_tr_b16 a[128:129], v15 offset:64
  ds_read_b64_tr_b16 a[130:131], v15 offset:1920
  ds_read_b64_tr_b16 a[184:185], v16 offset:0
  ds_read_b64_tr_b16 a[186:187], v16 offset:1856
  ds_read_b64_tr_b16 a[20:21], v15 offset:14848
  ds_read_b64_tr_b16 a[22:23], v15 offset:16704
  ds_read_b64_tr_b16 a[76:77], v15 offset:14880
  ds_read_b64_tr_b16 a[78:79], v15 offset:16736
  ds_read_b64_tr_b16 a[132:133], v15 offset:14912
  ds_read_b64_tr_b16 a[134:135], v15 offset:16768
  ds_read_b64_tr_b16 a[188:189], v16 offset:14848
  ds_read_b64_tr_b16 a[190:191], v16 offset:16704
  ds_read_b64_tr_b16 a[24:25], v15 offset:29696
  ds_read_b64_tr_b16 a[26:27], v15 offset:31552
  ds_read_b64_tr_b16 a[80:81], v15 offset:29728
  ds_read_b64_tr_b16 a[82:83], v15 offset:31584
  ds_read_b64_tr_b16 a[136:137], v15 offset:29760
  ds_read_b64_tr_b16 a[138:139], v15 offset:31616
  ds_read_b64_tr_b16 a[192:193], v16 offset:29696
  ds_read_b64_tr_b16 a[194:195], v16 offset:31552
  s_waitcnt lgkmcnt(0)
  s_barrier
  s_mul_i32 m0, s8, 928
  s_mov_b32 s20, 28
  s_mov_b32 exec_hi, 0xffffff
wl_156:
  buffer_load_dwordx4 v10, s[52:55], s26 offen lds
  s_add_u32 m0, m0, 3712
  s_add_u32 s26, s26, 28672
  s_sub_u32 s20, s20, 1
  s_cmp_lg_u32 s20, 0
  s_cbranch_scc1 wl_156
  s_mov_b32 exec_hi, -1
  s_waitcnt vmcnt(0)
  s_barrier
  v_mov_b32 v15, v11
  v_mov_b32 v16, v12
  ds_read_b64_tr_b16 a[28:29], v15 offset:0
  ds_read_b64_tr_b16 a[30:31], v15 offset:1856
  ds_read_b64_tr_b16 a[84:85], v15 offset:32
  ds_read_b64_tr_b16 a[86:87], v15 offset:1888
  ds_read_b64_tr_b16 a[140:141], v15 offset:64
  ds_read_b64_tr_b16 a[142:143], v15 offset:1920
  ds_read_b64_tr_b16 a[196:197], v16 offset:0
  ds_read_b64_tr_b16 a[198:199], v16 offset:1856
  ds_read_b64_tr_b16 a[32:33], v15 offset:14848
  ds_read_b64_tr_b16 a[34:35], v15 offset:16704
  ds_read_b64_tr_b16 a[88:89], v15 offset:14880
  ds_read_b64_tr_b16 a[90:91], v15 offset:16736
  ds_read_b64_tr_b16 a[144:145], v15 offset:14912
  ds_read_b64_tr_b16 a[146:147], v15 offset:16768
  ds_read_b64_tr_b16 a[200:201], v16 offset:14848
  ds_read_b64_tr_b16 a[202:203], v16 offset:16704
  ds_read_b64_tr_b16 a[36:37], v15 offset:29696
  ds_read_b64_tr_b16 a[38:39], v15 offset:31552
  ds_read_b64_tr_b16 a[92:93], v15 offset:29728
  ds_read_b64_tr_b16 a[94:95], v15 offset:31584
  ds_read_b64_tr_b16 a[148:149], v15 offset:29760
  ds_read_b64_tr_b16 a[150:151], v15 offset:31616
  ds_read_b64_tr_b16 a[204:205], v16 offset:29696
  ds_read_b64_tr_b16 a[206:207], v16 offset:31552
  ds_read_b64_tr_b16 a[40:41], v15 offset:44544
  ds_read_b64_tr_b16 a[42:43], v15 offset:46400
  ds_read_b64_tr_b16 a[96:97], v15 offset:44576
  ds_read_b64_tr_b16 a[98:99], v15 offset:46432
  ds_read_b64_tr_b16 a[152:153], v15 offset:44608
  ds_read_b64_tr_b16 a[154:155], v15 offset:46464
  ds_read_b64_tr_b16 a[208:209], v16 offset:44544
  ds_read_b64_tr_b16 a[210:211], v16 offset:46400
  v_add_u32 v15, 59392, v15
  v_add_u32 v16, 59392, v16
  ds_read_b64_tr_b16 a[44:45], v15 offset:0
  ds_read_b64_tr_b16 a[46:47], v15 offset:1856
  ds_read_b64_tr_b16 a[100:101], v15 offset:32
  ds_read_b64_tr_b16 a[102:103], v15 offset:1888
  ds_read_b64_tr_b16 a[156:157], v15 offset:64
  ds_read_b64_tr_b16 a[158:159], v15 offset:1920
  ds_read_b64_tr_b16 a[212:213], v16 offset:0
  ds_read_b64_tr_b16 a[214:215], v16 offset:1856
  ds_read_b64_tr_b16 a[48:49], v15 offset:14848
  ds_read_b64_tr_b16 a[50:51], v15 offset:16704
  ds_read_b64_tr_b16 a[104:105], v15 offset:14880
  ds_read_b64_tr_b16 a[106:107], v15 offset:16736
  ds_read_b64_tr_b16 a[160:161], v15 offset:14912
  ds_read_b64_tr_b16 a[162:163], v15 offset:16768
  ds_read_b64_tr_b16 a[216:217], v16 offset:14848
  ds_read_b64_tr_b16 a[218:219], v16 offset:16704
  ds_read_b64_tr_b16 a[52:53], v15 offset:29696
  ds_read_b64_tr_b16 a[54:55], v15 offset:31552
  ds_read_b64_tr_b16 a[108:109], v15 offset:29728
  ds_read_b64_tr_b16 a[110:111], v15 offset:31584
  ds_read_b64_tr_b16 a[164:165], v15 offset:29760
  ds_read_b64_tr_b16 a[166:167], v15 offset:31616
  ds_read_b64_tr_b16 a[220:221], v16 offset:29696
  ds_read_b64_tr_b16 a[222:223], v16 offset:31552
  s_waitcnt lgkmcnt(0)
  s_barrier
  s_mov_b32 s52, s56
  s_mov_b32 s53, s57
  s_mul_i32 s26, s10, 224
  s_add_u32 s26, s26, s8
  s_mul_i32 s26, s26, 896
  s_mul_i32 m0, s8, 928
  s_mov_b32 s20, 32
  s_mov_b32 exec_hi, 0xffffff
wl_157:
  buffer_load_dwordx4 v1, s[52:55], s26 offen lds
  s_add_u32 m0, m0, 3712
  s_add_u32 s26, s26, 3584
  s_sub_u32 s20, s20, 1
  s_cmp_lg_u32 s20, 0
  s_cbranch_scc1 wl_157
  s_mov_b32 exec_hi, -1
  s_waitcnt vmcnt(0)
  s_barrier
  v_mov_b32 v15, v13
  v_mov_b32 v16, v14
  ds_read_b64_tr_b16 a[224:225], v15 offset:0
  ds_read_b64_tr_b16 a[226:227], v15 offset:14848
  ds_read_b64_tr_b16 a[252:253], v15 offset:8
  ds_read_b64_tr_b16 a[254:255], v15 offset:14856
  ds_read_b64_tr_b16 v[116:117], v15 offset:64
  ds_read_b64_tr_b16 v[118:119], v15 offset:14912
  ds_read_b64_tr_b16 v[144:145], v15 offset:72
  ds_read_b64_tr_b16 v[146:147], v15 offset:14920
  ds_read_b64_tr_b16 v[172:173], v15 offset:128
  ds_read_b64_tr_b16 v[174:175], v15 offset:14976
  ds_read_b64_tr_b16 v[200:201], v15 offset:136
  ds_read_b64_tr_b16 v[202:203], v15 offset:14984
  ds_read_b64_tr_b16 v[228:229], v16 offset:0
  ds_read_b64_tr_b16 v[230:231], v16 offset:14848
  ds_read_b64_tr_b16 a[228:229], v15 offset:29696
  ds_read_b64_tr_b16 a[230:231], v15 offset:44544
  ds_read_b64_tr_b16 v[92:93], v15 offset:29704
  ds_read_b64_tr_b16 v[94:95], v15 offset:44552
  ds_read_b64_tr_b16 v[120:121], v15 offset:29760
  ds_read_b64_tr_b16 v[122:123], v15 offset:44608
  ds_read_b64_tr_b16 v[148:149], v15 offset:29768
  ds_read_b64_tr_b16 v[150:151], v15 offset:44616
  ds_read_b64_tr_b16 v[176:177], v15 offset:29824
  ds_read_b64_tr_b16 v[178:179], v15 offset:44672
  ds_read_b64_tr_b16 v[204:205], v15 offset:29832
  ds_read_b64_tr_b16 v[206:207], v15 offset:44680
  ds_read_b64_tr_b16 v[232:233], v16 offset:29696
  ds_read_b64_tr_b16 v[234:235], v16 offset:44544
  v_add_u32 v15, 59392, v15
  v_add_u32 v16, 59392, v16
  ds_read_b64_tr_b16 a[232:233], v15 offset:0
  ds_read_b64_tr_b16 a[234:235], v15 offset:14848
  ds_read_b64_tr_b16 v[96:97], v15 offset:8
  ds_read_b64_tr_b16 v[98:99], v15 offset:14856
  ds_read_b64_tr_b16 v[124:125], v15 offset:64
  ds_read_b64_tr_b16 v[126:127], v15 offset:14912
  ds_read_b64_tr_b16 v[152:153], v15 offset:72
  ds_read_b64_tr_b16 v[154:155], v15 offset:14920
  ds_read_b64_tr_b16 v[180:181], v15 offset:128
  ds_read_b64_tr_b16 v[182:183], v15 offset:14976
  ds_read_b64_tr_b16 v[208:209], v15 offset:136
  ds_read_b64_tr_b16 v[210:211], v15 offset:14984
  ds_read_b64_tr_b16 v[236:237], v16 offset:0
  ds_read_b64_tr_b16 v[238:239], v16 offset:14848
  ds_read_b64_tr_b16 a[236:237], v15 offset:29696
  ds_read_b64_tr_b16 a[238:239], v15 offset:44544
  ds_read_b64_tr_b16 v[100:101], v15 offset:29704
  ds_read_b64_tr_b16 v[102:103], v15 offset:44552
  ds_read_b64_tr_b16 v[128:129], v15 offset:29760
  ds_read_b64_tr_b16 v[130:131], v15 offset:44608
  ds_read_b64_tr_b16 v[156:157], v15 offset:29768
  ds_read_b64_tr_b16 v[158:159], v15 offset:44616
  ds_read_b64_tr_b16 v[184:185], v15 offset:29824
  ds_read_b64_tr_b16 v[186:187], v15 offset:44672
  ds_read_b64_tr_b16 v[212:213], v15 offset:29832
  ds_read_b64_tr_b16 v[214:215], v15 offset:44680
  ds_read_b64_tr_b16 v[240:241], v16 offset:29696
  ds_read_b64_tr_b16 v[242:243], v16 offset:44544
  s_waitcnt lgkmcnt(0)
  s_barrier
  s_mul_i32 m0, s8, 928
  s_mov_b32 s20, 24
  s_mov_b32 exec_hi, 0xffffff
wl_158:
  buffer_load_dwordx4 v1, s[52:55], s26 offen lds
  s_add_u32 m0, m0, 3712
  s_add_u32 s26, s26, 3584
  s_sub_u32 s20, s20, 1
  s_cmp_lg_u32 s20, 0
  s_cbranch_scc1 wl_158
  s_mov_b32 exec_hi, -1
  s_waitcnt vmcnt(0)
  s_barrier
  v_mov_b32 v15, v13
  v_mov_b32 v16, v14
  ds_read_b64_tr_b16 a[240:241], v15 offset:0
  ds_read_b64_tr_b16 a[242:243], v15 offset:14848
  ds_read_b64_tr_b16 v[104:105], v15 offset:8
  ds_read_b64_tr_b16 v[106:107], v15 offset:14856
  ds_read_b64_tr_b16 v[132:133], v15 offset:64
  ds_read_b64_tr_b16 v[134:135], v15 offset:14912
  ds_read_b64_tr_b16 v[160:161], v15 offset:72
  ds_read_b64_tr_b16 v[162:163], v15 offset:14920
  ds_read_b64_tr_b16 v[188:189], v15 offset:128
  ds_read_b64_tr_b16 v[190:191], v15 offset:14976
  ds_read_b64_tr_b16 v[216:217], v15 offset:136
  ds_read_b64_tr_b16 v[218:219], v15 offset:14984
  ds_read_b64_tr_b16 v[244:245], v16 offset:0
  ds_read_b64_tr_b16 v[246:247], v16 offset:14848
  ds_read_b64_tr_b16 a[244:245], v15 offset:29696
  ds_read_b64_tr_b16 a[246:247], v15 offset:44544
  ds_read_b64_tr_b16 v[108:109], v15 offset:29704
  ds_read_b64_tr_b16 v[110:111], v15 offset:44552
  ds_read_b64_tr_b16 v[136:137], v15 offset:29760
  ds_read_b64_tr_b16 v[138:139], v15 offset:44608
  ds_read_b64_tr_b16 v[164:165], v15 offset:29768
  ds_read_b64_tr_b16 v[166:167], v15 offset:44616
  ds_read_b64_tr_b16 v[192:193], v15 offset:29824
  ds_read_b64_tr_b16 v[194:195], v15 offset:44672
  ds_read_b64_tr_b16 v[220:221], v15 offset:29832
  ds_read_b64_tr_b16 v[222:223], v15 offset:44680
  ds_read_b64_tr_b16 v[248:249], v16 offset:29696
  ds_read_b64_tr_b16 v[250:251], v16 offset:44544
  v_add_u32 v15, 59392, v15
  v_add_u32 v16, 59392, v16
  ds_read_b64_tr_b16 a[248:249], v15 offset:0
  ds_read_b64_tr_b16 a[250:251], v15 offset:14848
  ds_read_b64_tr_b16 v[112:113], v15 offset:8
  ds_read_b64_tr_b16 v[114:115], v15 offset:14856
  ds_read_b64_tr_b16 v[140:141], v15 offset:64
  ds_read_b64_tr_b16 v[142:143], v15 offset:14912
  ds_read_b64_tr_b16 v[168:169], v15 offset:72
  ds_read_b64_tr_b16 v[170:171], v15 offset:14920
  ds_read_b64_tr_b16 v[196:197], v15 offset:128
  ds_read_b64_tr_b16 v[198:199], v15 offset:14976
  ds_read_b64_tr_b16 v[224:225], v15 offset:136
  ds_read_b64_tr_b16 v[226:227], v15 offset:14984
  ds_read_b64_tr_b16 v[252:253], v16 offset:0
  ds_read_b64_tr_b16 v[254:255], v16 offset:14848
  s_waitcnt lgkmcnt(0)
  s_barrier
  s_cmp_lg_u32 s23, 0
  s_cbranch_scc1 pl_159
  s_mov_b32 s47, 0x1f54aa0
  s_mov_b32 s48, 0x42108421
  s_mov_b32 s49, 0x10842108
  s_mov_b32 s50, 0x44408444
  s_mov_b32 s51, 0x84210800
pl_159:
  s_cmp_lg_u32 s23, 1
  s_cbranch_scc1 pl_160
  s_mov_b32 s47, 0xf552a0
  s_mov_b32 s48, 0x84210842
  s_mov_b32 s49, 0x21084210
  s_mov_b32 s50, 0x88880888
  s_mov_b32 s51, 0x8421000
pl_160:
  s_cmp_lg_u32 s23, 2
  s_cbranch_scc1 pl_161
  s_mov_b32 s47, 0xf4aa50
  s_mov_b32 s48, 0x8421084
  s_mov_b32 s49, 0x42108421
  s_mov_b32 s50, 0x1111011
  s_mov_b32 s51, 0x10842001
pl_161:
  s_cmp_lg_u32 s23, 3
  s_cbranch_scc1 pl_162
  s_mov_b32 s47, 0xf52a90
  s_mov_b32 s48, 0x10842108
  s_mov_b32 s49, 0x84210842
  s_mov_b32 s50, 0x10222102
  s_mov_b32 s51, 0x21084002
pl_162:
  s_cmp_lg_u32 s23, 4
  s_cbranch_scc1 pl_163
  s_mov_b32 s47, 0x7d4aa0
  s_mov_b32 s48, 0x21084210
  s_mov_b32 s49, 0x8421084
  s_mov_b32 s50, 0x22044220
  s_mov_b32 s51, 0x42108400
pl_163:
  s_cmp_lg_u32 s23, 5
  s_cbranch_scc1 pl_164
  s_mov_b32 s47, 0x3
  s_mov_b32 s48, 0x0
  s_mov_b32 s49, 0x0
  s_mov_b32 s50, 0x0
  s_mov_b32 s51, 0x44
pl_164:
  s_cmp_lg_u32 s23, 6
  s_cbranch_scc1 pl_165
  s_mov_b32 s47, 0x3
  s_mov_b32 s48, 0x0
  s_mov_b32 s49, 0x0
  s_mov_b32 s50, 0x0
  s_mov_b32 s51, 0x88
pl_165:
  s_cmp_lg_u32 s23, 7
  s_cbranch_scc1 pl_166
  s_mov_b32 s47, 0x3
  s_mov_b32 s48, 0x0
  s_mov_b32 s49, 0x0
  s_mov_b32 s50, 0x0
  s_mov_b32 s51, 0x110
pl_166:
  s_cmp_lg_u32 s23, 8
  s_cbranch_scc1 pl_167
  s_mov_b32 s47, 0x3
  s_mov_b32 s48, 0x0
  s_mov_b32 s49, 0x0
  s_mov_b32 s50, 0x0
  s_mov_b32 s51, 0x220
pl_167:
  s_mul_i32 s18, s8, 7168
  v_add_u32 v3, s18, v1
  s_mov_b32 s22, 29696
  s_mov_b32 s27, 0
  s_and_b32 s45, s47, 1
  s_cselect_b64 s[56:57], s[50:51], s[48:49]
  s_ff1_i32_b64 s44, s[56:57]
  s_bitset0_b64 s[56:57], s44
  s_cselect_b64 s[50:51], s[56:57], s[50:51]
  s_cselect_b64 s[48:49], s[48:49], s[56:57]
  s_lshr_b32 s47, s47, 1
  s_max_i32 s12, s44, 0
  s_lshl_b32 s19, s45, 6
  s_add_u32 s19, s19, s12
  s_mul_i32 s12, s19, 28672
  s_add_u32 s12, s12, 36175872
  v_and_b32 v8, 15, v0
  v_lshlrev_b32 v8, 1, v8
  s_mul_i32 s20, s10, 14
  s_add_u32 s19, s20, s24
  s_lshl_b32 s19, s19, 5
  buffer_load_ushort v62, v8, s[32:35], s19 offen offset:0
  buffer_load_ushort v63, v8, s[32:35], s19 offen offset:32
  buffer_load_ushort v64, v8, s[32:35], s19 offen offset:64
  s_add_u32 s19, s20, s25
  s_lshl_b32 s19, s19, 5
  buffer_load_ushort v65, v8, s[32:35], s19 offen
  buffer_load_dwordx4 v[72:75], v1, s[36:39], 0 offen
  v_mov_b32 v2, 0x0
  v_bfe_u32 v30, v0, 0, 4
  s_mov_b32 s100, 0x10
  v_mul_lo_u32 v30, v30, s100
  v_add_u32 v2, v2, v30
  v_bfe_u32 v30, v0, 4, 2
  s_mov_b32 s100, 0x200
  v_mul_lo_u32 v30, v30, s100
  v_add_u32 v2, v2, v30
  v_mov_b32 v5, 0x0
  v_bfe_u32 v30, v0, 0, 2
  s_mov_b32 s100, 0x10
  v_mul_lo_u32 v30, v30, s100
  v_add_u32 v5, v5, v30
  v_bfe_u32 v30, v0, 2, 2
  s_mov_b32 s100, 0x7000
  v_mul_lo_u32 v30, v30, s100
  v_add_u32 v5, v5, v30
  v_bfe_u32 v30, v0, 4, 2
  s_mov_b32 s100, 0x40
  v_mul_lo_u32 v30, v30, s100
  v_add_u32 v5, v5, v30
  v_mov_b32 v6, 0x0
  v_bfe_u32 v30, v0, 0, 2
  s_mov_b32 s100, 0x10
  v_mul_lo_u32 v30, v30, s100
  v_add_u32 v6, v6, v30
  v_bfe_u32 v30, v0, 2, 2
  s_mov_b32 s100, 0x7000
  v_mul_lo_u32 v30, v30, s100
  v_add_u32 v6, v6, v30
  v_bfe_u32 v30, v0, 4, 1
  s_mov_b32 s100, 0x8
  v_mul_lo_u32 v30, v30, s100
  v_add_u32 v6, v6, v30
  v_bfe_u32 v30, v0, 5, 1
  s_mov_b32 s100, 0x40
  v_mul_lo_u32 v30, v30, s100
  v_add_u32 v6, v6, v30
  v_add_u32 v4, 59392, v1
  v_mov_b32 v9, 0x3f803f80
  s_mul_i32 s19, s8, 6144
  s_add_u32 s19, s19, 76800
  v_add_u32 v7, s19, v1
  s_mov_b32 vcc_lo, 0x10001
  s_mov_b32 vcc_hi, 0x10001
  v_mov_b32 v40, 0x0
  v_mov_b32 v30, 0x3f80
  v_cndmask_b32 v40, v40, v30, vcc
  s_mov_b32 vcc_lo, 0x20002
  s_mov_b32 vcc_hi, 0x20002
  v_mov_b32 v41, 0x0
  v_mov_b32 v30, 0x3f800000
  v_cndmask_b32 v41, v41, v30, vcc
  v_or_b32 v44, v40, v41
  s_mov_b32 vcc_lo, 0x40004
  s_mov_b32 vcc_hi, 0x40004
  v_mov_b32 v40, 0x0
  v_mov_b32 v30, 0x3f80
  v_cndmask_b32 v40, v40, v30, vcc
  s_mov_b32 vcc_lo, 0x80008
  s_mov_b32 vcc_hi, 0x80008
  v_mov_b32 v41, 0x0
  v_mov_b32 v30, 0x3f800000
  v_cndmask_b32 v41, v41, v30, vcc
  v_or_b32 v45, v40, v41
  s_mov_b32 vcc_lo, 0x100010
  s_mov_b32 vcc_hi, 0x100010
  v_mov_b32 v40, 0x0
  v_mov_b32 v30, 0x3f80
  v_cndmask_b32 v40, v40, v30, vcc
  s_mov_b32 vcc_lo, 0x200020
  s_mov_b32 vcc_hi, 0x200020
  v_mov_b32 v41, 0x0
  v_mov_b32 v30, 0x3f800000
  v_cndmask_b32 v41, v41, v30, vcc
  v_or_b32 v46, v40, v41
  s_mov_b32 vcc_lo, 0x400040
  s_mov_b32 vcc_hi, 0x400040
  v_mov_b32 v40, 0x0
  v_mov_b32 v30, 0x3f80
  v_cndmask_b32 v40, v40, v30, vcc
  s_mov_b32 vcc_lo, 0x800080
  s_mov_b32 vcc_hi, 0x800080
  v_mov_b32 v41, 0x0
  v_mov_b32 v30, 0x3f800000
  v_cndmask_b32 v41, v41, v30, vcc
  v_or_b32 v47, v40, v41
  s_mov_b32 vcc_lo, 0x1000100
  s_mov_b32 vcc_hi, 0x1000100
  v_mov_b32 v40, 0x0
  v_mov_b32 v30, 0x3f80
  v_cndmask_b32 v40, v40, v30, vcc
  s_mov_b32 vcc_lo, 0x2000200
  s_mov_b32 vcc_hi, 0x2000200
  v_mov_b32 v41, 0x0
  v_mov_b32 v30, 0x3f800000
  v_cndmask_b32 v41, v41, v30, vcc
  v_or_b32 v48, v40, v41
  s_mov_b32 vcc_lo, 0x4000400
  s_mov_b32 vcc_hi, 0x4000400
  v_mov_b32 v40, 0x0
  v_mov_b32 v30, 0x3f80
  v_cndmask_b32 v40, v40, v30, vcc
  s_mov_b32 vcc_lo, 0x8000800
  s_mov_b32 vcc_hi, 0x8000800
  v_mov_b32 v41, 0x0
  v_mov_b32 v30, 0x3f800000
  v_cndmask_b32 v41, v41, v30, vcc
  v_or_b32 v49, v40, v41
  s_mov_b32 vcc_lo, 0x10001000
  s_mov_b32 vcc_hi, 0x10001000
  v_mov_b32 v40, 0x0
  v_mov_b32 v30, 0x3f80
  v_cndmask_b32 v40, v40, v30, vcc
  s_mov_b32 vcc_lo, 0x20002000
  s_mov_b32 vcc_hi, 0x20002000
  v_mov_b32 v41, 0x0
  v_mov_b32 v30, 0x3f800000
  v_cndmask_b32 v41, v41, v30, vcc
  v_or_b32 v50, v40, v41
  s_mov_b32 vcc_lo, 0x40004000
  s_mov_b32 vcc_hi, 0x40004000
  v_mov_b32 v40, 0x0
  v_mov_b32 v30, 0x3f80
  v_cndmask_b32 v40, v40, v30, vcc
  s_mov_b32 vcc_lo, 0x80008000
  s_mov_b32 vcc_hi, 0x80008000
  v_mov_b32 v41, 0x0
  v_mov_b32 v30, 0x3f800000
  v_cndmask_b32 v41, v41, v30, vcc
  v_or_b32 v51, v40, v41
  v_mov_b32 v52, 0x0
  v_bfe_u32 v30, v0, 0, 4
  s_mov_b32 s100, 0x10
  v_mul_lo_u32 v30, v30, s100
  v_add_u32 v52, v52, v30
  v_bfe_u32 v30, v0, 4, 2
  s_mov_b32 s100, 0xe00
  v_mul_lo_u32 v30, v30, s100
  v_add_u32 v52, v52, v30
  v_mov_b32 v53, 0x0
  v_bfe_u32 v30, v0, 0, 3
  s_mov_b32 s100, 0x10
  v_mul_lo_u32 v30, v30, s100
  v_add_u32 v53, v53, v30
  v_bfe_u32 v30, v0, 4, 2
  s_mov_b32 s100, 0xe00
  v_mul_lo_u32 v30, v30, s100
  v_add_u32 v53, v53, v30
  v_mov_b32 v31, 0x7ff00000
  v_and_b32 v30, 8, v0
  v_cmp_ne_u32 vcc, 0, v30
  s_nop 1
  v_cndmask_b32 v53, v53, v31, vcc
  v_mov_b32 v54, 0x0
  v_bfe_u32 v30, v0, 0, 2
  s_mov_b32 s100, 0x10
  v_mul_lo_u32 v30, v30, s100
  v_add_u32 v54, v54, v30
  v_bfe_u32 v30, v0, 2, 1
  s_mov_b32 s100, 0x200
  v_mul_lo_u32 v30, v30, s100
  v_add_u32 v54, v54, v30
  v_bfe_u32 v30, v0, 4, 1
  s_mov_b32 s100, 0x1000
  v_mul_lo_u32 v30, v30, s100
  v_add_u32 v54, v54, v30
  v_bfe_u32 v30, v0, 5, 1
  s_mov_b32 s100, 0x800
  v_mul_lo_u32 v30, v30, s100
  v_add_u32 v54, v54, v30
  v_mov_b32 v31, 0x400
  v_bfe_u32 v30, v0, 0, 2
  s_mov_b32 s100, 0x10
  v_mul_lo_u32 v30, v30, s100
  v_add_u32 v31, v31, v30
  v_bfe_u32 v30, v0, 2, 1
  s_mov_b32 s100, 0x200
  v_mul_lo_u32 v30, v30, s100
  v_add_u32 v31, v31, v30
  v_bfe_u32 v30, v0, 5, 1
  s_mov_b32 s100, 0x800
  v_mul_lo_u32 v30, v30, s100
  v_add_u32 v31, v31, v30
  v_mov_b32 v32, 0x1400
  v_bfe_u32 v30, v0, 0, 2
  s_mov_b32 s100, 0x10
  v_mul_lo_u32 v30, v30, s100
  v_add_u32 v32, v32, v30
  v_bfe_u32 v30, v0, 2, 1
  s_mov_b32 s100, 0x200
  v_mul_lo_u32 v30, v30, s100
  v_add_u32 v32, v32, v30
  v_mov_b32 v33, 0x7ff00000
  v_and_b32 v30, 32, v0
  v_cmp_ne_u32 vcc, 0, v30
  s_nop 1
  v_cndmask_b32 v32, v32, v33, vcc
  v_and_b32 v30, 16, v0
  v_cmp_ne_u32 vcc, 0, v30
  s_nop 1
  v_cndmask_b32 v31, v31, v32, vcc
  v_and_b32 v30, 8, v0
  v_cmp_ne_u32 vcc, 0, v30
  s_nop 1
  v_cndmask_b32 v54, v54, v31, vcc
  v_mov_b32 v55, 0x0
  v_bfe_u32 v30, v0, 0, 2
  s_mov_b32 s100, 0x380
  v_mul_lo_u32 v30, v30, s100
  v_add_u32 v55, v55, v30
  v_bfe_u32 v30, v0, 2, 1
  s_mov_b32 s100, 0x10
  v_mul_lo_u32 v30, v30, s100
  v_add_u32 v55, v55, v30
  v_bfe_u32 v30, v0, 4, 1
  s_mov_b32 s100, 0x80
  v_mul_lo_u32 v30, v30, s100
  v_add_u32 v55, v55, v30
  v_bfe_u32 v30, v0, 5, 1
  s_mov_b32 s100, 0x40
  v_mul_lo_u32 v30, v30, s100
  v_add_u32 v55, v55, v30
  v_mov_b32 v31, 0x20
  v_bfe_u32 v30, v0, 0, 2
  s_mov_b32 s100, 0x380
  v_mul_lo_u32 v30, v30, s100
  v_add_u32 v31, v31, v30
  v_bfe_u32 v30, v0, 2, 1
  s_mov_b32 s100, 0x10
  v_mul_lo_u32 v30, v30, s100
  v_add_u32 v31, v31, v30
  v_bfe_u32 v30, v0, 5, 1
  s_mov_b32 s100, 0x40
  v_mul_lo_u32 v30, v30, s100
  v_add_u32 v31, v31, v30
  v_mov_b32 v32, 0xa0
  v_bfe_u32 v30, v0, 0, 2
  s_mov_b32 s100, 0x380
  v_mul_lo_u32 v30, v30, s100
  v_add_u32 v32, v32, v30
  v_bfe_u32 v30, v0, 2, 1
  s_mov_b32 s100, 0x10
  v_mul_lo_u32 v30, v30, s100
  v_add_u32 v32, v32, v30
  v_mov_b32 v33, 0x7ff00000
  v_and_b32 v30, 32, v0
  v_cmp_ne_u32 vcc, 0, v30
  s_nop 1
  v_cndmask_b32 v32, v32, v33, vcc
  v_and_b32 v30, 16, v0
  v_cmp_ne_u32 vcc, 0, v30
  s_nop 1
  v_cndmask_b32 v31, v31, v32, vcc
  v_and_b32 v30, 8, v0
  v_cmp_ne_u32 vcc, 0, v30
  s_nop 1
  v_cndmask_b32 v55, v55, v31, vcc
  s_mul_i32 s19, s8, 7168
  s_lshl_b32 s26, s10, 6
  s_add_u32 s19, s19, s26
  s_mul_i32 s26, s8, 224
  v_mov_b32 v40, 0x0
  v_bfe_u32 v30, v0, 0, 2
  s_mov_b32 s100, 0x10
  v_mul_lo_u32 v30, v30, s100
  v_add_u32 v40, v40, v30
  v_bfe_u32 v30, v0, 2, 2
  s_mov_b32 s100, 0x200
  v_mul_lo_u32 v30, v30, s100
  v_add_u32 v40, v40, v30
  v_mov_b32 v41, 0x7000
  v_bfe_u32 v30, v0, 2, 2
  s_mov_b32 s100, 0x10
  v_mul_lo_u32 v30, v30, s100
  v_add_u32 v41, v41, v30
  v_add_u32 v40, s19, v40
  v_add_u32 v41, s26, v41
  v_mov_b32 v56, 29568
  s_mov_b32 vcc_lo, 0xffff
  s_mov_b32 vcc_hi, 0
  v_cndmask_b32 v56, v56, v40, vcc
  s_mov_b32 vcc_lo, 0xffff0000
  s_mov_b32 vcc_hi, 0
  v_cndmask_b32 v56, v56, v41, vcc
  v_add_u32 v40, 2048, v40
  v_add_u32 v41, 64, v41
  v_mov_b32 v57, 29568
  s_mov_b32 vcc_lo, 0xffff
  s_mov_b32 vcc_hi, 0
  v_cndmask_b32 v57, v57, v40, vcc
  s_mov_b32 vcc_lo, 0xffff0000
  s_mov_b32 vcc_hi, 0
  v_cndmask_b32 v57, v57, v41, vcc
  v_add_u32 v40, 2048, v40
  v_add_u32 v41, 64, v41
  v_mov_b32 v58, 29568
  s_mov_b32 vcc_lo, 0xffff
  s_mov_b32 vcc_hi, 0
  v_cndmask_b32 v58, v58, v40, vcc
  s_mov_b32 vcc_lo, 0xffff0000
  s_mov_b32 vcc_hi, 0
  v_cndmask_b32 v58, v58, v41, vcc
  v_add_u32 v40, 2048, v40
  v_add_u32 v41, 64, v41
  v_mov_b32 v59, 29568
  s_mov_b32 vcc_lo, 0xff
  s_mov_b32 vcc_hi, 0
  v_cndmask_b32 v59, v59, v40, vcc
  s_mov_b32 vcc_lo, 0xff0000
  s_mov_b32 vcc_hi, 0
  v_cndmask_b32 v59, v59, v41, vcc
  v_add_u32 v40, 2048, v40
  v_add_u32 v41, 64, v41
  ds_write_b128 v7, v[44:47] offset:0
  ds_write_b128 v7, v[48:51] offset:1024
  ds_write_b128 v7, v[52:55] offset:2048
  ds_write_b128 v7, v[56:59] offset:3072
  v_mov_b32 v24, v9
  v_mov_b32 v25, v9
  v_mov_b32 v26, v9
  v_mov_b32 v27, v9
  s_nop 1
  v_mfma_f32_16x16x32_bf16 v[76:79], v[24:27], a[0:3], 0
  v_mfma_f32_16x16x32_bf16 v[76:79], v[24:27], a[4:7], v[76:79]
  v_mfma_f32_16x16x32_bf16 v[76:79], v[24:27], a[8:11], v[76:79]
  v_mfma_f32_16x16x32_bf16 v[76:79], v[24:27], a[12:15], v[76:79]
  v_mfma_f32_16x16x32_bf16 v[76:79], v[24:27], a[16:19], v[76:79]
  v_mfma_f32_16x16x32_bf16 v[76:79], v[24:27], a[20:23], v[76:79]
  v_mfma_f32_16x16x32_bf16 v[76:79], v[24:27], a[24:27], v[76:79]
  v_mfma_f32_16x16x32_bf16 v[76:79], v[24:27], a[28:31], v[76:79]
  v_mfma_f32_16x16x32_bf16 v[76:79], v[24:27], a[32:35], v[76:79]
  v_mfma_f32_16x16x32_bf16 v[76:79], v[24:27], a[36:39], v[76:79]
  v_mfma_f32_16x16x32_bf16 v[76:79], v[24:27], a[40:43], v[76:79]
  v_mfma_f32_16x16x32_bf16 v[76:79], v[24:27], a[44:47], v[76:79]
  v_mfma_f32_16x16x32_bf16 v[76:79], v[24:27], a[48:51], v[76:79]
  v_mfma_f32_16x16x32_bf16 v[76:79], v[24:27], a[52:55], v[76:79]
  v_mfma_f32_16x16x32_bf16 v[80:83], v[24:27], a[56:59], 0
  v_mfma_f32_16x16x32_bf16 v[80:83], v[24:27], a[60:63], v[80:83]
  v_mfma_f32_16x16x32_bf16 v[80:83], v[24:27], a[64:67], v[80:83]
  v_mfma_f32_16x16x32_bf16 v[80:83], v[24:27], a[68:71], v[80:83]
  v_mfma_f32_16x16x32_bf16 v[80:83], v[24:27], a[72:75], v[80:83]
  v_mfma_f32_16x16x32_bf16 v[80:83], v[24:27], a[76:79], v[80:83]
  v_mfma_f32_16x16x32_bf16 v[80:83], v[24:27], a[80:83], v[80:83]
  v_mfma_f32_16x16x32_bf16 v[80:83], v[24:27], a[84:87], v[80:83]
  v_mfma_f32_16x16x32_bf16 v[80:83], v[24:27], a[88:91], v[80:83]
  v_mfma_f32_16x16x32_bf16 v[80:83], v[24:27], a[92:95], v[80:83]
  v_mfma_f32_16x16x32_bf16 v[80:83], v[24:27], a[96:99], v[80:83]
  v_mfma_f32_16x16x32_bf16 v[80:83], v[24:27], a[100:103], v[80:83]
  v_mfma_f32_16x16x32_bf16 v[80:83], v[24:27], a[104:107], v[80:83]
  v_mfma_f32_16x16x32_bf16 v[80:83], v[24:27], a[108:111], v[80:83]
  v_mfma_f32_16x16x32_bf16 v[84:87], v[24:27], a[112:115], 0
  v_mfma_f32_16x16x32_bf16 v[84:87], v[24:27], a[116:119], v[84:87]
  v_mfma_f32_16x16x32_bf16 v[84:87], v[24:27], a[120:123], v[84:87]
  v_mfma_f32_16x16x32_bf16 v[84:87], v[24:27], a[124:127], v[84:87]
  v_mfma_f32_16x16x32_bf16 v[84:87], v[24:27], a[128:131], v[84:87]
  v_mfma_f32_16x16x32_bf16 v[84:87], v[24:27], a[132:135], v[84:87]
  v_mfma_f32_16x16x32_bf16 v[84:87], v[24:27], a[136:139], v[84:87]
  v_mfma_f32_16x16x32_bf16 v[84:87], v[24:27], a[140:143], v[84:87]
  v_mfma_f32_16x16x32_bf16 v[84:87], v[24:27], a[144:147], v[84:87]
  v_mfma_f32_16x16x32_bf16 v[84:87], v[24:27], a[148:151], v[84:87]
  v_mfma_f32_16x16x32_bf16 v[84:87], v[24:27], a[152:155], v[84:87]
  v_mfma_f32_16x16x32_bf16 v[84:87], v[24:27], a[156:159], v[84:87]
  v_mfma_f32_16x16x32_bf16 v[84:87], v[24:27], a[160:163], v[84:87]
  v_mfma_f32_16x16x32_bf16 v[84:87], v[24:27], a[164:167], v[84:87]
  v_mfma_f32_16x16x32_bf16 v[88:91], v[24:27], a[168:171], 0
  v_mfma_f32_16x16x32_bf16 v[88:91], v[24:27], a[172:175], v[88:91]
  v_mfma_f32_16x16x32_bf16 v[88:91], v[24:27], a[176:179], v[88:91]
  v_mfma_f32_16x16x32_bf16 v[88:91], v[24:27], a[180:183], v[88:91]
  v_mfma_f32_16x16x32_bf16 v[88:91], v[24:27], a[184:187], v[88:91]
  v_mfma_f32_16x16x32_bf16 v[88:91], v[24:27], a[188:191], v[88:91]
  v_mfma_f32_16x16x32_bf16 v[88:91], v[24:27], a[192:195], v[88:91]
  v_mfma_f32_16x16x32_bf16 v[88:91], v[24:27], a[196:199], v[88:91]
  v_mfma_f32_16x16x32_bf16 v[88:91], v[24:27], a[200:203], v[88:91]
  v_mfma_f32_16x16x32_bf16 v[88:91], v[24:27], a[204:207], v[88:91]
  v_mfma_f32_16x16x32_bf16 v[88:91], v[24:27], a[208:211], v[88:91]
  v_mfma_f32_16x16x32_bf16 v[88:91], v[24:27], a[212:215], v[88:91]
  v_mfma_f32_16x16x32_bf16 v[88:91], v[24:27], a[216:219], v[88:91]
  v_mfma_f32_16x16x32_bf16 v[88:91], v[24:27], a[220:223], v[88:91]
  s_waitcnt vmcnt(0) lgkmcnt(0)
  v_add_u32 v8, 28672, v1
  ds_write_b128 v8, v[72:75]
  ds_write_b128 v8, v[72:75] offset:29696
  s_mov_b32 s60, 0xffff
  s_mov_b32 s61, 0
  s_mov_b32 s62, 0xffff0000
  s_mov_b32 s63, 0
  v_and_b32 v77, 0xffff0000, v76
  v_sub_f32 v78, v76, v77
  v_cvt_pk_bf16_f32 v77, v77, v77
  v_cvt_pk_bf16_f32 v78, v78, v78
  v_lshl_or_b32 v79, v62, 16, v62
  v_cndmask_b32 v44, 0, v79, s[62:63]
  v_cndmask_b32 v44, v44, v77, s[60:61]
  v_cndmask_b32 v45, 0, v78, s[60:61]
  v_and_b32 v81, 0xffff0000, v80
  v_sub_f32 v82, v80, v81
  v_cvt_pk_bf16_f32 v81, v81, v81
  v_cvt_pk_bf16_f32 v82, v82, v82
  v_lshl_or_b32 v83, v63, 16, v63
  v_cndmask_b32 v46, 0, v83, s[62:63]
  v_cndmask_b32 v46, v46, v81, s[60:61]
  v_cndmask_b32 v47, 0, v82, s[60:61]
  v_and_b32 v85, 0xffff0000, v84
  v_sub_f32 v86, v84, v85
  v_cvt_pk_bf16_f32 v85, v85, v85
  v_cvt_pk_bf16_f32 v86, v86, v86
  v_lshl_or_b32 v87, v64, 16, v64
  v_cndmask_b32 v48, 0, v87, s[62:63]
  v_cndmask_b32 v48, v48, v85, s[60:61]
  v_cndmask_b32 v49, 0, v86, s[60:61]
  v_and_b32 v89, 0xffff0000, v88
  v_sub_f32 v90, v88, v89
  v_cvt_pk_bf16_f32 v89, v89, v89
  v_cvt_pk_bf16_f32 v90, v90, v90
  v_lshl_or_b32 v91, v65, 16, v65
  v_cndmask_b32 v50, 0, v91, s[62:63]
  v_cndmask_b32 v50, v50, v89, s[60:61]
  v_cndmask_b32 v51, 0, v90, s[60:61]
  ds_write_b128 v7, v[44:47] offset:4096
  ds_write_b128 v7, v[48:51] offset:5120
  s_add_u32 s19, s24, 0
  s_lshr_b32 s40, s19, 1
  s_lshl_b32 s40, s40, 10
  s_and_b32 s19, s19, 1
  s_lshl_b32 s19, s19, 3
  s_add_u32 s40, s40, s19
  s_add_u32 s19, s24, 1
  s_lshr_b32 s41, s19, 1
  s_lshl_b32 s41, s41, 10
  s_and_b32 s19, s19, 1
  s_lshl_b32 s19, s19, 3
  s_add_u32 s41, s41, s19
  s_add_u32 s19, s24, 2
  s_lshr_b32 s42, s19, 1
  s_lshl_b32 s42, s42, 10
  s_and_b32 s19, s19, 1
  s_lshl_b32 s19, s19, 3
  s_add_u32 s42, s42, s19
  s_mov_b32 s19, s25
  s_lshr_b32 s43, s19, 1
  s_lshl_b32 s43, s43, 10
  s_and_b32 s19, s19, 1
  s_lshl_b32 s19, s19, 3
  s_add_u32 s43, s43, s19
  s_lshl_b32 s15, s45, 6
  s_add_u32 s15, s15, s44
  s_mov_b32 s17, 1
  s_lshl_b32 s14, s23, 2
  s_add_u32 s14, s14, s8
  s_lshl_b32 s14, s14, 8
  s_add_u32 s14, s14, 18890752
  s_waitcnt lgkmcnt(0)
  s_mov_b32 s101, 18907136
  v_mbcnt_lo_u32_b32 v31, -1, 0
  v_mbcnt_hi_u32_b32 v31, -1, v31
  s_lshl_b32 s100, s8, 6
  v_add_u32 v31, s100, v31
  v_min_u32 v31, 255, v31
  v_lshlrev_b32 v31, 7, v31
  s_branch wc_168x
wc_168:
  s_sleep 2
wc_168x:
  buffer_load_dword v30, v31, s[4:7], s101 offen sc1
  s_sub_u32 s99, s99, 1
  s_cbranch_scc1 FAIL
  s_waitcnt vmcnt(0)
  v_cmp_eq_u32 vcc, 0, v30
  s_cbranch_vccnz wc_168
wcd_169:
  s_barrier
  s_mul_i32 s19, s23, 458752
  s_mul_i32 s20, s10, 28672
  s_add_u32 s19, s19, s20
  s_add_u32 s19, s19, s18
  s_add_u32 s19, s19, 19922944
  s_add_u32 s20, s19, 229376
  v_lshlrev_b32 v30, 3, v1
  buffer_load_dword v31, v30, s[4:7], s19 offen sc1
  buffer_load_dword v31, v30, s[4:7], s20 offen sc1
P_slow:
  v_add_u32 v0, s18, v1
  s_waitcnt lgkmcnt(0)
  s_add_u32 s19, s12, 4096
stg_170:
  buffer_load_dwordx4 v[60:63], v3, s[4:7], s12 offen offset:0 sc1
  buffer_load_dwordx4 v[64:67], v3, s[4:7], s12 offen offset:1024 sc1
  buffer_load_dwordx4 v[68:71], v3, s[4:7], s12 offen offset:2048 sc1
  buffer_load_dwordx4 v[72:75], v3, s[4:7], s12 offen offset:3072 sc1
  buffer_load_dwordx4 v[76:79], v3, s[4:7], s19 offen offset:0 sc1
  buffer_load_dwordx4 v[80:83], v3, s[4:7], s19 offen offset:1024 sc1
  buffer_load_dwordx4 v[84:87], v3, s[4:7], s19 offen offset:2048 sc1
  s_sub_u32 s99, s99, 1
  s_cbranch_scc1 FAIL
  v_mov_b64 v[20:21], 0
  s_waitcnt vmcnt(6)
  ds_write_b128 v0, v[60:63] offset:0
  v_dot2c_f32_bf16 v20, v60, v9
  v_dot2c_f32_bf16 v21, v60, v60
  v_dot2c_f32_bf16 v20, v61, v9
  v_dot2c_f32_bf16 v21, v61, v61
  v_dot2c_f32_bf16 v20, v62, v9
  v_dot2c_f32_bf16 v21, v62, v62
  v_dot2c_f32_bf16 v20, v63, v9
  v_dot2c_f32_bf16 v21, v63, v63
  s_waitcnt vmcnt(5)
  ds_write_b128 v0, v[64:67] offset:1024
  v_dot2c_f32_bf16 v20, v64, v9
  v_dot2c_f32_bf16 v21, v64, v64
  v_dot2c_f32_bf16 v20, v65, v9
  v_dot2c_f32_bf16 v21, v65, v65
  v_dot2c_f32_bf16 v20, v66, v9
  v_dot2c_f32_bf16 v21, v66, v66
  v_dot2c_f32_bf16 v20, v67, v9
  v_dot2c_f32_bf16 v21, v67, v67
  s_waitcnt vmcnt(4)
  ds_write_b128 v0, v[68:71] offset:2048
  v_dot2c_f32_bf16 v20, v68, v9
  v_dot2c_f32_bf16 v21, v68, v68
  v_dot2c_f32_bf16 v20, v69, v9
  v_dot2c_f32_bf16 v21, v69, v69
  v_dot2c_f32_bf16 v20, v70, v9
  v_dot2c_f32_bf16 v21, v70, v70
  v_dot2c_f32_bf16 v20, v71, v9
  v_dot2c_f32_bf16 v21, v71, v71
  s_waitcnt vmcnt(3)
  ds_write_b128 v0, v[72:75] offset:3072
  v_dot2c_f32_bf16 v20, v72, v9
  v_dot2c_f32_bf16 v21, v72, v72
  v_dot2c_f32_bf16 v20, v73, v9
  v_dot2c_f32_bf16 v21, v73, v73
  v_dot2c_f32_bf16 v20, v74, v9
  v_dot2c_f32_bf16 v21, v74, v74
  v_dot2c_f32_bf16 v20, v75, v9
  v_dot2c_f32_bf16 v21, v75, v75
  s_waitcnt vmcnt(2)
  ds_write_b128 v0, v[76:79] offset:4096
  v_dot2c_f32_bf16 v20, v76, v9
  v_dot2c_f32_bf16 v21, v76, v76
  v_dot2c_f32_bf16 v20, v77, v9
  v_dot2c_f32_bf16 v21, v77, v77
  v_dot2c_f32_bf16 v20, v78, v9
  v_dot2c_f32_bf16 v21, v78, v78
  v_dot2c_f32_bf16 v20, v79, v9
  v_dot2c_f32_bf16 v21, v79, v79
  s_waitcnt vmcnt(1)
  ds_write_b128 v0, v[80:83] offset:5120
  v_dot2c_f32_bf16 v20, v80, v9
  v_dot2c_f32_bf16 v21, v80, v80
  v_dot2c_f32_bf16 v20, v81, v9
  v_dot2c_f32_bf16 v21, v81, v81
  v_dot2c_f32_bf16 v20, v82, v9
  v_dot2c_f32_bf16 v21, v82, v82
  v_dot2c_f32_bf16 v20, v83, v9
  v_dot2c_f32_bf16 v21, v83, v83
  s_waitcnt vmcnt(0)
  ds_write_b128 v0, v[84:87] offset:6144
  v_dot2c_f32_bf16 v20, v84, v9
  v_dot2c_f32_bf16 v21, v84, v84
  v_dot2c_f32_bf16 v20, v85, v9
  v_dot2c_f32_bf16 v21, v85, v85
  v_dot2c_f32_bf16 v20, v86, v9
  v_dot2c_f32_bf16 v21, v86, v86
  v_dot2c_f32_bf16 v20, v87, v9
  v_dot2c_f32_bf16 v21, v87, v87
  v_max3_u32 v8, v60, v64, v68
  v_max3_u32 v8, v8, v72, v76
  v_max3_u32 v8, v8, v80, v84
  v_cmp_eq_u32 vcc, -1, v8
  s_waitcnt lgkmcnt(0)
  s_cbranch_vccnz stg_170
  v_bfe_u32 v8, v1, 2, 7
  s_lshl_b32 s19, s8, 8
  s_add_u32 s19, s19, 74752
  v_add_u32 v8, s19, v8
  v_mov_b64 v[22:23], v[20:21]
  s_nop 1
  v_permlane32_swap_b32 v22, v20
  v_permlane32_swap_b32 v23, v21
  v_pk_add_f32 v[20:21], v[20:21], v[22:23]
  ds_write2_b32 v8, v20, v21 offset0:0 offset1:32
  s_waitcnt lgkmcnt(0)
  s_barrier
  v_bfe_u32 v0, v1, 2, 6
  v_add_u32 v0, 74752, v0
  ds_read2_b32 v[36:37], v0 offset0:0 offset1:16
  ds_read2_b32 v[38:39], v0 offset0:64 offset1:80
  ds_read2_b32 v[40:41], v0 offset0:128 offset1:144
  ds_read2_b32 v[42:43], v0 offset0:192 offset1:208
  ds_read2_b32 v[44:45], v0 offset0:32 offset1:48
  ds_read2_b32 v[46:47], v0 offset0:96 offset1:112
  ds_read2_b32 v[48:49], v0 offset0:160 offset1:176
  ds_read2_b32 v[50:51], v0 offset0:224 offset1:240
  ds_read_b128 v[24:27], v7 offset:4096
  ds_read_b128 v[28:31], v7 offset:5120
  ds_read_b128 v[60:63], v2 offset:0
  ds_read_b128 v[64:67], v2 offset:2048
  ds_read_b128 v[68:71], v2 offset:4096
  ds_read_b128 v[72:75], v2 offset:6144
  ds_read_b128 v[76:79], v2 offset:8192
  s_waitcnt lgkmcnt(11)
  v_pk_add_f32 v[36:37], v[36:37], v[38:39]
  v_pk_add_f32 v[40:41], v[40:41], v[42:43]
  v_pk_add_f32 v[36:37], v[36:37], v[40:41]
  s_waitcnt lgkmcnt(7)
  v_pk_add_f32 v[44:45], v[44:45], v[46:47]
  v_pk_add_f32 v[48:49], v[48:49], v[50:51]
  v_pk_add_f32 v[44:45], v[44:45], v[48:49]
  v_mul_f32 v36, 0xbb124925, v36
  v_mul_f32 v44, 0x3b124925, v44
  v_mul_f32 v37, 0xbb124925, v37
  v_mul_f32 v45, 0x3b124925, v45
  v_cmp_u_f32 vcc, v44, v45
  v_pk_fma_f32 v[44:45], v[36:37], v[36:37], v[44:45] neg_lo:[1,0,0] neg_hi:[1,0,0]
  v_max_f32 v44, 0, v44
  v_max_f32 v45, 0, v45
  v_mul_f32 v44, 0x3f800054, v44
  v_mul_f32 v45, 0x3f800054, v45
  v_add_f32 v44, 0x2edbe6ff, v44
  v_add_f32 v45, 0x2edbe6ff, v45
  v_rsq_f32 v40, v44
  v_rsq_f32 v41, v45
  s_nop 0
  v_pk_mul_f32 v[14:15], v[44:45], v[40:41]
  v_mul_f32 v10, 0xc0135761, v40
  v_mul_f32 v11, 0xc0135761, v41
  v_cndmask_b32 v36, v14, v36, s[60:61]
  v_cndmask_b32 v37, v15, v37, s[60:61]
  v_pk_mul_f32 v[40:41], v[40:41], v[40:41]
  v_and_b32 v44, 0xffff0000, v36
  v_and_b32 v45, 0xffff0000, v37
  v_pk_mul_f32 v[40:41], v[40:41], v[10:11]
  v_pk_add_f32 v[36:37], v[36:37], v[44:45] neg_lo:[0,1] neg_hi:[0,1]
  v_mul_f32 v12, 0x3d372713, v40
  v_mul_f32 v13, 0x3d372713, v41
  v_cvt_pk_bf16_f32 v16, v44, v36
  v_cvt_pk_bf16_f32 v17, v44, v36
  v_cvt_pk_bf16_f32 v18, v45, v37
  v_cvt_pk_bf16_f32 v19, v45, v37
P_body:
  s_mov_b32 s21, s45
  s_mov_b32 s16, s44
  s_bitcmp1_b32 s8, 0
  s_waitcnt lgkmcnt(0)
  s_cbranch_scc1 P_odd
  v_mfma_f32_16x16x16_bf16 v[32:35], v[24:25], v[16:17], 0
  s_and_b32 s19, s17, 1
  v_mfma_f32_16x16x16_bf16 v[36:39], v[26:27], v[16:17], 0
  s_lshl_b32 s20, s23, 1
  v_mfma_f32_16x16x16_bf16 v[40:43], v[28:29], v[16:17], 0
  s_add_u32 s19, s19, s20
  v_mfma_f32_16x16x16_bf16 v[44:47], v[30:31], v[16:17], 0
  s_mul_i32 s13, s19, 229376
  v_mfma_f32_16x16x16_bf16 v[48:51], v[24:25], v[18:19], 0
  s_mul_i32 s19, s8, 896
  v_mfma_f32_16x16x16_bf16 v[52:55], v[26:27], v[18:19], 0
  s_add_u32 s13, s13, s19
  v_mfma_f32_16x16x16_bf16 v[56:59], v[28:29], v[18:19], 0
  s_add_u32 s13, s13, 19922944
  v_mfma_f32_16x16x32_bf16 v[32:35], a[0:3], v[60:63], v[32:35]
  ds_read_b128 v[80:83], v2 offset:10240
  v_mfma_f32_16x16x32_bf16 v[36:39], a[56:59], v[60:63], v[36:39]
  s_add_u32 s18, s18, s22
  v_mfma_f32_16x16x32_bf16 v[32:35], a[4:7], v[64:67], v[32:35]
  ds_read_b128 v[84:87], v2 offset:12288
  v_mfma_f32_16x16x32_bf16 v[36:39], a[60:63], v[64:67], v[36:39]
  s_and_b32 s45, s47, 1
  v_mfma_f32_16x16x32_bf16 v[32:35], a[8:11], v[68:71], v[32:35]
  ds_read_b128 v[60:63], v2 offset:14336
  v_mfma_f32_16x16x32_bf16 v[36:39], a[64:67], v[68:71], v[36:39]
  s_cselect_b64 s[56:57], s[50:51], s[48:49]
  v_mfma_f32_16x16x32_bf16 v[32:35], a[12:15], v[72:75], v[32:35]
  ds_read_b128 v[64:67], v2 offset:16384
  v_mfma_f32_16x16x32_bf16 v[36:39], a[68:71], v[72:75], v[36:39]
  s_ff1_i32_b64 s44, s[56:57]
  v_mfma_f32_16x16x32_bf16 v[32:35], a[16:19], v[76:79], v[32:35]
  ds_read_b128 v[68:71], v2 offset:18432
  v_mfma_f32_16x16x32_bf16 v[36:39], a[72:75], v[76:79], v[36:39]
  s_waitcnt lgkmcnt(4)
  s_bitset0_b64 s[56:57], s44
  v_mfma_f32_16x16x32_bf16 v[32:35], a[20:23], v[80:83], v[32:35]
  ds_read_b128 v[72:75], v2 offset:20480
  v_mfma_f32_16x16x32_bf16 v[36:39], a[76:79], v[80:83], v[36:39]
  s_waitcnt lgkmcnt(4)
  s_cselect_b64 s[50:51], s[56:57], s[50:51]
  v_mfma_f32_16x16x32_bf16 v[32:35], a[24:27], v[84:87], v[32:35]
  ds_read_b128 v[76:79], v2 offset:22528
  v_mfma_f32_16x16x32_bf16 v[36:39], a[80:83], v[84:87], v[36:39]
  s_waitcnt lgkmcnt(4)
  s_cselect_b64 s[48:49], s[48:49], s[56:57]
  v_mfma_f32_16x16x32_bf16 v[32:35], a[28:31], v[60:63], v[32:35]
  ds_read_b128 v[80:83], v2 offset:24576
  v_mfma_f32_16x16x32_bf16 v[36:39], a[84:87], v[60:63], v[36:39]
  s_waitcnt lgkmcnt(4)
  s_lshr_b32 s47, s47, 1
  v_mfma_f32_16x16x32_bf16 v[32:35], a[32:35], v[64:67], v[32:35]
  ds_read_b128 v[84:87], v2 offset:26624
  v_mfma_f32_16x16x32_bf16 v[36:39], a[88:91], v[64:67], v[36:39]
  s_waitcnt lgkmcnt(4)
  s_max_i32 s12, s44, 0
  v_mfma_f32_16x16x32_bf16 v[32:35], a[36:39], v[68:71], v[32:35]
  ds_read_b128 v[60:63], v2 offset:0
  v_mfma_f32_16x16x32_bf16 v[36:39], a[92:95], v[68:71], v[36:39]
  s_waitcnt lgkmcnt(4)
  s_lshl_b32 s19, s45, 6
  v_mfma_f32_16x16x32_bf16 v[32:35], a[40:43], v[72:75], v[32:35]
  ds_read_b128 v[64:67], v2 offset:2048
  v_mfma_f32_16x16x32_bf16 v[36:39], a[96:99], v[72:75], v[36:39]
  s_waitcnt lgkmcnt(4)
  s_add_u32 s19, s19, s12
  v_mfma_f32_16x16x32_bf16 v[32:35], a[44:47], v[76:79], v[32:35]
  ds_read_b128 v[68:71], v2 offset:4096
  v_mfma_f32_16x16x32_bf16 v[36:39], a[100:103], v[76:79], v[36:39]
  s_waitcnt lgkmcnt(4)
  s_mul_i32 s12, s19, 28672
  v_mfma_f32_16x16x32_bf16 v[32:35], a[48:51], v[80:83], v[32:35]
  ds_read_b128 v[72:75], v2 offset:6144
  v_mfma_f32_16x16x32_bf16 v[36:39], a[104:107], v[80:83], v[36:39]
  s_waitcnt lgkmcnt(4)
  s_add_u32 s12, s12, 36175872
  v_mfma_f32_16x16x32_bf16 v[32:35], a[52:55], v[84:87], v[32:35]
  ds_read_b128 v[76:79], v2 offset:8192
  s_mul_i32 s26, s10, 3584
  v_mfma_f32_16x16x32_bf16 v[36:39], a[108:111], v[84:87], v[36:39]
  s_waitcnt lgkmcnt(4)
  s_add_u32 s26, s26, s13
  s_add_u32 s20, s26, 114688
  v_mfma_f32_16x16x32_bf16 v[40:43], a[112:115], v[60:63], v[40:43]
  ds_read_b128 v[80:83], v2 offset:10240
  v_mul_f32 v20, v32, v32
  v_mfma_f32_16x16x32_bf16 v[44:47], a[168:171], v[60:63], v[44:47]
  s_waitcnt lgkmcnt(4)
  v_mul_f32 v21, v33, v33
  v_mul_f32 v22, v34, v34
  v_mul_f32 v23, v35, v35
  v_mfma_f32_16x16x32_bf16 v[40:43], a[116:119], v[64:67], v[40:43]
  ds_read_b128 v[84:87], v2 offset:12288
  v_fma_f32 v20, v20, v12, v10
  v_mfma_f32_16x16x32_bf16 v[44:47], a[172:175], v[64:67], v[44:47]
  s_waitcnt lgkmcnt(4)
  v_fma_f32 v21, v21, v12, v10
  v_fma_f32 v22, v22, v12, v10
  v_fma_f32 v23, v23, v12, v10
  v_mfma_f32_16x16x32_bf16 v[40:43], a[120:123], v[68:71], v[40:43]
  ds_read_b128 v[60:63], v2 offset:14336
  v_mul_f32 v20, v20, v32
  v_mul_f32 v21, v21, v33
  v_mfma_f32_16x16x32_bf16 v[44:47], a[176:179], v[68:71], v[44:47]
  s_waitcnt lgkmcnt(4)
  v_mul_f32 v22, v22, v34
  v_mul_f32 v23, v23, v35
  v_mfma_f32_16x16x32_bf16 v[40:43], a[124:127], v[72:75], v[40:43]
  ds_read_b128 v[64:67], v2 offset:16384
  v_exp_f32 v20, v20
  v_mfma_f32_16x16x32_bf16 v[44:47], a[180:183], v[72:75], v[44:47]
  s_waitcnt lgkmcnt(4)
  v_exp_f32 v21, v21
  v_mfma_f32_16x16x32_bf16 v[40:43], a[128:131], v[76:79], v[40:43]
  ds_read_b128 v[68:71], v2 offset:18432
  v_exp_f32 v22, v22
  v_mfma_f32_16x16x32_bf16 v[44:47], a[184:187], v[76:79], v[44:47]
  s_waitcnt lgkmcnt(4)
  v_exp_f32 v23, v23
  v_fma_f32 v20, v20, v14, v14
  v_mfma_f32_16x16x32_bf16 v[40:43], a[132:135], v[80:83], v[40:43]
  ds_read_b128 v[72:75], v2 offset:20480
  v_fma_f32 v21, v21, v14, v14
  v_fma_f32 v22, v22, v14, v14
  v_mfma_f32_16x16x32_bf16 v[44:47], a[188:191], v[80:83], v[44:47]
  s_waitcnt lgkmcnt(4)
  v_fma_f32 v23, v23, v14, v14
  v_mfma_f32_16x16x32_bf16 v[40:43], a[136:139], v[84:87], v[40:43]
  ds_read_b128 v[76:79], v2 offset:22528
  v_rcp_f32 v20, v20
  v_mfma_f32_16x16x32_bf16 v[44:47], a[192:195], v[84:87], v[44:47]
  s_waitcnt lgkmcnt(4)
  v_rcp_f32 v21, v21
  v_mfma_f32_16x16x32_bf16 v[40:43], a[140:143], v[60:63], v[40:43]
  ds_read_b128 v[80:83], v2 offset:24576
  v_rcp_f32 v22, v22
  v_mfma_f32_16x16x32_bf16 v[44:47], a[196:199], v[60:63], v[44:47]
  s_waitcnt lgkmcnt(4)
  v_rcp_f32 v23, v23
  v_add_u32 v0, s40, v4
  v_mfma_f32_16x16x32_bf16 v[40:43], a[144:147], v[64:67], v[40:43]
  ds_read_b128 v[84:87], v2 offset:26624
  v_mul_f32 v32, v32, v20
  v_mul_f32 v33, v33, v21
  v_mfma_f32_16x16x32_bf16 v[44:47], a[200:203], v[64:67], v[44:47]
  s_waitcnt lgkmcnt(4)
  v_mul_f32 v34, v34, v22
  v_mul_f32 v35, v35, v23
  v_cvt_pk_bf16_f32 v32, v32, v33
  v_mfma_f32_16x16x32_bf16 v[40:43], a[148:151], v[68:71], v[40:43]
  ds_read_b128 v[60:63], v2 offset:256
  v_cvt_pk_bf16_f32 v33, v34, v35
  v_mfma_f32_16x16x32_bf16 v[44:47], a[204:207], v[68:71], v[44:47]
  s_waitcnt lgkmcnt(4)
  ds_write_b64 v0, v[32:33] offset:0
  v_mul_f32 v20, v36, v36
  v_mul_f32 v21, v37, v37
  v_mfma_f32_16x16x32_bf16 v[40:43], a[152:155], v[72:75], v[40:43]
  ds_read_b128 v[64:67], v2 offset:2304
  v_mul_f32 v22, v38, v38
  v_mul_f32 v23, v39, v39
  v_mfma_f32_16x16x32_bf16 v[44:47], a[208:211], v[72:75], v[44:47]
  s_waitcnt lgkmcnt(5)
  v_fma_f32 v20, v20, v12, v10
  v_fma_f32 v21, v21, v12, v10
  v_mfma_f32_16x16x32_bf16 v[40:43], a[156:159], v[76:79], v[40:43]
  ds_read_b128 v[68:71], v2 offset:4352
  v_fma_f32 v22, v22, v12, v10
  v_fma_f32 v23, v23, v12, v10
  v_mfma_f32_16x16x32_bf16 v[44:47], a[212:215], v[76:79], v[44:47]
  s_waitcnt lgkmcnt(5)
  v_mul_f32 v20, v20, v36
  v_mul_f32 v21, v21, v37
  v_mul_f32 v22, v22, v38
  v_mfma_f32_16x16x32_bf16 v[40:43], a[160:163], v[80:83], v[40:43]
  ds_read_b128 v[72:75], v2 offset:6400
  v_mul_f32 v23, v23, v39
  v_mfma_f32_16x16x32_bf16 v[44:47], a[216:219], v[80:83], v[44:47]
  s_waitcnt lgkmcnt(5)
  v_exp_f32 v20, v20
  v_exp_f32 v21, v21
  v_mfma_f32_16x16x32_bf16 v[40:43], a[164:167], v[84:87], v[40:43]
  ds_read_b128 v[76:79], v2 offset:8448
  v_mfma_f32_16x16x32_bf16 v[44:47], a[220:223], v[84:87], v[44:47]
  s_waitcnt lgkmcnt(5)
  v_exp_f32 v22, v22
  v_exp_f32 v23, v23
  v_mfma_f32_16x16x32_bf16 v[48:51], a[0:3], v[60:63], v[48:51]
  ds_read_b128 v[80:83], v2 offset:10496
  v_fma_f32 v20, v20, v14, v14
  v_mfma_f32_16x16x32_bf16 v[52:55], a[56:59], v[60:63], v[52:55]
  v_fma_f32 v21, v21, v14, v14
  v_fma_f32 v22, v22, v14, v14
  v_fma_f32 v23, v23, v14, v14
  v_mfma_f32_16x16x32_bf16 v[56:59], a[112:115], v[60:63], v[56:59]
  s_waitcnt lgkmcnt(4)
  v_rcp_f32 v20, v20
  v_mfma_f32_16x16x32_bf16 v[48:51], a[4:7], v[64:67], v[48:51]
  ds_read_b128 v[84:87], v2 offset:12544
  v_rcp_f32 v21, v21
  v_mfma_f32_16x16x32_bf16 v[52:55], a[60:63], v[64:67], v[52:55]
  v_rcp_f32 v22, v22
  v_rcp_f32 v23, v23
  v_mfma_f32_16x16x32_bf16 v[56:59], a[116:119], v[64:67], v[56:59]
  s_waitcnt lgkmcnt(4)
  v_add_u32 v0, s41, v4
  v_mul_f32 v36, v36, v20
  v_mul_f32 v37, v37, v21
  v_mfma_f32_16x16x32_bf16 v[48:51], a[8:11], v[68:71], v[48:51]
  ds_read_b128 v[60:63], v2 offset:14592
  v_mul_f32 v38, v38, v22
  v_mul_f32 v39, v39, v23
  v_mfma_f32_16x16x32_bf16 v[52:55], a[64:67], v[68:71], v[52:55]
  v_cvt_pk_bf16_f32 v36, v36, v37
  v_cvt_pk_bf16_f32 v37, v38, v39
  v_mfma_f32_16x16x32_bf16 v[56:59], a[120:123], v[68:71], v[56:59]
  s_waitcnt lgkmcnt(4)
  ds_write_b64 v0, v[36:37] offset:0
  v_mul_f32 v20, v40, v40
  v_mul_f32 v21, v41, v41
  v_mul_f32 v22, v42, v42
  v_mfma_f32_16x16x32_bf16 v[48:51], a[12:15], v[72:75], v[48:51]
  ds_read_b128 v[64:67], v2 offset:16640
  v_mul_f32 v23, v43, v43
  v_fma_f32 v20, v20, v12, v10
  v_mfma_f32_16x16x32_bf16 v[52:55], a[68:71], v[72:75], v[52:55]
  v_fma_f32 v21, v21, v12, v10
  v_fma_f32 v22, v22, v12, v10
  v_fma_f32 v23, v23, v12, v10
  v_mfma_f32_16x16x32_bf16 v[56:59], a[124:127], v[72:75], v[56:59]
  s_waitcnt lgkmcnt(5)
  v_mul_f32 v20, v20, v40
  v_mul_f32 v21, v21, v41
  v_mul_f32 v22, v22, v42
  v_mfma_f32_16x16x32_bf16 v[48:51], a[16:19], v[76:79], v[48:51]
  ds_read_b128 v[68:71], v2 offset:18688
  v_mul_f32 v23, v23, v43
  v_mfma_f32_16x16x32_bf16 v[52:55], a[72:75], v[76:79], v[52:55]
  v_exp_f32 v20, v20
  v_exp_f32 v21, v21
  v_mfma_f32_16x16x32_bf16 v[56:59], a[128:131], v[76:79], v[56:59]
  s_waitcnt lgkmcnt(5)
  v_exp_f32 v22, v22
  v_mfma_f32_16x16x32_bf16 v[48:51], a[20:23], v[80:83], v[48:51]
  ds_read_b128 v[72:75], v2 offset:20736
  v_exp_f32 v23, v23
  v_fma_f32 v20, v20, v14, v14
  v_mfma_f32_16x16x32_bf16 v[52:55], a[76:79], v[80:83], v[52:55]
  v_fma_f32 v21, v21, v14, v14
  v_fma_f32 v22, v22, v14, v14
  v_fma_f32 v23, v23, v14, v14
  v_mfma_f32_16x16x32_bf16 v[56:59], a[132:135], v[80:83], v[56:59]
  s_waitcnt lgkmcnt(5)
  v_rcp_f32 v20, v20
  v_mfma_f32_16x16x32_bf16 v[48:51], a[24:27], v[84:87], v[48:51]
  ds_read_b128 v[76:79], v2 offset:22784
  v_rcp_f32 v21, v21
  v_mfma_f32_16x16x32_bf16 v[52:55], a[80:83], v[84:87], v[52:55]
  v_rcp_f32 v22, v22
  v_rcp_f32 v23, v23
  v_mfma_f32_16x16x32_bf16 v[56:59], a[136:139], v[84:87], v[56:59]
  s_waitcnt lgkmcnt(5)
  v_add_u32 v0, s42, v4
  v_mul_f32 v40, v40, v20
  v_mul_f32 v41, v41, v21
  v_mfma_f32_16x16x32_bf16 v[48:51], a[28:31], v[60:63], v[48:51]
  ds_read_b128 v[80:83], v2 offset:24832
  v_mul_f32 v42, v42, v22
  v_mul_f32 v43, v43, v23
  v_mfma_f32_16x16x32_bf16 v[52:55], a[84:87], v[60:63], v[52:55]
  v_cvt_pk_bf16_f32 v40, v40, v41
  v_cvt_pk_bf16_f32 v41, v42, v43
  v_mfma_f32_16x16x32_bf16 v[56:59], a[140:143], v[60:63], v[56:59]
  s_waitcnt lgkmcnt(4)
  ds_write_b64 v0, v[40:41] offset:0
  v_mul_f32 v20, v44, v44
  v_mul_f32 v21, v45, v45
  v_mul_f32 v22, v46, v46
  v_mfma_f32_16x16x32_bf16 v[48:51], a[32:35], v[64:67], v[48:51]
  ds_read_b128 v[84:87], v2 offset:26880
  v_mul_f32 v23, v47, v47
  v_fma_f32 v20, v20, v12, v10
  v_mfma_f32_16x16x32_bf16 v[52:55], a[88:91], v[64:67], v[52:55]
  v_fma_f32 v21, v21, v12, v10
  v_fma_f32 v22, v22, v12, v10
  v_fma_f32 v23, v23, v12, v10
  v_mfma_f32_16x16x32_bf16 v[56:59], a[144:147], v[64:67], v[56:59]
  s_waitcnt lgkmcnt(5)
  v_mul_f32 v20, v20, v44
  v_mul_f32 v21, v21, v45
  v_mul_f32 v22, v22, v46
  v_mfma_f32_16x16x32_bf16 v[48:51], a[36:39], v[68:71], v[48:51]
  v_mul_f32 v23, v23, v47
  v_mfma_f32_16x16x32_bf16 v[52:55], a[92:95], v[68:71], v[52:55]
  v_exp_f32 v20, v20
  v_exp_f32 v21, v21
  v_mfma_f32_16x16x32_bf16 v[56:59], a[148:151], v[68:71], v[56:59]
  s_waitcnt lgkmcnt(4)
  v_exp_f32 v22, v22
  v_mfma_f32_16x16x32_bf16 v[48:51], a[40:43], v[72:75], v[48:51]
  v_exp_f32 v23, v23
  v_fma_f32 v20, v20, v14, v14
  v_fma_f32 v21, v21, v14, v14
  v_mfma_f32_16x16x32_bf16 v[52:55], a[96:99], v[72:75], v[52:55]
  v_fma_f32 v22, v22, v14, v14
  v_fma_f32 v23, v23, v14, v14
  v_mfma_f32_16x16x32_bf16 v[56:59], a[152:155], v[72:75], v[56:59]
  s_waitcnt lgkmcnt(3)
  v_rcp_f32 v20, v20
  v_mfma_f32_16x16x32_bf16 v[48:51], a[44:47], v[76:79], v[48:51]
  v_rcp_f32 v21, v21
  v_rcp_f32 v22, v22
  v_mfma_f32_16x16x32_bf16 v[52:55], a[100:103], v[76:79], v[52:55]
  v_rcp_f32 v23, v23
  v_mfma_f32_16x16x32_bf16 v[56:59], a[156:159], v[76:79], v[56:59]
  s_waitcnt lgkmcnt(2)
  v_add_u32 v0, s43, v4
  v_mul_f32 v44, v44, v20
  v_mul_f32 v45, v45, v21
  v_mfma_f32_16x16x32_bf16 v[48:51], a[48:51], v[80:83], v[48:51]
  v_mul_f32 v46, v46, v22
  v_mul_f32 v47, v47, v23
  v_cvt_pk_bf16_f32 v44, v44, v45
  v_mfma_f32_16x16x32_bf16 v[52:55], a[104:107], v[80:83], v[52:55]
  v_cvt_pk_bf16_f32 v45, v46, v47
  ds_write_b64 v0, v[44:45] offset:0
  s_waitcnt lgkmcnt(0)
  s_barrier
  ds_read_b128 v[88:91], v4 offset:0
  v_mfma_f32_16x16x32_bf16 v[56:59], a[160:163], v[80:83], v[56:59]
  s_mov_b32 m0, s18
  s_nop 0
  buffer_load_dwordx4 v3, s[4:7], s12 offen offset:0 sc1 lds
  v_mfma_f32_16x16x32_bf16 v[48:51], a[52:55], v[84:87], v[48:51]
  buffer_load_dwordx4 v3, s[4:7], s12 offen offset:1024 sc1 lds
  v_mfma_f32_16x16x32_bf16 v[52:55], a[108:111], v[84:87], v[52:55]
  buffer_load_dwordx4 v3, s[4:7], s12 offen offset:2048 sc1 lds
  v_mfma_f32_16x16x32_bf16 v[56:59], a[164:167], v[84:87], v[56:59]
  s_waitcnt lgkmcnt(0)
  buffer_load_dwordx4 v3, s[4:7], s12 offen offset:3072 sc1 lds
  v_mfma_f32_16x16x32_bf16 v[60:63], a[224:227], v[88:91], 0
  ds_read_b128 v[28:31], v4 offset:1024
  s_add_u32 m0, s18, 4096
  s_add_u32 s19, s12, 4096
  buffer_load_dwordx4 v3, s[4:7], s19 offen offset:0 sc1 lds
  v_mfma_f32_16x16x32_bf16 v[64:67], a[252:255], v[88:91], 0
  ds_read_b128 v[24:27], v4 offset:2048
  v_mul_f32 v20, v48, v48
  v_mul_f32 v21, v49, v49
  v_mfma_f32_16x16x32_bf16 v[68:71], v[116:119], v[88:91], 0
  v_mul_f32 v22, v50, v50
  v_mul_f32 v23, v51, v51
  v_fma_f32 v20, v20, v13, v11
  v_mfma_f32_16x16x32_bf16 v[72:75], v[144:147], v[88:91], 0
  v_fma_f32 v21, v21, v13, v11
  v_fma_f32 v22, v22, v13, v11
  v_mfma_f32_16x16x32_bf16 v[76:79], v[172:175], v[88:91], 0
  v_fma_f32 v23, v23, v13, v11
  v_mfma_f32_16x16x32_bf16 v[80:83], v[200:203], v[88:91], 0
  buffer_load_dwordx4 v3, s[4:7], s19 offen offset:1024 sc1 lds
  v_mul_f32 v20, v20, v48
  v_mul_f32 v21, v21, v49
  v_mfma_f32_16x16x32_bf16 v[84:87], v[228:231], v[88:91], 0
  s_waitcnt lgkmcnt(1)
  v_mul_f32 v22, v22, v50
  v_mul_f32 v23, v23, v51
  v_mfma_f32_16x16x32_bf16 v[60:63], a[228:231], v[28:31], v[60:63]
  ds_read_b128 v[88:91], v4 offset:3072
  v_exp_f32 v20, v20
  v_mfma_f32_16x16x32_bf16 v[64:67], v[92:95], v[28:31], v[64:67]
  v_exp_f32 v21, v21
  v_mfma_f32_16x16x32_bf16 v[68:71], v[120:123], v[28:31], v[68:71]
  v_exp_f32 v22, v22
  v_mfma_f32_16x16x32_bf16 v[72:75], v[148:151], v[28:31], v[72:75]
  v_exp_f32 v23, v23
  v_mfma_f32_16x16x32_bf16 v[76:79], v[176:179], v[28:31], v[76:79]
  buffer_load_dwordx4 v3, s[4:7], s19 offen offset:2048 sc1 lds
  v_fma_f32 v20, v20, v15, v15
  v_fma_f32 v21, v21, v15, v15
  v_mfma_f32_16x16x32_bf16 v[80:83], v[204:207], v[28:31], v[80:83]
  v_fma_f32 v22, v22, v15, v15
  v_fma_f32 v23, v23, v15, v15
  v_mfma_f32_16x16x32_bf16 v[84:87], v[232:235], v[28:31], v[84:87]
  s_waitcnt lgkmcnt(1)
  v_rcp_f32 v20, v20
  v_mfma_f32_16x16x32_bf16 v[60:63], a[232:235], v[24:27], v[60:63]
  ds_read_b128 v[28:31], v4 offset:4096
  v_rcp_f32 v21, v21
  v_mfma_f32_16x16x32_bf16 v[64:67], v[96:99], v[24:27], v[64:67]
  v_rcp_f32 v22, v22
  v_mfma_f32_16x16x32_bf16 v[68:71], v[124:127], v[24:27], v[68:71]
  v_rcp_f32 v23, v23
  v_add_u32 v0, s40, v4
  v_mfma_f32_16x16x32_bf16 v[72:75], v[152:155], v[24:27], v[72:75]
  v_mul_f32 v48, v48, v20
  v_mul_f32 v49, v49, v21
  v_mul_f32 v50, v50, v22
  v_mfma_f32_16x16x32_bf16 v[76:79], v[180:183], v[24:27], v[76:79]
  v_mul_f32 v51, v51, v23
  v_cvt_pk_bf16_f32 v48, v48, v49
  v_cvt_pk_bf16_f32 v49, v50, v51
  v_mfma_f32_16x16x32_bf16 v[80:83], v[208:211], v[24:27], v[80:83]
  ds_write_b64 v0, v[48:49] offset:7168
  v_mul_f32 v20, v52, v52
  v_mul_f32 v21, v53, v53
  v_mfma_f32_16x16x32_bf16 v[84:87], v[236:239], v[24:27], v[84:87]
  s_waitcnt lgkmcnt(2)
  v_mul_f32 v22, v54, v54
  v_mul_f32 v23, v55, v55
  v_fma_f32 v20, v20, v13, v11
  v_mfma_f32_16x16x32_bf16 v[60:63], a[236:239], v[88:91], v[60:63]
  ds_read_b128 v[24:27], v4 offset:5120
  v_fma_f32 v21, v21, v13, v11
  v_fma_f32 v22, v22, v13, v11
  v_mfma_f32_16x16x32_bf16 v[64:67], v[100:103], v[88:91], v[64:67]
  v_fma_f32 v23, v23, v13, v11
  v_mul_f32 v20, v20, v52
  v_mfma_f32_16x16x32_bf16 v[68:71], v[128:131], v[88:91], v[68:71]
  v_mul_f32 v21, v21, v53
  v_mul_f32 v22, v22, v54
  v_mul_f32 v23, v23, v55
  v_mfma_f32_16x16x32_bf16 v[72:75], v[156:159], v[88:91], v[72:75]
  v_exp_f32 v20, v20
  v_mfma_f32_16x16x32_bf16 v[76:79], v[184:187], v[88:91], v[76:79]
  v_exp_f32 v21, v21
  v_mfma_f32_16x16x32_bf16 v[80:83], v[212:215], v[88:91], v[80:83]
  v_exp_f32 v22, v22
  v_mfma_f32_16x16x32_bf16 v[84:87], v[240:243], v[88:91], v[84:87]
  s_waitcnt lgkmcnt(2)
  v_exp_f32 v23, v23
  v_fma_f32 v20, v20, v15, v15
  v_mfma_f32_16x16x32_bf16 v[60:63], a[240:243], v[28:31], v[60:63]
  ds_read_b128 v[88:91], v4 offset:6144
  v_fma_f32 v21, v21, v15, v15
  v_fma_f32 v22, v22, v15, v15
  v_mfma_f32_16x16x32_bf16 v[64:67], v[104:107], v[28:31], v[64:67]
  v_fma_f32 v23, v23, v15, v15
  v_rcp_f32 v20, v20
  v_mfma_f32_16x16x32_bf16 v[68:71], v[132:135], v[28:31], v[68:71]
  v_rcp_f32 v21, v21
  v_mfma_f32_16x16x32_bf16 v[72:75], v[160:163], v[28:31], v[72:75]
  v_rcp_f32 v22, v22
  v_rcp_f32 v23, v23
  v_mfma_f32_16x16x32_bf16 v[76:79], v[188:191], v[28:31], v[76:79]
  v_add_u32 v0, s41, v4
  v_mul_f32 v52, v52, v20
  v_mfma_f32_16x16x32_bf16 v[80:83], v[216:219], v[28:31], v[80:83]
  v_mul_f32 v53, v53, v21
  v_mul_f32 v54, v54, v22
  v_mul_f32 v55, v55, v23
  v_mfma_f32_16x16x32_bf16 v[84:87], v[244:247], v[28:31], v[84:87]
  s_waitcnt lgkmcnt(1)
  v_cvt_pk_bf16_f32 v52, v52, v53
  v_cvt_pk_bf16_f32 v53, v54, v55
  v_mfma_f32_16x16x32_bf16 v[60:63], a[244:247], v[24:27], v[60:63]
  ds_write_b64 v0, v[52:53] offset:7168
  v_mul_f32 v20, v56, v56
  v_mul_f32 v21, v57, v57
  v_mul_f32 v22, v58, v58
  v_mfma_f32_16x16x32_bf16 v[64:67], v[108:111], v[24:27], v[64:67]
  v_mul_f32 v23, v59, v59
  v_fma_f32 v20, v20, v13, v11
  v_mfma_f32_16x16x32_bf16 v[68:71], v[136:139], v[24:27], v[68:71]
  v_fma_f32 v21, v21, v13, v11
  v_fma_f32 v22, v22, v13, v11
  v_fma_f32 v23, v23, v13, v11
  v_mfma_f32_16x16x32_bf16 v[72:75], v[164:167], v[24:27], v[72:75]
  v_mul_f32 v20, v20, v56
  v_mul_f32 v21, v21, v57
  v_mul_f32 v22, v22, v58
  v_mfma_f32_16x16x32_bf16 v[76:79], v[192:195], v[24:27], v[76:79]
  v_mul_f32 v23, v23, v59
  v_exp_f32 v20, v20
  v_mfma_f32_16x16x32_bf16 v[80:83], v[220:223], v[24:27], v[80:83]
  v_exp_f32 v21, v21
  v_mfma_f32_16x16x32_bf16 v[84:87], v[248:251], v[24:27], v[84:87]
  s_waitcnt lgkmcnt(1)
  v_exp_f32 v22, v22
  v_exp_f32 v23, v23
  v_mfma_f32_16x16x32_bf16 v[60:63], a[248:251], v[88:91], v[60:63]
  v_fma_f32 v20, v20, v15, v15
  v_fma_f32 v21, v21, v15, v15
  v_mfma_f32_16x16x32_bf16 v[64:67], v[112:115], v[88:91], v[64:67]
  v_fma_f32 v22, v22, v15, v15
  v_fma_f32 v23, v23, v15, v15
  v_mfma_f32_16x16x32_bf16 v[68:71], v[140:143], v[88:91], v[68:71]
  v_rcp_f32 v20, v20
  v_rcp_f32 v21, v21
  v_mfma_f32_16x16x32_bf16 v[72:75], v[168:171], v[88:91], v[72:75]
  v_rcp_f32 v22, v22
  v_mfma_f32_16x16x32_bf16 v[76:79], v[196:199], v[88:91], v[76:79]
  v_rcp_f32 v23, v23
  v_add_u32 v0, s42, v4
  v_mul_f32 v56, v56, v20
  v_mfma_f32_16x16x32_bf16 v[80:83], v[224:227], v[88:91], v[80:83]
  v_mul_f32 v57, v57, v21
  v_mul_f32 v58, v58, v22
  v_mul_f32 v59, v59, v23
  v_mfma_f32_16x16x32_bf16 v[84:87], v[252:255], v[88:91], v[84:87]
  v_cvt_pk_bf16_f32 v56, v56, v57
  v_cvt_pk_bf16_f32 v57, v58, v59
  ds_write_b64 v0, v[56:57] offset:7168
  s_waitcnt lgkmcnt(0)
  s_barrier
  ds_read_b128 v[88:91], v4 offset:7168
  ds_read_b128 v[28:31], v4 offset:8192
  s_waitcnt lgkmcnt(1)
  v_mfma_f32_16x16x32_bf16 v[32:35], a[224:227], v[88:91], 0
  ds_read_b128 v[24:27], v4 offset:9216
  v_cvt_pk_bf16_f32 v60, v60, v61
  v_mfma_f32_16x16x32_bf16 v[36:39], a[252:255], v[88:91], 0
  v_cvt_pk_bf16_f32 v61, v62, v63
  v_cvt_pk_bf16_f32 v62, v64, v65
  v_mfma_f32_16x16x32_bf16 v[40:43], v[116:119], v[88:91], 0
  v_cvt_pk_bf16_f32 v63, v66, v67
  v_mfma_f32_16x16x32_bf16 v[44:47], v[144:147], v[88:91], 0
  buffer_store_dwordx4 v[60:63], v5, s[4:7], s26 offen offset:0
  v_cvt_pk_bf16_f32 v68, v68, v69
  v_mfma_f32_16x16x32_bf16 v[48:51], v[172:175], v[88:91], 0
  v_cvt_pk_bf16_f32 v69, v70, v71
  v_cvt_pk_bf16_f32 v70, v72, v73
  v_mfma_f32_16x16x32_bf16 v[52:55], v[200:203], v[88:91], 0
  v_cvt_pk_bf16_f32 v71, v74, v75
  v_mfma_f32_16x16x32_bf16 v[56:59], v[228:231], v[88:91], 0
  s_waitcnt lgkmcnt(1)
  buffer_store_dwordx4 v[68:71], v5, s[4:7], s26 offen offset:256
  v_cvt_pk_bf16_f32 v76, v76, v77
  v_mfma_f32_16x16x32_bf16 v[32:35], a[228:231], v[28:31], v[32:35]
  ds_read_b128 v[88:91], v4 offset:10240
  v_cvt_pk_bf16_f32 v77, v78, v79
  v_mfma_f32_16x16x32_bf16 v[36:39], v[92:95], v[28:31], v[36:39]
  v_cvt_pk_bf16_f32 v78, v80, v81
  v_cvt_pk_bf16_f32 v79, v82, v83
  v_mfma_f32_16x16x32_bf16 v[40:43], v[120:123], v[28:31], v[40:43]
  buffer_store_dwordx4 v[76:79], v5, s[4:7], s26 offen offset:512
  v_cvt_pk_bf16_f32 v84, v84, v85
  v_mfma_f32_16x16x32_bf16 v[44:47], v[148:151], v[28:31], v[44:47]
  v_cvt_pk_bf16_f32 v85, v86, v87
  v_mfma_f32_16x16x32_bf16 v[48:51], v[176:179], v[28:31], v[48:51]
  buffer_store_dwordx2 v[84:85], v6, s[4:7], s26 offen offset:768
  v_mfma_f32_16x16x32_bf16 v[52:55], v[204:207], v[28:31], v[52:55]
  v_mfma_f32_16x16x32_bf16 v[56:59], v[232:235], v[28:31], v[56:59]
  s_waitcnt lgkmcnt(1)
  v_mfma_f32_16x16x32_bf16 v[32:35], a[232:235], v[24:27], v[32:35]
  ds_read_b128 v[28:31], v4 offset:11264
  v_mfma_f32_16x16x32_bf16 v[36:39], v[96:99], v[24:27], v[36:39]
  v_mfma_f32_16x16x32_bf16 v[40:43], v[124:127], v[24:27], v[40:43]
  v_mfma_f32_16x16x32_bf16 v[44:47], v[152:155], v[24:27], v[44:47]
  v_mfma_f32_16x16x32_bf16 v[48:51], v[180:183], v[24:27], v[48:51]
  v_mfma_f32_16x16x32_bf16 v[52:55], v[208:211], v[24:27], v[52:55]
  v_mfma_f32_16x16x32_bf16 v[56:59], v[236:239], v[24:27], v[56:59]
  s_waitcnt lgkmcnt(1)
  v_mfma_f32_16x16x32_bf16 v[32:35], a[236:239], v[88:91], v[32:35]
  ds_read_b128 v[24:27], v4 offset:12288
  v_mfma_f32_16x16x32_bf16 v[36:39], v[100:103], v[88:91], v[36:39]
  v_mfma_f32_16x16x32_bf16 v[40:43], v[128:131], v[88:91], v[40:43]
  v_mfma_f32_16x16x32_bf16 v[44:47], v[156:159], v[88:91], v[44:47]
  v_mfma_f32_16x16x32_bf16 v[48:51], v[184:187], v[88:91], v[48:51]
  v_mfma_f32_16x16x32_bf16 v[52:55], v[212:215], v[88:91], v[52:55]
  v_mfma_f32_16x16x32_bf16 v[56:59], v[240:243], v[88:91], v[56:59]
  s_waitcnt lgkmcnt(1)
  v_mfma_f32_16x16x32_bf16 v[32:35], a[240:243], v[28:31], v[32:35]
  ds_read_b128 v[88:91], v4 offset:13312
  v_mfma_f32_16x16x32_bf16 v[36:39], v[104:107], v[28:31], v[36:39]
  v_mfma_f32_16x16x32_bf16 v[40:43], v[132:135], v[28:31], v[40:43]
  v_mfma_f32_16x16x32_bf16 v[44:47], v[160:163], v[28:31], v[44:47]
  v_mfma_f32_16x16x32_bf16 v[48:51], v[188:191], v[28:31], v[48:51]
  v_mfma_f32_16x16x32_bf16 v[52:55], v[216:219], v[28:31], v[52:55]
  v_mfma_f32_16x16x32_bf16 v[56:59], v[244:247], v[28:31], v[56:59]
  s_waitcnt lgkmcnt(1)
  v_mfma_f32_16x16x32_bf16 v[32:35], a[244:247], v[24:27], v[32:35]
  s_waitcnt lgkmcnt(0)
  v_mfma_f32_16x16x32_bf16 v[32:35], a[248:251], v[88:91], v[32:35]
  v_mfma_f32_16x16x32_bf16 v[36:39], v[108:111], v[24:27], v[36:39]
  v_mfma_f32_16x16x32_bf16 v[36:39], v[112:115], v[88:91], v[36:39]
  v_mfma_f32_16x16x32_bf16 v[40:43], v[136:139], v[24:27], v[40:43]
  v_mfma_f32_16x16x32_bf16 v[40:43], v[140:143], v[88:91], v[40:43]
  v_cvt_pk_bf16_f32 v32, v32, v33
  v_cvt_pk_bf16_f32 v33, v34, v35
  v_mfma_f32_16x16x32_bf16 v[44:47], v[164:167], v[24:27], v[44:47]
  v_cvt_pk_bf16_f32 v34, v36, v37
  v_cvt_pk_bf16_f32 v35, v38, v39
  v_mfma_f32_16x16x32_bf16 v[44:47], v[168:171], v[88:91], v[44:47]
  buffer_store_dwordx4 v[32:35], v5, s[4:7], s20 offen offset:0
  v_mfma_f32_16x16x32_bf16 v[48:51], v[192:195], v[24:27], v[48:51]
  v_mfma_f32_16x16x32_bf16 v[48:51], v[196:199], v[88:91], v[48:51]
  v_cvt_pk_bf16_f32 v40, v40, v41
  v_cvt_pk_bf16_f32 v41, v42, v43
  v_mfma_f32_16x16x32_bf16 v[52:55], v[220:223], v[24:27], v[52:55]
  v_cvt_pk_bf16_f32 v42, v44, v45
  v_cvt_pk_bf16_f32 v43, v46, v47
  v_mfma_f32_16x16x32_bf16 v[52:55], v[224:227], v[88:91], v[52:55]
  buffer_store_dwordx4 v[40:43], v5, s[4:7], s20 offen offset:256
  v_mfma_f32_16x16x32_bf16 v[56:59], v[248:251], v[24:27], v[56:59]
  v_mfma_f32_16x16x32_bf16 v[56:59], v[252:255], v[88:91], v[56:59]
  v_cvt_pk_bf16_f32 v48, v48, v49
  v_cvt_pk_bf16_f32 v49, v50, v51
  v_cvt_pk_bf16_f32 v50, v52, v53
  v_cvt_pk_bf16_f32 v51, v54, v55
  buffer_store_dwordx4 v[48:51], v5, s[4:7], s20 offen offset:512
  s_nop 2
  v_cvt_pk_bf16_f32 v56, v56, v57
  v_cvt_pk_bf16_f32 v57, v58, v59
  buffer_store_dwordx2 v[56:57], v6, s[4:7], s20 offen offset:768
  s_branch P_red
P_odd:
  v_mfma_f32_16x16x16_bf16 v[32:35], v[24:25], v[16:17], 0
  s_and_b32 s19, s17, 1
  v_mfma_f32_16x16x16_bf16 v[36:39], v[26:27], v[16:17], 0
  s_lshl_b32 s20, s23, 1
  v_mfma_f32_16x16x16_bf16 v[40:43], v[28:29], v[16:17], 0
  s_add_u32 s19, s19, s20
  v_mfma_f32_16x16x16_bf16 v[44:47], v[30:31], v[18:19], 0
  s_mul_i32 s13, s19, 229376
  v_mfma_f32_16x16x16_bf16 v[48:51], v[24:25], v[18:19], 0
  s_mul_i32 s19, s8, 896
  v_mfma_f32_16x16x16_bf16 v[52:55], v[26:27], v[18:19], 0
  s_add_u32 s13, s13, s19
  v_mfma_f32_16x16x16_bf16 v[56:59], v[28:29], v[18:19], 0
  s_add_u32 s13, s13, 19922944
  v_mfma_f32_16x16x32_bf16 v[32:35], a[0:3], v[60:63], v[32:35]
  ds_read_b128 v[80:83], v2 offset:10240
  v_mfma_f32_16x16x32_bf16 v[36:39], a[56:59], v[60:63], v[36:39]
  s_add_u32 s18, s18, s22
  v_mfma_f32_16x16x32_bf16 v[32:35], a[4:7], v[64:67], v[32:35]
  ds_read_b128 v[84:87], v2 offset:12288
  v_mfma_f32_16x16x32_bf16 v[36:39], a[60:63], v[64:67], v[36:39]
  s_and_b32 s45, s47, 1
  v_mfma_f32_16x16x32_bf16 v[32:35], a[8:11], v[68:71], v[32:35]
  ds_read_b128 v[60:63], v2 offset:14336
  v_mfma_f32_16x16x32_bf16 v[36:39], a[64:67], v[68:71], v[36:39]
  s_cselect_b64 s[56:57], s[50:51], s[48:49]
  v_mfma_f32_16x16x32_bf16 v[32:35], a[12:15], v[72:75], v[32:35]
  ds_read_b128 v[64:67], v2 offset:16384
  v_mfma_f32_16x16x32_bf16 v[36:39], a[68:71], v[72:75], v[36:39]
  s_ff1_i32_b64 s44, s[56:57]
  v_mfma_f32_16x16x32_bf16 v[32:35], a[16:19], v[76:79], v[32:35]
  ds_read_b128 v[68:71], v2 offset:18432
  v_mfma_f32_16x16x32_bf16 v[36:39], a[72:75], v[76:79], v[36:39]
  s_waitcnt lgkmcnt(4)
  s_bitset0_b64 s[56:57], s44
  v_mfma_f32_16x16x32_bf16 v[32:35], a[20:23], v[80:83], v[32:35]
  ds_read_b128 v[72:75], v2 offset:20480
  v_mfma_f32_16x16x32_bf16 v[36:39], a[76:79], v[80:83], v[36:39]
  s_waitcnt lgkmcnt(4)
  s_cselect_b64 s[50:51], s[56:57], s[50:51]
  v_mfma_f32_16x16x32_bf16 v[32:35], a[24:27], v[84:87], v[32:35]
  ds_read_b128 v[76:79], v2 offset:22528
  v_mfma_f32_16x16x32_bf16 v[36:39], a[80:83], v[84:87], v[36:39]
  s_waitcnt lgkmcnt(4)
  s_cselect_b64 s[48:49], s[48:49], s[56:57]
  v_mfma_f32_16x16x32_bf16 v[32:35], a[28:31], v[60:63], v[32:35]
  ds_read_b128 v[80:83], v2 offset:24576
  v_mfma_f32_16x16x32_bf16 v[36:39], a[84:87], v[60:63], v[36:39]
  s_waitcnt lgkmcnt(4)
  s_lshr_b32 s47, s47, 1
  v_mfma_f32_16x16x32_bf16 v[32:35], a[32:35], v[64:67], v[32:35]
  ds_read_b128 v[84:87], v2 offset:26624
  v_mfma_f32_16x16x32_bf16 v[36:39], a[88:91], v[64:67], v[36:39]
  s_waitcnt lgkmcnt(4)
  s_max_i32 s12, s44, 0
  v_mfma_f32_16x16x32_bf16 v[32:35], a[36:39], v[68:71], v[32:35]
  ds_read_b128 v[60:63], v2 offset:0
  v_mfma_f32_16x16x32_bf16 v[36:39], a[92:95], v[68:71], v[36:39]
  s_waitcnt lgkmcnt(4)
  s_lshl_b32 s19, s45, 6
  v_mfma_f32_16x16x32_bf16 v[32:35], a[40:43], v[72:75], v[32:35]
  ds_read_b128 v[64:67], v2 offset:256
  v_mfma_f32_16x16x32_bf16 v[36:39], a[96:99], v[72:75], v[36:39]
  s_waitcnt lgkmcnt(4)
  s_add_u32 s19, s19, s12
  v_mfma_f32_16x16x32_bf16 v[32:35], a[44:47], v[76:79], v[32:35]
  ds_read_b128 v[68:71], v2 offset:2048
  v_mfma_f32_16x16x32_bf16 v[36:39], a[100:103], v[76:79], v[36:39]
  s_waitcnt lgkmcnt(4)
  s_mul_i32 s12, s19, 28672
  v_mfma_f32_16x16x32_bf16 v[32:35], a[48:51], v[80:83], v[32:35]
  ds_read_b128 v[72:75], v2 offset:2304
  v_mfma_f32_16x16x32_bf16 v[36:39], a[104:107], v[80:83], v[36:39]
  s_waitcnt lgkmcnt(4)
  s_add_u32 s12, s12, 36175872
  v_mfma_f32_16x16x32_bf16 v[32:35], a[52:55], v[84:87], v[32:35]
  ds_read_b128 v[76:79], v2 offset:4096
  s_mul_i32 s26, s10, 3584
  v_mfma_f32_16x16x32_bf16 v[36:39], a[108:111], v[84:87], v[36:39]
  s_waitcnt lgkmcnt(4)
  s_add_u32 s26, s26, s13
  s_add_u32 s20, s26, 114688
  v_mfma_f32_16x16x32_bf16 v[40:43], a[112:115], v[60:63], v[40:43]
  s_waitcnt lgkmcnt(3)
  ds_read_b128 v[80:83], v2 offset:4352
  v_mul_f32 v20, v32, v32
  v_mul_f32 v21, v33, v33
  v_mfma_f32_16x16x32_bf16 v[44:47], a[168:171], v[64:67], v[44:47]
  s_waitcnt lgkmcnt(3)
  ds_read_b128 v[84:87], v2 offset:6144
  v_mul_f32 v22, v34, v34
  v_mul_f32 v23, v35, v35
  v_mfma_f32_16x16x32_bf16 v[40:43], a[116:119], v[68:71], v[40:43]
  s_waitcnt lgkmcnt(3)
  ds_read_b128 v[60:63], v2 offset:6400
  v_fma_f32 v20, v20, v12, v10
  v_fma_f32 v21, v21, v12, v10
  v_mfma_f32_16x16x32_bf16 v[44:47], a[172:175], v[72:75], v[44:47]
  s_waitcnt lgkmcnt(3)
  ds_read_b128 v[64:67], v2 offset:8192
  v_fma_f32 v22, v22, v12, v10
  v_fma_f32 v23, v23, v12, v10
  v_mfma_f32_16x16x32_bf16 v[40:43], a[120:123], v[76:79], v[40:43]
  s_waitcnt lgkmcnt(3)
  ds_read_b128 v[68:71], v2 offset:8448
  v_mul_f32 v20, v20, v32
  v_mul_f32 v21, v21, v33
  v_mfma_f32_16x16x32_bf16 v[44:47], a[176:179], v[80:83], v[44:47]
  s_waitcnt lgkmcnt(3)
  ds_read_b128 v[72:75], v2 offset:10240
  v_mul_f32 v22, v22, v34
  v_mul_f32 v23, v23, v35
  v_mfma_f32_16x16x32_bf16 v[40:43], a[124:127], v[84:87], v[40:43]
  s_waitcnt lgkmcnt(3)
  ds_read_b128 v[76:79], v2 offset:10496
  v_exp_f32 v20, v20
  v_mfma_f32_16x16x32_bf16 v[44:47], a[180:183], v[60:63], v[44:47]
  s_waitcnt lgkmcnt(3)
  ds_read_b128 v[80:83], v2 offset:12288
  v_exp_f32 v21, v21
  v_mfma_f32_16x16x32_bf16 v[40:43], a[128:131], v[64:67], v[40:43]
  s_waitcnt lgkmcnt(3)
  ds_read_b128 v[84:87], v2 offset:12544
  v_exp_f32 v22, v22
  v_mfma_f32_16x16x32_bf16 v[44:47], a[184:187], v[68:71], v[44:47]
  s_waitcnt lgkmcnt(3)
  ds_read_b128 v[60:63], v2 offset:14336
  v_exp_f32 v23, v23
  v_fma_f32 v20, v20, v14, v14
  v_mfma_f32_16x16x32_bf16 v[40:43], a[132:135], v[72:75], v[40:43]
  s_waitcnt lgkmcnt(3)
  ds_read_b128 v[64:67], v2 offset:14592
  v_fma_f32 v21, v21, v14, v14
  v_fma_f32 v22, v22, v14, v14
  v_mfma_f32_16x16x32_bf16 v[44:47], a[188:191], v[76:79], v[44:47]
  s_waitcnt lgkmcnt(3)
  ds_read_b128 v[68:71], v2 offset:16384
  v_fma_f32 v23, v23, v14, v14
  v_mfma_f32_16x16x32_bf16 v[40:43], a[136:139], v[80:83], v[40:43]
  s_waitcnt lgkmcnt(3)
  ds_read_b128 v[72:75], v2 offset:16640
  v_rcp_f32 v20, v20
  v_mfma_f32_16x16x32_bf16 v[44:47], a[192:195], v[84:87], v[44:47]
  s_waitcnt lgkmcnt(3)
  ds_read_b128 v[76:79], v2 offset:18432
  v_rcp_f32 v21, v21
  v_mfma_f32_16x16x32_bf16 v[40:43], a[140:143], v[60:63], v[40:43]
  s_waitcnt lgkmcnt(3)
  ds_read_b128 v[80:83], v2 offset:18688
  v_rcp_f32 v22, v22
  v_mfma_f32_16x16x32_bf16 v[44:47], a[196:199], v[64:67], v[44:47]
  s_waitcnt lgkmcnt(3)
  ds_read_b128 v[84:87], v2 offset:20480
  v_rcp_f32 v23, v23
  v_add_u32 v0, s40, v4
  v_mfma_f32_16x16x32_bf16 v[40:43], a[144:147], v[68:71], v[40:43]
  s_waitcnt lgkmcnt(3)
  ds_read_b128 v[60:63], v2 offset:20736
  v_mul_f32 v32, v32, v20
  v_mul_f32 v33, v33, v21
  v_mfma_f32_16x16x32_bf16 v[44:47], a[200:203], v[72:75], v[44:47]
  s_waitcnt lgkmcnt(3)
  ds_read_b128 v[64:67], v2 offset:22528
  v_mul_f32 v34, v34, v22
  v_mul_f32 v35, v35, v23
  v_mfma_f32_16x16x32_bf16 v[40:43], a[148:151], v[76:79], v[40:43]
  s_waitcnt lgkmcnt(3)
  ds_read_b128 v[68:71], v2 offset:22784
  v_cvt_pk_bf16_f32 v32, v32, v33
  v_cvt_pk_bf16_f32 v33, v34, v35
  v_mfma_f32_16x16x32_bf16 v[44:47], a[204:207], v[80:83], v[44:47]
  s_waitcnt lgkmcnt(3)
  ds_read_b128 v[72:75], v2 offset:24576
  ds_write_b64 v0, v[32:33] offset:0
  v_mul_f32 v20, v36, v36
  v_mul_f32 v21, v37, v37
  v_mfma_f32_16x16x32_bf16 v[40:43], a[152:155], v[84:87], v[40:43]
  s_waitcnt lgkmcnt(4)
  ds_read_b128 v[76:79], v2 offset:24832
  v_mul_f32 v22, v38, v38
  v_mul_f32 v23, v39, v39
  v_mfma_f32_16x16x32_bf16 v[44:47], a[208:211], v[60:63], v[44:47]
  s_waitcnt lgkmcnt(4)
  ds_read_b128 v[80:83], v2 offset:26624
  v_fma_f32 v20, v20, v12, v10
  v_fma_f32 v21, v21, v12, v10
  v_mfma_f32_16x16x32_bf16 v[40:43], a[156:159], v[64:67], v[40:43]
  s_waitcnt lgkmcnt(4)
  ds_read_b128 v[84:87], v2 offset:26880
  v_fma_f32 v22, v22, v12, v10
  v_fma_f32 v23, v23, v12, v10
  v_mul_f32 v20, v20, v36
  v_mfma_f32_16x16x32_bf16 v[44:47], a[212:215], v[68:71], v[44:47]
  s_waitcnt lgkmcnt(4)
  ds_read_b128 v[60:63], v2 offset:256
  v_mul_f32 v21, v21, v37
  v_mul_f32 v22, v22, v38
  v_mfma_f32_16x16x32_bf16 v[40:43], a[160:163], v[72:75], v[40:43]
  s_waitcnt lgkmcnt(3)
  ds_read_b128 v[64:67], v2 offset:2304
  v_mul_f32 v23, v23, v39
  v_mfma_f32_16x16x32_bf16 v[44:47], a[216:219], v[76:79], v[44:47]
  s_waitcnt lgkmcnt(3)
  ds_read_b128 v[68:71], v2 offset:4352
  v_exp_f32 v20, v20
  v_mfma_f32_16x16x32_bf16 v[40:43], a[164:167], v[80:83], v[40:43]
  s_waitcnt lgkmcnt(3)
  ds_read_b128 v[72:75], v2 offset:6400
  v_exp_f32 v21, v21
  v_exp_f32 v22, v22
  v_mfma_f32_16x16x32_bf16 v[44:47], a[220:223], v[84:87], v[44:47]
  s_waitcnt lgkmcnt(3)
  ds_read_b128 v[76:79], v2 offset:8448
  v_exp_f32 v23, v23
  v_mfma_f32_16x16x32_bf16 v[48:51], a[0:3], v[60:63], v[48:51]
  ds_read_b128 v[80:83], v2 offset:10496
  v_fma_f32 v20, v20, v14, v14
  v_mfma_f32_16x16x32_bf16 v[52:55], a[56:59], v[60:63], v[52:55]
  v_fma_f32 v21, v21, v14, v14
  v_fma_f32 v22, v22, v14, v14
  v_fma_f32 v23, v23, v14, v14
  v_mfma_f32_16x16x32_bf16 v[56:59], a[112:115], v[60:63], v[56:59]
  s_waitcnt lgkmcnt(4)
  v_rcp_f32 v20, v20
  v_mfma_f32_16x16x32_bf16 v[48:51], a[4:7], v[64:67], v[48:51]
  ds_read_b128 v[84:87], v2 offset:12544
  v_rcp_f32 v21, v21
  v_mfma_f32_16x16x32_bf16 v[52:55], a[60:63], v[64:67], v[52:55]
  v_rcp_f32 v22, v22
  v_rcp_f32 v23, v23
  v_mfma_f32_16x16x32_bf16 v[56:59], a[116:119], v[64:67], v[56:59]
  s_waitcnt lgkmcnt(4)
  v_add_u32 v0, s41, v4
  v_mul_f32 v36, v36, v20
  v_mul_f32 v37, v37, v21
  v_mfma_f32_16x16x32_bf16 v[48:51], a[8:11], v[68:71], v[48:51]
  ds_read_b128 v[60:63], v2 offset:14592
  v_mul_f32 v38, v38, v22
  v_mul_f32 v39, v39, v23
  v_mfma_f32_16x16x32_bf16 v[52:55], a[64:67], v[68:71], v[52:55]
  v_cvt_pk_bf16_f32 v36, v36, v37
  v_cvt_pk_bf16_f32 v37, v38, v39
  v_mfma_f32_16x16x32_bf16 v[56:59], a[120:123], v[68:71], v[56:59]
  s_waitcnt lgkmcnt(4)
  ds_write_b64 v0, v[36:37] offset:0
  v_mul_f32 v20, v40, v40
  v_mul_f32 v21, v41, v41
  v_mul_f32 v22, v42, v42
  v_mfma_f32_16x16x32_bf16 v[48:51], a[12:15], v[72:75], v[48:51]
  ds_read_b128 v[64:67], v2 offset:16640
  v_mul_f32 v23, v43, v43
  v_fma_f32 v20, v20, v12, v10
  v_mfma_f32_16x16x32_bf16 v[52:55], a[68:71], v[72:75], v[52:55]
  v_fma_f32 v21, v21, v12, v10
  v_fma_f32 v22, v22, v12, v10
  v_fma_f32 v23, v23, v12, v10
  v_mfma_f32_16x16x32_bf16 v[56:59], a[124:127], v[72:75], v[56:59]
  s_waitcnt lgkmcnt(5)
  v_mul_f32 v20, v20, v40
  v_mul_f32 v21, v21, v41
  v_mul_f32 v22, v22, v42
  v_mfma_f32_16x16x32_bf16 v[48:51], a[16:19], v[76:79], v[48:51]
  ds_read_b128 v[68:71], v2 offset:18688
  v_mul_f32 v23, v23, v43
  v_mfma_f32_16x16x32_bf16 v[52:55], a[72:75], v[76:79], v[52:55]
  v_exp_f32 v20, v20
  v_exp_f32 v21, v21
  v_mfma_f32_16x16x32_bf16 v[56:59], a[128:131], v[76:79], v[56:59]
  s_waitcnt lgkmcnt(5)
  v_exp_f32 v22, v22
  v_mfma_f32_16x16x32_bf16 v[48:51], a[20:23], v[80:83], v[48:51]
  ds_read_b128 v[72:75], v2 offset:20736
  v_exp_f32 v23, v23
  v_fma_f32 v20, v20, v14, v14
  v_mfma_f32_16x16x32_bf16 v[52:55], a[76:79], v[80:83], v[52:55]
  v_fma_f32 v21, v21, v14, v14
  v_fma_f32 v22, v22, v14, v14
  v_fma_f32 v23, v23, v14, v14
  v_mfma_f32_16x16x32_bf16 v[56:59], a[132:135], v[80:83], v[56:59]
  s_waitcnt lgkmcnt(5)
  v_rcp_f32 v20, v20
  v_mfma_f32_16x16x32_bf16 v[48:51], a[24:27], v[84:87], v[48:51]
  ds_read_b128 v[76:79], v2 offset:22784
  v_rcp_f32 v21, v21
  v_mfma_f32_16x16x32_bf16 v[52:55], a[80:83], v[84:87], v[52:55]
  v_rcp_f32 v22, v22
  v_rcp_f32 v23, v23
  v_mfma_f32_16x16x32_bf16 v[56:59], a[136:139], v[84:87], v[56:59]
  s_waitcnt lgkmcnt(5)
  v_add_u32 v0, s42, v4
  v_mul_f32 v40, v40, v20
  v_mul_f32 v41, v41, v21
  v_mfma_f32_16x16x32_bf16 v[48:51], a[28:31], v[60:63], v[48:51]
  ds_read_b128 v[80:83], v2 offset:24832
  v_mul_f32 v42, v42, v22
  v_mul_f32 v43, v43, v23
  v_mfma_f32_16x16x32_bf16 v[52:55], a[84:87], v[60:63], v[52:55]
  v_cvt_pk_bf16_f32 v40, v40, v41
  v_cvt_pk_bf16_f32 v41, v42, v43
  v_mfma_f32_16x16x32_bf16 v[56:59], a[140:143], v[60:63], v[56:59]
  s_waitcnt lgkmcnt(4)
  ds_write_b64 v0, v[40:41] offset:0
  v_mul_f32 v20, v44, v44
  v_mul_f32 v21, v45, v45
  v_mul_f32 v22, v46, v46
  v_mfma_f32_16x16x32_bf16 v[48:51], a[32:35], v[64:67], v[48:51]
  ds_read_b128 v[84:87], v2 offset:26880
  v_mul_f32 v23, v47, v47
  v_fma_f32 v20, v20, v13, v11
  v_mfma_f32_16x16x32_bf16 v[52:55], a[88:91], v[64:67], v[52:55]
  v_fma_f32 v21, v21, v13, v11
  v_fma_f32 v22, v22, v13, v11
  v_fma_f32 v23, v23, v13, v11
  v_mfma_f32_16x16x32_bf16 v[56:59], a[144:147], v[64:67], v[56:59]
  s_waitcnt lgkmcnt(5)
  v_mul_f32 v20, v20, v44
  v_mul_f32 v21, v21, v45
  v_mul_f32 v22, v22, v46
  v_mfma_f32_16x16x32_bf16 v[48:51], a[36:39], v[68:71], v[48:51]
  v_mul_f32 v23, v23, v47
  v_mfma_f32_16x16x32_bf16 v[52:55], a[92:95], v[68:71], v[52:55]
  v_exp_f32 v20, v20
  v_exp_f32 v21, v21
  v_mfma_f32_16x16x32_bf16 v[56:59], a[148:151], v[68:71], v[56:59]
  s_waitcnt lgkmcnt(4)
  v_exp_f32 v22, v22
  v_mfma_f32_16x16x32_bf16 v[48:51], a[40:43], v[72:75], v[48:51]
  v_exp_f32 v23, v23
  v_fma_f32 v20, v20, v15, v15
  v_fma_f32 v21, v21, v15, v15
  v_mfma_f32_16x16x32_bf16 v[52:55], a[96:99], v[72:75], v[52:55]
  v_fma_f32 v22, v22, v15, v15
  v_fma_f32 v23, v23, v15, v15
  v_mfma_f32_16x16x32_bf16 v[56:59], a[152:155], v[72:75], v[56:59]
  s_waitcnt lgkmcnt(3)
  v_rcp_f32 v20, v20
  v_mfma_f32_16x16x32_bf16 v[48:51], a[44:47], v[76:79], v[48:51]
  v_rcp_f32 v21, v21
  v_rcp_f32 v22, v22
  v_mfma_f32_16x16x32_bf16 v[52:55], a[100:103], v[76:79], v[52:55]
  v_rcp_f32 v23, v23
  v_mfma_f32_16x16x32_bf16 v[56:59], a[156:159], v[76:79], v[56:59]
  s_waitcnt lgkmcnt(2)
  v_add_u32 v0, s43, v4
  v_mul_f32 v44, v44, v20
  v_mul_f32 v45, v45, v21
  v_mfma_f32_16x16x32_bf16 v[48:51], a[48:51], v[80:83], v[48:51]
  v_mul_f32 v46, v46, v22
  v_mul_f32 v47, v47, v23
  v_cvt_pk_bf16_f32 v44, v44, v45
  v_mfma_f32_16x16x32_bf16 v[52:55], a[104:107], v[80:83], v[52:55]
  v_cvt_pk_bf16_f32 v45, v46, v47
  ds_write_b64 v0, v[44:45] offset:7168
  s_waitcnt lgkmcnt(0)
  s_barrier
  ds_read_b128 v[88:91], v4 offset:0
  v_mfma_f32_16x16x32_bf16 v[56:59], a[160:163], v[80:83], v[56:59]
  s_mov_b32 m0, s18
  s_nop 0
  buffer_load_dwordx4 v3, s[4:7], s12 offen offset:0 sc1 lds
  v_mfma_f32_16x16x32_bf16 v[48:51], a[52:55], v[84:87], v[48:51]
  buffer_load_dwordx4 v3, s[4:7], s12 offen offset:1024 sc1 lds
  v_mfma_f32_16x16x32_bf16 v[52:55], a[108:111], v[84:87], v[52:55]
  buffer_load_dwordx4 v3, s[4:7], s12 offen offset:2048 sc1 lds
  v_mfma_f32_16x16x32_bf16 v[56:59], a[164:167], v[84:87], v[56:59]
  s_waitcnt lgkmcnt(0)
  buffer_load_dwordx4 v3, s[4:7], s12 offen offset:3072 sc1 lds
  v_mfma_f32_16x16x32_bf16 v[60:63], a[224:227], v[88:91], 0
  ds_read_b128 v[28:31], v4 offset:1024
  s_add_u32 m0, s18, 4096
  s_add_u32 s19, s12, 4096
  buffer_load_dwordx4 v3, s[4:7], s19 offen offset:0 sc1 lds
  v_mfma_f32_16x16x32_bf16 v[64:67], a[252:255], v[88:91], 0
  ds_read_b128 v[24:27], v4 offset:2048
  v_mul_f32 v20, v48, v48
  v_mul_f32 v21, v49, v49
  v_mfma_f32_16x16x32_bf16 v[68:71], v[116:119], v[88:91], 0
  v_mul_f32 v22, v50, v50
  v_mul_f32 v23, v51, v51
  v_fma_f32 v20, v20, v13, v11
  v_mfma_f32_16x16x32_bf16 v[72:75], v[144:147], v[88:91], 0
  v_fma_f32 v21, v21, v13, v11
  v_fma_f32 v22, v22, v13, v11
  v_mfma_f32_16x16x32_bf16 v[76:79], v[172:175], v[88:91], 0
  v_fma_f32 v23, v23, v13, v11
  v_mfma_f32_16x16x32_bf16 v[80:83], v[200:203], v[88:91], 0
  buffer_load_dwordx4 v3, s[4:7], s19 offen offset:1024 sc1 lds
  v_mul_f32 v20, v20, v48
  v_mul_f32 v21, v21, v49
  v_mfma_f32_16x16x32_bf16 v[84:87], v[228:231], v[88:91], 0
  s_waitcnt lgkmcnt(1)
  v_mul_f32 v22, v22, v50
  v_mul_f32 v23, v23, v51
  v_mfma_f32_16x16x32_bf16 v[60:63], a[228:231], v[28:31], v[60:63]
  ds_read_b128 v[88:91], v4 offset:3072
  v_exp_f32 v20, v20
  v_mfma_f32_16x16x32_bf16 v[64:67], v[92:95], v[28:31], v[64:67]
  v_exp_f32 v21, v21
  v_mfma_f32_16x16x32_bf16 v[68:71], v[120:123], v[28:31], v[68:71]
  v_exp_f32 v22, v22
  v_mfma_f32_16x16x32_bf16 v[72:75], v[148:151], v[28:31], v[72:75]
  v_exp_f32 v23, v23
  v_mfma_f32_16x16x32_bf16 v[76:79], v[176:179], v[28:31], v[76:79]
  buffer_load_dwordx4 v3, s[4:7], s19 offen offset:2048 sc1 lds
  v_fma_f32 v20, v20, v15, v15
  v_fma_f32 v21, v21, v15, v15
  v_mfma_f32_16x16x32_bf16 v[80:83], v[204:207], v[28:31], v[80:83]
  v_fma_f32 v22, v22, v15, v15
  v_fma_f32 v23, v23, v15, v15
  v_mfma_f32_16x16x32_bf16 v[84:87], v[232:235], v[28:31], v[84:87]
  s_waitcnt lgkmcnt(1)
  v_rcp_f32 v20, v20
  v_mfma_f32_16x16x32_bf16 v[60:63], a[232:235], v[24:27], v[60:63]
  ds_read_b128 v[28:31], v4 offset:4096
  v_rcp_f32 v21, v21
  v_mfma_f32_16x16x32_bf16 v[64:67], v[96:99], v[24:27], v[64:67]
  v_rcp_f32 v22, v22
  v_mfma_f32_16x16x32_bf16 v[68:71], v[124:127], v[24:27], v[68:71]
  v_rcp_f32 v23, v23
  v_add_u32 v0, s40, v4
  v_mfma_f32_16x16x32_bf16 v[72:75], v[152:155], v[24:27], v[72:75]
  v_mul_f32 v48, v48, v20
  v_mul_f32 v49, v49, v21
  v_mul_f32 v50, v50, v22
  v_mfma_f32_16x16x32_bf16 v[76:79], v[180:183], v[24:27], v[76:79]
  v_mul_f32 v51, v51, v23
  v_cvt_pk_bf16_f32 v48, v48, v49
  v_cvt_pk_bf16_f32 v49, v50, v51
  v_mfma_f32_16x16x32_bf16 v[80:83], v[208:211], v[24:27], v[80:83]
  ds_write_b64 v0, v[48:49] offset:7168
  v_mul_f32 v20, v52, v52
  v_mul_f32 v21, v53, v53
  v_mfma_f32_16x16x32_bf16 v[84:87], v[236:239], v[24:27], v[84:87]
  s_waitcnt lgkmcnt(2)
  v_mul_f32 v22, v54, v54
  v_mul_f32 v23, v55, v55
  v_fma_f32 v20, v20, v13, v11
  v_mfma_f32_16x16x32_bf16 v[60:63], a[236:239], v[88:91], v[60:63]
  ds_read_b128 v[24:27], v4 offset:5120
  v_fma_f32 v21, v21, v13, v11
  v_fma_f32 v22, v22, v13, v11
  v_mfma_f32_16x16x32_bf16 v[64:67], v[100:103], v[88:91], v[64:67]
  v_fma_f32 v23, v23, v13, v11
  v_mul_f32 v20, v20, v52
  v_mfma_f32_16x16x32_bf16 v[68:71], v[128:131], v[88:91], v[68:71]
  v_mul_f32 v21, v21, v53
  v_mul_f32 v22, v22, v54
  v_mul_f32 v23, v23, v55
  v_mfma_f32_16x16x32_bf16 v[72:75], v[156:159], v[88:91], v[72:75]
  v_exp_f32 v20, v20
  v_mfma_f32_16x16x32_bf16 v[76:79], v[184:187], v[88:91], v[76:79]
  v_exp_f32 v21, v21
  v_mfma_f32_16x16x32_bf16 v[80:83], v[212:215], v[88:91], v[80:83]
  v_exp_f32 v22, v22
  v_mfma_f32_16x16x32_bf16 v[84:87], v[240:243], v[88:91], v[84:87]
  s_waitcnt lgkmcnt(2)
  v_exp_f32 v23, v23
  v_fma_f32 v20, v20, v15, v15
  v_mfma_f32_16x16x32_bf16 v[60:63], a[240:243], v[28:31], v[60:63]
  ds_read_b128 v[88:91], v4 offset:6144
  v_fma_f32 v21, v21, v15, v15
  v_fma_f32 v22, v22, v15, v15
  v_mfma_f32_16x16x32_bf16 v[64:67], v[104:107], v[28:31], v[64:67]
  v_fma_f32 v23, v23, v15, v15
  v_rcp_f32 v20, v20
  v_mfma_f32_16x16x32_bf16 v[68:71], v[132:135], v[28:31], v[68:71]
  v_rcp_f32 v21, v21
  v_mfma_f32_16x16x32_bf16 v[72:75], v[160:163], v[28:31], v[72:75]
  v_rcp_f32 v22, v22
  v_rcp_f32 v23, v23
  v_mfma_f32_16x16x32_bf16 v[76:79], v[188:191], v[28:31], v[76:79]
  v_add_u32 v0, s41, v4
  v_mul_f32 v52, v52, v20
  v_mfma_f32_16x16x32_bf16 v[80:83], v[216:219], v[28:31], v[80:83]
  v_mul_f32 v53, v53, v21
  v_mul_f32 v54, v54, v22
  v_mul_f32 v55, v55, v23
  v_mfma_f32_16x16x32_bf16 v[84:87], v[244:247], v[28:31], v[84:87]
  s_waitcnt lgkmcnt(1)
  v_cvt_pk_bf16_f32 v52, v52, v53
  v_cvt_pk_bf16_f32 v53, v54, v55
  v_mfma_f32_16x16x32_bf16 v[60:63], a[244:247], v[24:27], v[60:63]
  ds_write_b64 v0, v[52:53] offset:7168
  v_mul_f32 v20, v56, v56
  v_mul_f32 v21, v57, v57
  v_mul_f32 v22, v58, v58
  v_mfma_f32_16x16x32_bf16 v[64:67], v[108:111], v[24:27], v[64:67]
  v_mul_f32 v23, v59, v59
  v_fma_f32 v20, v20, v13, v11
  v_mfma_f32_16x16x32_bf16 v[68:71], v[136:139], v[24:27], v[68:71]
  v_fma_f32 v21, v21, v13, v11
  v_fma_f32 v22, v22, v13, v11
  v_fma_f32 v23, v23, v13, v11
  v_mfma_f32_16x16x32_bf16 v[72:75], v[164:167], v[24:27], v[72:75]
  v_mul_f32 v20, v20, v56
  v_mul_f32 v21, v21, v57
  v_mul_f32 v22, v22, v58
  v_mfma_f32_16x16x32_bf16 v[76:79], v[192:195], v[24:27], v[76:79]
  v_mul_f32 v23, v23, v59
  v_exp_f32 v20, v20
  v_mfma_f32_16x16x32_bf16 v[80:83], v[220:223], v[24:27], v[80:83]
  v_exp_f32 v21, v21
  v_mfma_f32_16x16x32_bf16 v[84:87], v[248:251], v[24:27], v[84:87]
  s_waitcnt lgkmcnt(1)
  v_exp_f32 v22, v22
  v_exp_f32 v23, v23
  v_mfma_f32_16x16x32_bf16 v[60:63], a[248:251], v[88:91], v[60:63]
  v_fma_f32 v20, v20, v15, v15
  v_fma_f32 v21, v21, v15, v15
  v_mfma_f32_16x16x32_bf16 v[64:67], v[112:115], v[88:91], v[64:67]
  v_fma_f32 v22, v22, v15, v15
  v_fma_f32 v23, v23, v15, v15
  v_mfma_f32_16x16x32_bf16 v[68:71], v[140:143], v[88:91], v[68:71]
  v_rcp_f32 v20, v20
  v_rcp_f32 v21, v21
  v_mfma_f32_16x16x32_bf16 v[72:75], v[168:171], v[88:91], v[72:75]
  v_rcp_f32 v22, v22
  v_mfma_f32_16x16x32_bf16 v[76:79], v[196:199], v[88:91], v[76:79]
  v_rcp_f32 v23, v23
  v_add_u32 v0, s42, v4
  v_mul_f32 v56, v56, v20
  v_mfma_f32_16x16x32_bf16 v[80:83], v[224:227], v[88:91], v[80:83]
  v_mul_f32 v57, v57, v21
  v_mul_f32 v58, v58, v22
  v_mul_f32 v59, v59, v23
  v_mfma_f32_16x16x32_bf16 v[84:87], v[252:255], v[88:91], v[84:87]
  v_cvt_pk_bf16_f32 v56, v56, v57
  v_cvt_pk_bf16_f32 v57, v58, v59
  ds_write_b64 v0, v[56:57] offset:7168
  s_waitcnt lgkmcnt(0)
  s_barrier
  ds_read_b128 v[88:91], v4 offset:7168
  ds_read_b128 v[28:31], v4 offset:8192
  s_waitcnt lgkmcnt(1)
  v_mfma_f32_16x16x32_bf16 v[32:35], a[224:227], v[88:91], 0
  ds_read_b128 v[24:27], v4 offset:9216
  v_cvt_pk_bf16_f32 v60, v60, v61
  v_mfma_f32_16x16x32_bf16 v[36:39], a[252:255], v[88:91], 0
  v_cvt_pk_bf16_f32 v61, v62, v63
  v_cvt_pk_bf16_f32 v62, v64, v65
  v_mfma_f32_16x16x32_bf16 v[40:43], v[116:119], v[88:91], 0
  v_cvt_pk_bf16_f32 v63, v66, v67
  v_mfma_f32_16x16x32_bf16 v[44:47], v[144:147], v[88:91], 0
  buffer_store_dwordx4 v[60:63], v5, s[4:7], s26 offen offset:0
  v_cvt_pk_bf16_f32 v68, v68, v69
  v_mfma_f32_16x16x32_bf16 v[48:51], v[172:175], v[88:91], 0
  v_cvt_pk_bf16_f32 v69, v70, v71
  v_cvt_pk_bf16_f32 v70, v72, v73
  v_mfma_f32_16x16x32_bf16 v[52:55], v[200:203], v[88:91], 0
  v_cvt_pk_bf16_f32 v71, v74, v75
  v_mfma_f32_16x16x32_bf16 v[56:59], v[228:231], v[88:91], 0
  s_waitcnt lgkmcnt(1)
  buffer_store_dwordx4 v[68:71], v5, s[4:7], s26 offen offset:256
  v_cvt_pk_bf16_f32 v76, v76, v77
  v_mfma_f32_16x16x32_bf16 v[32:35], a[228:231], v[28:31], v[32:35]
  ds_read_b128 v[88:91], v4 offset:10240
  v_cvt_pk_bf16_f32 v77, v78, v79
  v_mfma_f32_16x16x32_bf16 v[36:39], v[92:95], v[28:31], v[36:39]
  v_cvt_pk_bf16_f32 v78, v80, v81
  v_cvt_pk_bf16_f32 v79, v82, v83
  v_mfma_f32_16x16x32_bf16 v[40:43], v[120:123], v[28:31], v[40:43]
  buffer_store_dwordx4 v[76:79], v5, s[4:7], s26 offen offset:512
  v_cvt_pk_bf16_f32 v84, v84, v85
  v_mfma_f32_16x16x32_bf16 v[44:47], v[148:151], v[28:31], v[44:47]
  v_cvt_pk_bf16_f32 v85, v86, v87
  v_mfma_f32_16x16x32_bf16 v[48:51], v[176:179], v[28:31], v[48:51]
  buffer_store_dwordx2 v[84:85], v6, s[4:7], s26 offen offset:768
  v_mfma_f32_16x16x32_bf16 v[52:55], v[204:207], v[28:31], v[52:55]
  v_mfma_f32_16x16x32_bf16 v[56:59], v[232:235], v[28:31], v[56:59]
  s_waitcnt lgkmcnt(1)
  v_mfma_f32_16x16x32_bf16 v[32:35], a[232:235], v[24:27], v[32:35]
  ds_read_b128 v[28:31], v4 offset:11264
  v_mfma_f32_16x16x32_bf16 v[36:39], v[96:99], v[24:27], v[36:39]
  v_mfma_f32_16x16x32_bf16 v[40:43], v[124:127], v[24:27], v[40:43]
  v_mfma_f32_16x16x32_bf16 v[44:47], v[152:155], v[24:27], v[44:47]
  v_mfma_f32_16x16x32_bf16 v[48:51], v[180:183], v[24:27], v[48:51]
  v_mfma_f32_16x16x32_bf16 v[52:55], v[208:211], v[24:27], v[52:55]
  v_mfma_f32_16x16x32_bf16 v[56:59], v[236:239], v[24:27], v[56:59]
  s_waitcnt lgkmcnt(1)
  v_mfma_f32_16x16x32_bf16 v[32:35], a[236:239], v[88:91], v[32:35]
  ds_read_b128 v[24:27], v4 offset:12288
  v_mfma_f32_16x16x32_bf16 v[36:39], v[100:103], v[88:91], v[36:39]
  v_mfma_f32_16x16x32_bf16 v[40:43], v[128:131], v[88:91], v[40:43]
  v_mfma_f32_16x16x32_bf16 v[44:47], v[156:159], v[88:91], v[44:47]
  v_mfma_f32_16x16x32_bf16 v[48:51], v[184:187], v[88:91], v[48:51]
  v_mfma_f32_16x16x32_bf16 v[52:55], v[212:215], v[88:91], v[52:55]
  v_mfma_f32_16x16x32_bf16 v[56:59], v[240:243], v[88:91], v[56:59]
  s_waitcnt lgkmcnt(1)
  v_mfma_f32_16x16x32_bf16 v[32:35], a[240:243], v[28:31], v[32:35]
  ds_read_b128 v[88:91], v4 offset:13312
  v_mfma_f32_16x16x32_bf16 v[36:39], v[104:107], v[28:31], v[36:39]
  v_mfma_f32_16x16x32_bf16 v[40:43], v[132:135], v[28:31], v[40:43]
  v_mfma_f32_16x16x32_bf16 v[44:47], v[160:163], v[28:31], v[44:47]
  v_mfma_f32_16x16x32_bf16 v[48:51], v[188:191], v[28:31], v[48:51]
  v_mfma_f32_16x16x32_bf16 v[52:55], v[216:219], v[28:31], v[52:55]
  v_mfma_f32_16x16x32_bf16 v[56:59], v[244:247], v[28:31], v[56:59]
  s_waitcnt lgkmcnt(1)
  v_mfma_f32_16x16x32_bf16 v[32:35], a[244:247], v[24:27], v[32:35]
  s_waitcnt lgkmcnt(0)
  v_mfma_f32_16x16x32_bf16 v[32:35], a[248:251], v[88:91], v[32:35]
  v_mfma_f32_16x16x32_bf16 v[36:39], v[108:111], v[24:27], v[36:39]
  v_mfma_f32_16x16x32_bf16 v[36:39], v[112:115], v[88:91], v[36:39]
  v_mfma_f32_16x16x32_bf16 v[40:43], v[136:139], v[24:27], v[40:43]
  v_mfma_f32_16x16x32_bf16 v[40:43], v[140:143], v[88:91], v[40:43]
  v_cvt_pk_bf16_f32 v32, v32, v33
  v_cvt_pk_bf16_f32 v33, v34, v35
  v_mfma_f32_16x16x32_bf16 v[44:47], v[164:167], v[24:27], v[44:47]
  v_cvt_pk_bf16_f32 v34, v36, v37
  v_cvt_pk_bf16_f32 v35, v38, v39
  v_mfma_f32_16x16x32_bf16 v[44:47], v[168:171], v[88:91], v[44:47]
  buffer_store_dwordx4 v[32:35], v5, s[4:7], s20 offen offset:0
  v_mfma_f32_16x16x32_bf16 v[48:51], v[192:195], v[24:27], v[48:51]
  v_mfma_f32_16x16x32_bf16 v[48:51], v[196:199], v[88:91], v[48:51]
  v_cvt_pk_bf16_f32 v40, v40, v41
  v_cvt_pk_bf16_f32 v41, v42, v43
  v_mfma_f32_16x16x32_bf16 v[52:55], v[220:223], v[24:27], v[52:55]
  v_cvt_pk_bf16_f32 v42, v44, v45
  v_cvt_pk_bf16_f32 v43, v46, v47
  v_mfma_f32_16x16x32_bf16 v[52:55], v[224:227], v[88:91], v[52:55]
  buffer_store_dwordx4 v[40:43], v5, s[4:7], s20 offen offset:256
  v_mfma_f32_16x16x32_bf16 v[56:59], v[248:251], v[24:27], v[56:59]
  v_mfma_f32_16x16x32_bf16 v[56:59], v[252:255], v[88:91], v[56:59]
  v_cvt_pk_bf16_f32 v48, v48, v49
  v_cvt_pk_bf16_f32 v49, v50, v51
  v_cvt_pk_bf16_f32 v50, v52, v53
  v_cvt_pk_bf16_f32 v51, v54, v55
  buffer_store_dwordx4 v[48:51], v5, s[4:7], s20 offen offset:512
  s_nop 2
  v_cvt_pk_bf16_f32 v56, v56, v57
  v_cvt_pk_bf16_f32 v57, v58, v59
  buffer_store_dwordx2 v[56:57], v6, s[4:7], s20 offen offset:768
P_red:
  v_add_u32 v0, s18, v1
  s_waitcnt vmcnt(8)
  ds_read_b128 v[60:63], v0 offset:0
  ds_read_b128 v[64:67], v0 offset:1024
  ds_read_b128 v[68:71], v0 offset:2048
  ds_read_b128 v[72:75], v0 offset:3072
  ds_read_b128 v[76:79], v0 offset:4096
  ds_read_b128 v[80:83], v0 offset:5120
  ds_read_b128 v[84:87], v0 offset:6144
  ds_read_b128 v[24:27], v7 offset:0
  ds_read_b128 v[28:31], v7 offset:1024
  ds_read_b128 v[88:91], v7 offset:2048
  ds_read_b128 v[48:51], v7 offset:3072
  v_mov_b64 v[20:21], 0
  v_add_u32 v2, s22, v2
  v_mov_b32 v8, s17
  s_lshl_b32 s19, s10, 2
  s_add_u32 s19, s19, s14
  s_waitcnt lgkmcnt(10)
  v_dot2c_f32_bf16 v20, v60, v9
  v_dot2c_f32_bf16 v21, v60, v60
  v_dot2c_f32_bf16 v20, v61, v9
  v_dot2c_f32_bf16 v21, v61, v61
  v_dot2c_f32_bf16 v20, v62, v9
  v_dot2c_f32_bf16 v21, v62, v62
  v_dot2c_f32_bf16 v20, v63, v9
  v_dot2c_f32_bf16 v21, v63, v63
  s_waitcnt lgkmcnt(9)
  v_dot2c_f32_bf16 v20, v64, v9
  v_dot2c_f32_bf16 v21, v64, v64
  v_dot2c_f32_bf16 v20, v65, v9
  v_dot2c_f32_bf16 v21, v65, v65
  v_dot2c_f32_bf16 v20, v66, v9
  v_dot2c_f32_bf16 v21, v66, v66
  v_dot2c_f32_bf16 v20, v67, v9
  v_dot2c_f32_bf16 v21, v67, v67
  s_waitcnt lgkmcnt(8)
  v_dot2c_f32_bf16 v20, v68, v9
  v_dot2c_f32_bf16 v21, v68, v68
  v_dot2c_f32_bf16 v20, v69, v9
  v_dot2c_f32_bf16 v21, v69, v69
  v_dot2c_f32_bf16 v20, v70, v9
  v_dot2c_f32_bf16 v21, v70, v70
  v_dot2c_f32_bf16 v20, v71, v9
  v_dot2c_f32_bf16 v21, v71, v71
  s_waitcnt lgkmcnt(0)
  v_add_u32 v48, s27, v48
  v_add_u32 v49, s27, v49
  v_add_u32 v50, s27, v50
  v_add_u32 v51, s27, v51
  ds_read_b128 v[32:35], v48
  ds_read_b128 v[36:39], v49
  ds_read_b128 v[40:43], v50
  ds_read_b128 v[44:47], v51
  s_add_u32 s27, s27, s22
  s_sub_i32 s22, 0, s22
  v_bfe_u32 v0, v1, 2, 5
  s_waitcnt vmcnt(0)
  s_mov_b64 exec, 1
  buffer_store_dword v8, off, s[4:7], s19
  s_mov_b64 exec, -1
  v_dot2c_f32_bf16 v20, v72, v9
  v_dot2c_f32_bf16 v21, v72, v72
  v_dot2c_f32_bf16 v20, v73, v9
  v_dot2c_f32_bf16 v21, v73, v73
  v_dot2c_f32_bf16 v20, v74, v9
  v_dot2c_f32_bf16 v21, v74, v74
  v_dot2c_f32_bf16 v20, v75, v9
  v_dot2c_f32_bf16 v21, v75, v75
  v_dot2c_f32_bf16 v20, v76, v9
  v_dot2c_f32_bf16 v21, v76, v76
  v_dot2c_f32_bf16 v20, v77, v9
  v_dot2c_f32_bf16 v21, v77, v77
  v_dot2c_f32_bf16 v20, v78, v9
  v_dot2c_f32_bf16 v21, v78, v78
  v_dot2c_f32_bf16 v20, v79, v9
  v_dot2c_f32_bf16 v21, v79, v79
  v_dot2c_f32_bf16 v20, v80, v9
  v_dot2c_f32_bf16 v21, v80, v80
  v_dot2c_f32_bf16 v20, v81, v9
  v_dot2c_f32_bf16 v21, v81, v81
  v_dot2c_f32_bf16 v20, v82, v9
  v_dot2c_f32_bf16 v21, v82, v82
  v_dot2c_f32_bf16 v20, v83, v9
  v_dot2c_f32_bf16 v21, v83, v83
  v_dot2c_f32_bf16 v20, v84, v9
  v_dot2c_f32_bf16 v21, v84, v84
  v_dot2c_f32_bf16 v20, v85, v9
  v_dot2c_f32_bf16 v21, v85, v85
  v_dot2c_f32_bf16 v20, v86, v9
  v_dot2c_f32_bf16 v21, v86, v86
  v_dot2c_f32_bf16 v20, v87, v9
  v_dot2c_f32_bf16 v21, v87, v87
  buffer_load_dword v8, v0, s[4:7], s14 offen sc1
  v_bfe_u32 v48, v1, 2, 7
  s_lshl_b32 s19, s8, 8
  s_add_u32 s19, s19, 73728
  v_add_u32 v48, s19, v48
  v_mov_b64 v[22:23], v[20:21]
  s_nop 1
  v_permlane32_swap_b32 v22, v20
  v_permlane32_swap_b32 v23, v21
  v_pk_add_f32 v[20:21], v[20:21], v[22:23]
  ds_write2_b32 v48, v20, v21 offset0:0 offset1:32
  s_waitcnt lgkmcnt(1)
  v_mfma_f32_16x16x32_bf16 v[52:55], v[24:27], v[32:35], 0
  v_mfma_f32_16x16x32_bf16 v[52:55], v[28:31], v[36:39], v[52:55]
  v_mfma_f32_16x16x32_bf16 v[56:59], v[24:27], v[40:43], 0
  v_mfma_f32_16x16x32_bf16 v[56:59], v[28:31], v[44:47], v[56:59]
  s_waitcnt lgkmcnt(0)
  s_barrier
  v_bfe_u32 v32, v1, 2, 6
  v_add_u32 v32, 73728, v32
  ds_read2_b32 v[36:37], v32 offset0:0 offset1:16
  ds_read2_b32 v[38:39], v32 offset0:64 offset1:80
  ds_read2_b32 v[40:41], v32 offset0:128 offset1:144
  ds_read2_b32 v[42:43], v32 offset0:192 offset1:208
  ds_read2_b32 v[44:45], v32 offset0:32 offset1:48
  ds_read2_b32 v[46:47], v32 offset0:96 offset1:112
  ds_read2_b32 v[48:49], v32 offset0:160 offset1:176
  ds_read2_b32 v[50:51], v32 offset0:224 offset1:240
  s_mul_i32 s19, s10, 28672
  s_add_u32 s19, s19, s13
  s_add_u32 s20, s19, 14336
P_fl:
  s_waitcnt vmcnt(0)
  v_cmp_gt_u32 vcc, s17, v8
  s_cbranch_vccz P_fo
  buffer_load_dword v8, v0, s[4:7], s14 offen sc1
  s_sub_u32 s99, s99, 1
  s_cbranch_scc1 FAIL
  s_branch P_fl
P_fo:
  buffer_load_dwordx4 v[60:63], v88, s[4:7], s19 offen offset:0 sc1
  buffer_load_dwordx4 v[64:67], v88, s[4:7], s20 offen offset:0 sc1
  buffer_load_dwordx4 v[68:71], v88, s[4:7], s19 offen offset:256 sc1
  buffer_load_dwordx4 v[72:75], v88, s[4:7], s20 offen offset:256 sc1
  s_waitcnt lgkmcnt(4)
  v_pk_add_f32 v[36:37], v[36:37], v[38:39]
  v_pk_add_f32 v[40:41], v[40:41], v[42:43]
  v_pk_add_f32 v[36:37], v[36:37], v[40:41]
  s_waitcnt lgkmcnt(0)
  v_pk_add_f32 v[44:45], v[44:45], v[46:47]
  v_pk_add_f32 v[48:49], v[48:49], v[50:51]
  v_pk_add_f32 v[44:45], v[44:45], v[48:49]
  v_mul_f32 v36, 0xbb124925, v36
  buffer_load_dwordx4 v[76:79], v88, s[4:7], s19 offen offset:512 sc1
  v_mul_f32 v44, 0x3b124925, v44
  v_mul_f32 v37, 0xbb124925, v37
  v_mul_f32 v45, 0x3b124925, v45
  v_cmp_u_f32 vcc, v44, v45
  v_pk_fma_f32 v[44:45], v[36:37], v[36:37], v[44:45] neg_lo:[1,0,0] neg_hi:[1,0,0]
  v_max_f32 v44, 0, v44
  v_max_f32 v45, 0, v45
  v_mul_f32 v44, 0x3f800054, v44
  v_mul_f32 v45, 0x3f800054, v45
  v_add_f32 v44, 0x2edbe6ff, v44
  buffer_load_dwordx4 v[80:83], v88, s[4:7], s20 offen offset:512 sc1
  v_add_f32 v45, 0x2edbe6ff, v45
  v_rsq_f32 v40, v44
  v_rsq_f32 v41, v45
  s_nop 0
  v_pk_mul_f32 v[14:15], v[44:45], v[40:41]
  v_mul_f32 v10, 0xc0135761, v40
  v_mul_f32 v11, 0xc0135761, v41
  v_cndmask_b32 v36, v14, v36, s[60:61]
  v_cndmask_b32 v37, v15, v37, s[60:61]
  v_pk_mul_f32 v[40:41], v[40:41], v[40:41]
  buffer_load_dwordx4 v[84:87], v89, s[4:7], s19 offen offset:768 sc1
  v_and_b32 v44, 0xffff0000, v36
  v_and_b32 v45, 0xffff0000, v37
  v_pk_mul_f32 v[40:41], v[40:41], v[10:11]
  v_pk_add_f32 v[36:37], v[36:37], v[44:45] neg_lo:[0,1] neg_hi:[0,1]
  v_mul_f32 v12, 0x3d372713, v40
  v_mul_f32 v13, 0x3d372713, v41
  v_cvt_pk_bf16_f32 v16, v44, v36
  v_cvt_pk_bf16_f32 v17, v44, v36
  v_cvt_pk_bf16_f32 v18, v45, v37
  v_cvt_pk_bf16_f32 v19, v45, v37
  buffer_load_dwordx4 v[32:35], v89, s[4:7], s20 offen offset:768 sc1
  s_or_b32 s46, vcc_lo, vcc_hi
  s_waitcnt vmcnt(7)
  v_mfma_f32_16x16x32_bf16 v[52:55], v[24:27], v[60:63], v[52:55]
  s_waitcnt vmcnt(6)
  v_mfma_f32_16x16x32_bf16 v[52:55], v[24:27], v[64:67], v[52:55]
  s_waitcnt vmcnt(5)
  v_mfma_f32_16x16x32_bf16 v[52:55], v[28:31], v[68:71], v[52:55]
  s_waitcnt vmcnt(4)
  v_mfma_f32_16x16x32_bf16 v[52:55], v[28:31], v[72:75], v[52:55]
  s_waitcnt vmcnt(3)
  v_mfma_f32_16x16x32_bf16 v[56:59], v[24:27], v[76:79], v[56:59]
  s_waitcnt vmcnt(2)
  v_mfma_f32_16x16x32_bf16 v[56:59], v[24:27], v[80:83], v[56:59]
  s_waitcnt vmcnt(1)
  v_mfma_f32_16x16x32_bf16 v[56:59], v[28:31], v[84:87], v[56:59]
  s_waitcnt vmcnt(0)
  v_mfma_f32_16x16x32_bf16 v[56:59], v[28:31], v[32:35], v[56:59]
  v_cvt_pk_bf16_f32 v32, v52, v53
  v_cvt_pk_bf16_f32 v33, v54, v55
  s_nop 5
  v_cvt_pk_bf16_f32 v34, v56, v57
  v_cvt_pk_bf16_f32 v35, v58, v59
  s_nop 0
  v_permlane16_swap_b32 v32, v34
  v_permlane16_swap_b32 v33, v35
  s_cmp_eq_u32 s21, 0
  s_cbranch_scc1 P_l0
  s_lshl_b32 s19, s16, 3
  s_add_u32 s19, s19, s10
  s_mul_i32 s19, s19, 3584
  s_mul_i32 s20, s8, 224
  s_add_u32 s19, s19, s20
  buffer_store_dwordx4 v[32:35], v91, s[28:31], s19 offen
  ds_read_b128 v[24:27], v7 offset:4096
  ds_read_b128 v[28:31], v7 offset:5120
  ds_read_b128 v[60:63], v2 offset:0
  ds_read_b128 v[64:67], v2 offset:2048
  ds_read_b128 v[68:71], v2 offset:4096
  ds_read_b128 v[72:75], v2 offset:6144
  ds_read_b128 v[76:79], v2 offset:8192
  s_branch P_next
P_l0:
  v_mov_b64 v[36:37], 0
  v_min_u32 v32, -2, v32
  v_min_u32 v33, -2, v33
  v_min_u32 v34, -2, v34
  v_min_u32 v35, -2, v35
  v_dot2c_f32_bf16 v36, v32, v9
  v_dot2c_f32_bf16 v37, v32, v32
  v_dot2c_f32_bf16 v36, v33, v9
  v_dot2c_f32_bf16 v37, v33, v33
  v_dot2c_f32_bf16 v36, v34, v9
  v_dot2c_f32_bf16 v37, v34, v34
  v_dot2c_f32_bf16 v36, v35, v9
  v_dot2c_f32_bf16 v37, v35, v35
  v_bfe_u32 v0, v1, 1, 5
  s_lshl_b32 s26, s8, 5
  s_add_u32 s26, s26, 75776
  v_add_u32 v8, s26, v0
  v_add_u32 v0, 75776, v0
  v_add_f32_dpp v36, v36, v36 row_ror:4 row_mask:0xf bank_mask:0xf
  v_add_f32_dpp v37, v37, v37 row_ror:4 row_mask:0xf bank_mask:0xf
  s_nop 0
  v_add_f32_dpp v36, v36, v36 row_ror:8 row_mask:0xf bank_mask:0xf
  v_add_f32_dpp v37, v37, v37 row_ror:8 row_mask:0xf bank_mask:0xf
  v_mov_b64 v[38:39], v[36:37]
  s_nop 1
  v_permlane16_swap_b32 v38, v36
  v_permlane16_swap_b32 v39, v37
  v_pk_add_f32 v[36:37], v[36:37], v[38:39]
  v_mov_b64 v[38:39], v[36:37]
  s_nop 1
  v_permlane32_swap_b32 v38, v36
  v_permlane32_swap_b32 v39, v37
  v_pk_add_f32 v[36:37], v[36:37], v[38:39]
  ds_write_b64 v8, v[36:37]
  s_mul_i32 s19, s16, 28672
  s_mul_i32 s20, s8, 7168
  s_add_u32 s19, s19, s20
  s_lshl_b32 s20, s10, 6
  s_add_u32 s19, s19, s20
  s_add_u32 s20, s19, 34340864
  s_add_u32 s19, s19, 32505856
  s_waitcnt lgkmcnt(0)
  s_barrier
  ds_read2_b64 v[36:39], v0 offset0:0 offset1:4
  ds_read2_b64 v[40:43], v0 offset0:8 offset1:12
  v_lshlrev_b32 v48, 16, v32
  v_and_b32 v49, 0xffff0000, v32
  v_lshlrev_b32 v50, 16, v33
  v_and_b32 v51, 0xffff0000, v33
  v_lshlrev_b32 v52, 16, v34
  v_and_b32 v53, 0xffff0000, v34
  v_lshlrev_b32 v54, 16, v35
  v_and_b32 v55, 0xffff0000, v35
  ds_read_b128 v[24:27], v7 offset:4096
  ds_read_b128 v[28:31], v7 offset:5120
  ds_read_b128 v[60:63], v2 offset:0
  ds_read_b128 v[64:67], v2 offset:2048
  ds_read_b128 v[68:71], v2 offset:4096
  ds_read_b128 v[72:75], v2 offset:6144
  ds_read_b128 v[76:79], v2 offset:8192
  s_waitcnt lgkmcnt(7)
  v_pk_add_f32 v[36:37], v[36:37], v[38:39]
  v_pk_add_f32 v[40:41], v[40:41], v[42:43]
  v_pk_add_f32 v[36:37], v[36:37], v[40:41]
  v_mul_f32 v36, 0xbb124925, v36
  v_mul_f32 v37, 0x3b124925, v37
  v_fma_f32 v37, -v36, v36, v37
  v_max_f32 v37, 0, v37
  v_add_f32 v37, 0x3727c5ac, v37
  v_rsq_f32 v38, v37
  s_nop 0
  v_mul_f32 v36, v36, v38
  v_pk_fma_f32 v[48:49], v[48:49], v[38:39], v[36:37] op_sel_hi:[1,0,0]
  v_pk_fma_f32 v[50:51], v[50:51], v[38:39], v[36:37] op_sel_hi:[1,0,0]
  v_pk_fma_f32 v[52:53], v[52:53], v[38:39], v[36:37] op_sel_hi:[1,0,0]
  v_pk_fma_f32 v[54:55], v[54:55], v[38:39], v[36:37] op_sel_hi:[1,0,0]
  v_cvt_pk_bf16_f32 v56, v48, v49
  v_cvt_pk_bf16_f32 v57, v50, v51
  v_cvt_pk_bf16_f32 v58, v52, v53
  v_cvt_pk_bf16_f32 v59, v54, v55
  v_min_u32 v56, -2, v56
  v_min_u32 v57, -2, v57
  v_min_u32 v58, -2, v58
  v_min_u32 v59, -2, v59
  buffer_store_dwordx4 v[56:59], v90, s[4:7], s19 offen sc1
  buffer_store_dwordx4 v[32:35], v90, s[4:7], s20 offen sc1
P_next:
  s_lshl_b32 s15, s45, 6
  s_add_u32 s15, s15, s44
  s_add_u32 s17, s17, 1
  s_cmp_lt_i32 s44, 0
  s_cbranch_scc1 DONE
  s_cmp_eq_u32 s46, 0
  s_cbranch_scc1 P_body
  s_branch P_slow
K1_rq:
  s_and_b32 s23, s10, 1
  s_lshr_b32 s10, s10, 1
  v_and_b32 v0, 63, v0
  v_lshlrev_b32 v1, 4, v0
  s_mul_i32 s101, s10, 896
  s_add_u32 s101, s101, 18907136
  v_mbcnt_lo_u32_b32 v61, -1, 0
  v_mbcnt_hi_u32_b32 v61, -1, v61
  s_cmp_lg_u32 s8, 0
  s_cbranch_scc1 wcd_172
  v_min_u32 v61, 6, v61
  v_lshlrev_b32 v61, 7, v61
  s_branch wc_171x
wc_171:
  s_sleep 2
wc_171x:
  buffer_load_dword v60, v61, s[4:7], s101 offen sc1
  s_sub_u32 s99, s99, 1
  s_cbranch_scc1 FAIL
  s_waitcnt vmcnt(0)
  v_cmp_eq_u32 vcc, 0, v60
  s_cbranch_vccnz wc_171
wcd_172:
  s_barrier
  s_lshl_b32 s100, s10, 2
  s_add_u32 s100, s100, s8
  s_mul_i32 s100, s100, 100352
  s_add_u32 s100, s100, 0
  s_add_u32 s101, s100, 100352
  v_and_b32 v72, 63, v0
  v_lshlrev_b32 v72, 7, v72
  s_lshl_b32 s12, s23, 13
  s_add_u32 s100, s100, s12
ld_174:
  buffer_load_dword v73, v72, s[4:7], s100 offen
  s_add_u32 s100, s100, 16384
  s_cmp_lt_u32 s100, s101
  s_cbranch_scc1 ld_174
nl_173:
  s_lshl_b32 s19, s10, 2
  s_add_u32 s19, s19, s8
  s_mul_i32 s19, s19, 100352
  buffer_load_dwordx4 a[0:3], v1, s[4:7], s19 offen offset:0
  buffer_load_dwordx4 a[4:7], v1, s[4:7], s19 offen offset:1024
  buffer_load_dwordx4 a[8:11], v1, s[4:7], s19 offen offset:2048
  buffer_load_dwordx4 a[12:15], v1, s[4:7], s19 offen offset:3072
  s_add_u32 s19, s19, 4096
  buffer_load_dwordx4 a[16:19], v1, s[4:7], s19 offen offset:0
  buffer_load_dwordx4 a[20:23], v1, s[4:7], s19 offen offset:1024
  buffer_load_dwordx4 a[24:27], v1, s[4:7], s19 offen offset:2048
  buffer_load_dwordx4 a[28:31], v1, s[4:7], s19 offen offset:3072
  s_add_u32 s19, s19, 4096
  buffer_load_dwordx4 a[32:35], v1, s[4:7], s19 offen offset:0
  buffer_load_dwordx4 a[36:39], v1, s[4:7], s19 offen offset:1024
  buffer_load_dwordx4 a[40:43], v1, s[4:7], s19 offen offset:2048
  buffer_load_dwordx4 a[44:47], v1, s[4:7], s19 offen offset:3072
  s_add_u32 s19, s19, 4096
  buffer_load_dwordx4 a[48:51], v1, s[4:7], s19 offen offset:0
  buffer_load_dwordx4 a[52:55], v1, s[4:7], s19 offen offset:1024
  buffer_load_dwordx4 a[56:59], v1, s[4:7], s19 offen offset:2048
  buffer_load_dwordx4 a[60:63], v1, s[4:7], s19 offen offset:3072
  s_add_u32 s19, s19, 4096
  buffer_load_dwordx4 a[64:67], v1, s[4:7], s19 offen offset:0
  buffer_load_dwordx4 a[68:71], v1, s[4:7], s19 offen offset:1024
  buffer_load_dwordx4 a[72:75], v1, s[4:7], s19 offen offset:2048
  buffer_load_dwordx4 a[76:79], v1, s[4:7], s19 offen offset:3072
  s_add_u32 s19, s19, 4096
  buffer_load_dwordx4 a[80:83], v1, s[4:7], s19 offen offset:0
  buffer_load_dwordx4 a[84:87], v1, s[4:7], s19 offen offset:1024
  buffer_load_dwordx4 a[88:91], v1, s[4:7], s19 offen offset:2048
  buffer_load_dwordx4 a[92:95], v1, s[4:7], s19 offen offset:3072
  s_add_u32 s19, s19, 4096
  buffer_load_dwordx4 a[96:99], v1, s[4:7], s19 offen offset:0
  buffer_load_dwordx4 a[100:103], v1, s[4:7], s19 offen offset:1024
  buffer_load_dwordx4 a[104:107], v1, s[4:7], s19 offen offset:2048
  buffer_load_dwordx4 a[108:111], v1, s[4:7], s19 offen offset:3072
  s_add_u32 s19, s19, 4096
  buffer_load_dwordx4 a[112:115], v1, s[4:7], s19 offen offset:0
  buffer_load_dwordx4 a[116:119], v1, s[4:7], s19 offen offset:1024
  buffer_load_dwordx4 a[120:123], v1, s[4:7], s19 offen offset:2048
  buffer_load_dwordx4 a[124:127], v1, s[4:7], s19 offen offset:3072
  s_add_u32 s19, s19, 4096
  buffer_load_dwordx4 a[128:131], v1, s[4:7], s19 offen offset:0
  buffer_load_dwordx4 a[132:135], v1, s[4:7], s19 offen offset:1024
  buffer_load_dwordx4 a[136:139], v1, s[4:7], s19 offen offset:2048
  buffer_load_dwordx4 a[140:143], v1, s[4:7], s19 offen offset:3072
  s_add_u32 s19, s19, 4096
  buffer_load_dwordx4 a[144:147], v1, s[4:7], s19 offen offset:0
  buffer_load_dwordx4 a[148:151], v1, s[4:7], s19 offen offset:1024
  buffer_load_dwordx4 a[152:155], v1, s[4:7], s19 offen offset:2048
  buffer_load_dwordx4 a[156:159], v1, s[4:7], s19 offen offset:3072
  s_add_u32 s19, s19, 4096
  buffer_load_dwordx4 a[160:163], v1, s[4:7], s19 offen offset:0
  buffer_load_dwordx4 a[164:167], v1, s[4:7], s19 offen offset:1024
  buffer_load_dwordx4 a[168:171], v1, s[4:7], s19 offen offset:2048
  buffer_load_dwordx4 a[172:175], v1, s[4:7], s19 offen offset:3072
  s_add_u32 s19, s19, 4096
  buffer_load_dwordx4 a[176:179], v1, s[4:7], s19 offen offset:0
  buffer_load_dwordx4 a[180:183], v1, s[4:7], s19 offen offset:1024
  buffer_load_dwordx4 a[184:187], v1, s[4:7], s19 offen offset:2048
  buffer_load_dwordx4 a[188:191], v1, s[4:7], s19 offen offset:3072
  s_add_u32 s19, s19, 4096
  buffer_load_dwordx4 a[192:195], v1, s[4:7], s19 offen offset:0
  buffer_load_dwordx4 a[196:199], v1, s[4:7], s19 offen offset:1024
  buffer_load_dwordx4 a[200:203], v1, s[4:7], s19 offen offset:2048
  buffer_load_dwordx4 a[204:207], v1, s[4:7], s19 offen offset:3072
  s_add_u32 s19, s19, 4096
  buffer_load_dwordx4 a[208:211], v1, s[4:7], s19 offen offset:0
  buffer_load_dwordx4 a[212:215], v1, s[4:7], s19 offen offset:1024
  buffer_load_dwordx4 a[216:219], v1, s[4:7], s19 offen offset:2048
  buffer_load_dwordx4 a[220:223], v1, s[4:7], s19 offen offset:3072
  s_add_u32 s19, s19, 4096
  buffer_load_dwordx4 a[224:227], v1, s[4:7], s19 offen offset:0
  buffer_load_dwordx4 a[228:231], v1, s[4:7], s19 offen offset:1024
  buffer_load_dwordx4 a[232:235], v1, s[4:7], s19 offen offset:2048
  buffer_load_dwordx4 a[236:239], v1, s[4:7], s19 offen offset:3072
  s_add_u32 s19, s19, 4096
  buffer_load_dwordx4 a[240:243], v1, s[4:7], s19 offen offset:0
  buffer_load_dwordx4 a[244:247], v1, s[4:7], s19 offen offset:1024
  buffer_load_dwordx4 a[248:251], v1, s[4:7], s19 offen offset:2048
  buffer_load_dwordx4 a[252:255], v1, s[4:7], s19 offen offset:3072
  s_add_u32 s19, s19, 4096
  buffer_load_dwordx4 v[120:123], v1, s[4:7], s19 offen offset:0
  buffer_load_dwordx4 v[124:127], v1, s[4:7], s19 offen offset:1024
  buffer_load_dwordx4 v[128:131], v1, s[4:7], s19 offen offset:2048
  buffer_load_dwordx4 v[132:135], v1, s[4:7], s19 offen offset:3072
  s_add_u32 s19, s19, 4096
  buffer_load_dwordx4 v[136:139], v1, s[4:7], s19 offen offset:0
  buffer_load_dwordx4 v[140:143], v1, s[4:7], s19 offen offset:1024
  buffer_load_dwordx4 v[144:147], v1, s[4:7], s19 offen offset:2048
  buffer_load_dwordx4 v[148:151], v1, s[4:7], s19 offen offset:3072
  s_add_u32 s19, s19, 4096
  buffer_load_dwordx4 v[152:155], v1, s[4:7], s19 offen offset:0
  buffer_load_dwordx4 v[156:159], v1, s[4:7], s19 offen offset:1024
  buffer_load_dwordx4 v[160:163], v1, s[4:7], s19 offen offset:2048
  buffer_load_dwordx4 v[164:167], v1, s[4:7], s19 offen offset:3072
  s_add_u32 s19, s19, 4096
  buffer_load_dwordx4 v[168:171], v1, s[4:7], s19 offen offset:0
  buffer_load_dwordx4 v[172:175], v1, s[4:7], s19 offen offset:1024
  buffer_load_dwordx4 v[176:179], v1, s[4:7], s19 offen offset:2048
  buffer_load_dwordx4 v[180:183], v1, s[4:7], s19 offen offset:3072
  s_add_u32 s19, s19, 4096
  buffer_load_dwordx4 v[184:187], v1, s[4:7], s19 offen offset:0
  buffer_load_dwordx4 v[188:191], v1, s[4:7], s19 offen offset:1024
  buffer_load_dwordx4 v[192:195], v1, s[4:7], s19 offen offset:2048
  buffer_load_dwordx4 v[196:199], v1, s[4:7], s19 offen offset:3072
  s_add_u32 s19, s19, 4096
  buffer_load_dwordx4 v[200:203], v1, s[4:7], s19 offen offset:0
  buffer_load_dwordx4 v[204:207], v1, s[4:7], s19 offen offset:1024
  buffer_load_dwordx4 v[208:211], v1, s[4:7], s19 offen offset:2048
  buffer_load_dwordx4 v[212:215], v1, s[4:7], s19 offen offset:3072
  s_add_u32 s19, s19, 4096
  buffer_load_dwordx4 v[216:219], v1, s[4:7], s19 offen offset:0
  buffer_load_dwordx4 v[220:223], v1, s[4:7], s19 offen offset:1024
  buffer_load_dwordx4 v[224:227], v1, s[4:7], s19 offen offset:2048
  buffer_load_dwordx4 v[228:231], v1, s[4:7], s19 offen offset:3072
  s_add_u32 s19, s19, 4096
  buffer_load_dwordx4 v[232:235], v1, s[4:7], s19 offen offset:0
  buffer_load_dwordx4 v[236:239], v1, s[4:7], s19 offen offset:1024
  buffer_load_dwordx4 v[240:243], v1, s[4:7], s19 offen offset:2048
  buffer_load_dwordx4 v[244:247], v1, s[4:7], s19 offen offset:3072
  s_add_u32 s19, s19, 4096
  buffer_load_dwordx4 v[248:251], v1, s[4:7], s19 offen offset:0
  buffer_load_dwordx4 v[252:255], v1, s[4:7], s19 offen offset:1024
  s_mul_i32 s17, s8, 7168
  v_add_u32 v3, s17, v1
  v_mov_b32 v58, v3
  s_mov_b32 s18, 45056
  v_mov_b32 v2, 0x0
  v_bfe_u32 v60, v0, 0, 4
  s_mov_b32 s100, 0x10
  v_mul_lo_u32 v60, v60, s100
  v_add_u32 v2, v2, v60
  v_bfe_u32 v60, v0, 4, 2
  s_mov_b32 s100, 0x200
  v_mul_lo_u32 v60, v60, s100
  v_add_u32 v2, v2, v60
  s_mul_i32 s19, s8, 7168
  v_mov_b32 v4, 0x0
  v_bfe_u32 v60, v0, 0, 4
  s_mov_b32 s100, 0x10
  v_mul_lo_u32 v60, v60, s100
  v_add_u32 v4, v4, v60
  v_bfe_u32 v60, v0, 4, 2
  s_mov_b32 s100, 0x400
  v_mul_lo_u32 v60, v60, s100
  v_add_u32 v4, v4, v60
  v_mov_b32 v5, 0x1000
  v_bfe_u32 v60, v0, 0, 4
  s_mov_b32 s100, 0x10
  v_mul_lo_u32 v60, v60, s100
  v_add_u32 v5, v5, v60
  v_bfe_u32 v60, v0, 4, 2
  s_mov_b32 s100, 0x200
  v_mul_lo_u32 v60, v60, s100
  v_add_u32 v5, v5, v60
  v_mov_b32 v6, 0x1800
  v_bfe_u32 v60, v0, 0, 4
  s_mov_b32 s100, 0x10
  v_mul_lo_u32 v60, v60, s100
  v_add_u32 v6, v6, v60
  v_bfe_u32 v60, v0, 4, 1
  s_mov_b32 s100, 0x200
  v_mul_lo_u32 v60, v60, s100
  v_add_u32 v6, v6, v60
  v_bfe_u32 v60, v0, 5, 1
  s_mov_b32 s100, 0x4
  v_mul_lo_u32 v60, v60, s100
  v_add_u32 v6, v6, v60
  v_add_u32 v4, s19, v4
  v_add_u32 v5, s19, v5
  v_add_u32 v6, s19, v6
  v_mov_b32 v7, 0x0
  v_bfe_u32 v60, v0, 0, 1
  s_mov_b32 s100, 0x10
  v_mul_lo_u32 v60, v60, s100
  v_add_u32 v7, v7, v60
  v_bfe_u32 v60, v0, 2, 2
  s_mov_b32 s100, 0x20
  v_mul_lo_u32 v60, v60, s100
  v_add_u32 v7, v7, v60
  v_bfe_u32 v60, v0, 4, 2
  s_mov_b32 s100, 0x100
  v_mul_lo_u32 v60, v60, s100
  v_add_u32 v7, v7, v60
  v_mov_b32 v8, 0x400
  v_bfe_u32 v60, v0, 0, 1
  s_mov_b32 s100, 0x10
  v_mul_lo_u32 v60, v60, s100
  v_add_u32 v8, v8, v60
  v_bfe_u32 v60, v0, 2, 4
  s_mov_b32 s100, 0x20
  v_mul_lo_u32 v60, v60, s100
  v_add_u32 v8, v8, v60
  v_mov_b32 v9, 0x600
  v_bfe_u32 v60, v0, 0, 1
  s_mov_b32 s100, 0x10
  v_mul_lo_u32 v60, v60, s100
  v_add_u32 v9, v9, v60
  v_bfe_u32 v60, v0, 2, 3
  s_mov_b32 s100, 0x20
  v_mul_lo_u32 v60, v60, s100
  v_add_u32 v9, v9, v60
  v_bfe_u32 v60, v0, 5, 1
  s_mov_b32 s100, 0x4
  v_mul_lo_u32 v60, v60, s100
  v_add_u32 v9, v9, v60
  s_lshl_b32 s19, s8, 12
  s_add_u32 s19, s19, 28672
  v_add_u32 v10, s19, v1
  s_and_b32 s19, s8, 1
  s_lshl_b32 s19, s19, 10
  s_add_u32 s19, s19, 28672
  v_add_u32 v11, s19, v1
  v_mov_b32 v13, 0x0
  v_bfe_u32 v60, v0, 0, 4
  s_mov_b32 s100, 0x10
  v_mul_lo_u32 v60, v60, s100
  v_add_u32 v13, v13, v60
  v_bfe_u32 v60, v0, 4, 2
  s_mov_b32 s100, 0x4
  v_mul_lo_u32 v60, v60, s100
  v_add_u32 v13, v13, v60
  s_mov_b32 s56, 0xfff0ffff
  s_mov_b32 s57, 0xf000ff00
  s_mov_b32 s58, 0xffe0fffe
  s_mov_b32 s59, 0xe000fe00
  s_mov_b32 s60, 0xffc0fffc
  s_mov_b32 s61, 0xc000fc00
  s_mov_b32 s62, 0xff80fff8
  s_mov_b32 s63, 0x8000f800
  s_bitcmp1_b32 s8, 0
  s_cselect_b64 s[40:41], -1, s[56:57]
  s_cselect_b64 s[48:49], s[56:57], 0
  s_cselect_b64 s[42:43], -1, s[58:59]
  s_cselect_b64 s[50:51], s[58:59], 0
  s_cselect_b64 s[44:45], -1, s[60:61]
  s_cselect_b64 s[52:53], s[60:61], 0
  s_cselect_b64 s[46:47], -1, s[62:63]
  s_cselect_b64 s[54:55], s[62:63], 0
  s_mov_b32 s16, s23
  s_cmp_lt_i32 s97, 0
  s_cbranch_scc1 nf_175
  s_mov_b32 s101, 18907136
  v_mbcnt_lo_u32_b32 v61, -1, 0
  v_mbcnt_hi_u32_b32 v61, -1, v61
  s_lshl_b32 s100, s8, 6
  v_add_u32 v61, s100, v61
  v_min_u32 v61, 255, v61
  v_lshlrev_b32 v61, 7, v61
  s_branch wc_176x
wc_176:
  s_sleep 2
wc_176x:
  buffer_load_dword v60, v61, s[4:7], s101 offen sc1
  s_sub_u32 s99, s99, 1
  s_cbranch_scc1 FAIL
  s_waitcnt vmcnt(0)
  v_cmp_eq_u32 vcc, 0, v60
  s_cbranch_vccnz wc_176
wcd_177:
  s_barrier
  v_mov_b32 v60, -1
  v_mov_b32 v61, -1
  v_mov_b32 v62, -1
  v_mov_b32 v63, -1
  s_lshl_b32 s100, s97, 2
  s_add_u32 s100, s100, s8
  s_lshl_b32 s100, s100, 10
  s_add_u32 s100, s100, 29753344
fl_178:
  s_cmp_ge_u32 s100, 32505856
  s_cbranch_scc1 fd_179
  buffer_store_dwordx4 v[60:63], v1, s[4:7], s100 offen sc1
  s_add_u32 s100, s100, 360448
  s_branch fl_178
fd_179:
  s_add_u32 s100, s100, 458752
fl_180:
  s_cmp_ge_u32 s100, 34340864
  s_cbranch_scc1 fd_181
  buffer_store_dwordx4 v[60:63], v1, s[4:7], s100 offen sc1
  s_add_u32 s100, s100, 360448
  s_branch fl_180
fd_181:
  s_add_u32 s100, s100, 458752
fl_182:
  s_cmp_ge_u32 s100, 36175872
  s_cbranch_scc1 fd_183
  buffer_store_dwordx4 v[60:63], v1, s[4:7], s100 offen sc1
  s_add_u32 s100, s100, 360448
  s_branch fl_182
fd_183:
  s_add_u32 s100, s100, 458752
fl_184:
  s_cmp_ge_u32 s100, 38010880
  s_cbranch_scc1 fd_185
  buffer_store_dwordx4 v[60:63], v1, s[4:7], s100 offen sc1
  s_add_u32 s100, s100, 360448
  s_branch fl_184
fd_185:
  s_add_u32 s100, s100, 458752
fl_186:
  s_cmp_ge_u32 s100, 39845888
  s_cbranch_scc1 fd_187
  buffer_store_dwordx4 v[60:63], v1, s[4:7], s100 offen sc1
  s_add_u32 s100, s100, 360448
  s_branch fl_186
fd_187:
  s_add_u32 s100, s100, 655360
fl_188:
  s_cmp_ge_u32 s100, 42467328
  s_cbranch_scc1 fd_189
  buffer_store_dwordx4 v[60:63], v1, s[4:7], s100 offen sc1
  s_add_u32 s100, s100, 360448
  s_branch fl_188
fd_189:
  s_add_u32 s100, s100, 655360
fl_190:
  s_cmp_ge_u32 s100, 45088768
  s_cbranch_scc1 fd_191
  buffer_store_dwordx4 v[60:63], v1, s[4:7], s100 offen sc1
  s_add_u32 s100, s100, 360448
  s_branch fl_190
fd_191:
  s_add_u32 s100, s100, 163840
fl_192:
  s_cmp_ge_u32 s100, 45744128
  s_cbranch_scc1 fd_193
  buffer_store_dwordx4 v[60:63], v1, s[4:7], s100 offen sc1
  s_add_u32 s100, s100, 360448
  s_branch fl_192
fd_193:
  s_add_u32 s100, s100, 163840
fl_194:
  s_cmp_ge_u32 s100, 46399488
  s_cbranch_scc1 fd_195
  buffer_store_dwordx4 v[60:63], v1, s[4:7], s100 offen sc1
  s_add_u32 s100, s100, 360448
  s_branch fl_194
fd_195:
  s_waitcnt vmcnt(0)
  s_barrier
  s_cmp_lg_u32 s8, 0
  s_cbranch_scc1 arr_196
  v_mov_b32 v60, 1
  s_mov_b64 exec, 1
  s_mov_b32 s100, 18903040
  buffer_atomic_add v60, off, s[4:7], s100 sc0
  s_waitcnt vmcnt(0)
  v_readfirstlane_b32 s100, v60
  s_cmp_lg_u32 s100, 87
  s_cbranch_scc1 arr_196x
  s_mov_b32 s100, 18903424
  s_nop 1
  buffer_store_dword v60, off, s[4:7], s100 sc1
arr_196x:
  s_mov_b64 exec, -1
arr_196:
nf_175:
  s_mov_b32 s101, 18907136
  v_mbcnt_lo_u32_b32 v61, -1, 0
  v_mbcnt_hi_u32_b32 v61, -1, v61
  s_lshl_b32 s100, s8, 6
  v_add_u32 v61, s100, v61
  v_min_u32 v61, 255, v61
  v_lshlrev_b32 v61, 7, v61
  s_branch wc_197x
wc_197:
  s_sleep 2
wc_197x:
  buffer_load_dword v60, v61, s[4:7], s101 offen sc1
  s_sub_u32 s99, s99, 1
  s_cbranch_scc1 FAIL
  s_waitcnt vmcnt(0)
  v_cmp_eq_u32 vcc, 0, v60
  s_cbranch_vccnz wc_197
wcd_198:
  s_barrier
  s_min_u32 s19, s23, 63
  s_mul_i32 s19, s19, 28672
  s_mul_i32 s21, s11, 7340032
  s_add_u32 s21, s21, s19
  s_add_u32 s21, s21, 25165824
  s_mov_b32 m0, s17
  s_nop 0
  buffer_load_dwordx4 v3, s[4:7], s21 offen offset:0 sc1 lds
  buffer_load_dwordx4 v3, s[4:7], s21 offen offset:1024 sc1 lds
  buffer_load_dwordx4 v3, s[4:7], s21 offen offset:2048 sc1 lds
  buffer_load_dwordx4 v3, s[4:7], s21 offen offset:3072 sc1 lds
  s_add_u32 m0, s17, 4096
  s_add_u32 s19, s21, 4096
  buffer_load_dwordx4 v3, s[4:7], s19 offen offset:0 sc1 lds
  buffer_load_dwordx4 v3, s[4:7], s19 offen offset:1024 sc1 lds
  buffer_load_dwordx4 v3, s[4:7], s19 offen offset:2048 sc1 lds
  s_waitcnt vmcnt(0)
Q_loop:
  s_cmp_eq_u32 s11, 0
  s_cbranch_scc1 Q_nochk
  ds_read2st64_b32 v[60:61], v58 offset0:0 offset1:4
  ds_read2st64_b32 v[62:63], v58 offset0:8 offset1:12
  ds_read2st64_b32 v[64:65], v58 offset0:16 offset1:20
  ds_read2st64_b32 v[66:67], v58 offset0:24 offset1:24
  s_waitcnt lgkmcnt(0)
  v_max3_u32 v12, v60, v61, v62
  v_max3_u32 v12, v12, v63, v64
  v_max3_u32 v12, v12, v65, v66
  v_cmp_eq_u32 vcc, -1, v12
  s_cbranch_vccz tok_199
  s_add_u32 s19, s21, 4096
stg_200:
  buffer_load_dwordx4 v[60:63], v3, s[4:7], s21 offen offset:0 sc1
  buffer_load_dwordx4 v[64:67], v3, s[4:7], s21 offen offset:1024 sc1
  buffer_load_dwordx4 v[68:71], v3, s[4:7], s21 offen offset:2048 sc1
  buffer_load_dwordx4 v[72:75], v3, s[4:7], s21 offen offset:3072 sc1
  buffer_load_dwordx4 v[76:79], v3, s[4:7], s19 offen offset:0 sc1
  buffer_load_dwordx4 v[80:83], v3, s[4:7], s19 offen offset:1024 sc1
  buffer_load_dwordx4 v[84:87], v3, s[4:7], s19 offen offset:2048 sc1
  s_sub_u32 s99, s99, 1
  s_cbranch_scc1 FAIL
  s_waitcnt vmcnt(6)
  ds_write_b128 v58, v[60:63] offset:0
  s_waitcnt vmcnt(5)
  ds_write_b128 v58, v[64:67] offset:1024
  s_waitcnt vmcnt(4)
  ds_write_b128 v58, v[68:71] offset:2048
  s_waitcnt vmcnt(3)
  ds_write_b128 v58, v[72:75] offset:3072
  s_waitcnt vmcnt(2)
  ds_write_b128 v58, v[76:79] offset:4096
  s_waitcnt vmcnt(1)
  ds_write_b128 v58, v[80:83] offset:5120
  s_waitcnt vmcnt(0)
  ds_write_b128 v58, v[84:87] offset:6144
  v_max3_u32 v12, v60, v64, v68
  v_max3_u32 v12, v12, v72, v76
  v_max3_u32 v12, v12, v80, v84
  v_cmp_eq_u32 vcc, -1, v12
  s_waitcnt lgkmcnt(0)
  s_cbranch_vccnz stg_200
tok_199:
Q_nochk:
  s_barrier
  ds_read_b128 v[14:17], v2 offset:0
  ds_read_b128 v[18:21], v2 offset:256
  s_waitcnt lgkmcnt(0)
  v_mfma_f32_16x16x32_bf16 v[88:91], a[0:3], v[18:21], 0
  ds_read_b128 v[22:25], v2 offset:2048
  v_mfma_f32_16x16x32_bf16 v[92:95], a[56:59], v[18:21], 0
  ds_read_b128 v[26:29], v2 offset:2304
  v_mfma_f32_16x16x32_bf16 v[96:99], a[112:115], v[18:21], 0
  s_mul_i32 s13, s16, 57344
  v_mfma_f32_16x16x32_bf16 v[100:103], a[168:171], v[18:21], 0
  s_mul_i32 s19, s11, 28672
  v_mfma_f32_16x16x32_bf16 v[104:107], a[224:227], v[18:21], 0
  s_add_u32 s13, s13, s19
  v_mfma_f32_16x16x32_bf16 v[108:111], v[144:147], v[18:21], 0
  s_mul_i32 s19, s8, 1792
  v_mfma_f32_16x16x32_bf16 v[112:115], v[200:203], v[18:21], 0
  s_add_u32 s13, s13, s19
  v_mfma_f32_16x16x32_bf16 v[60:63], a[0:3], v[14:17], 0
  v_mfma_f32_16x16x32_bf16 v[64:67], a[56:59], v[14:17], 0
  v_mfma_f32_16x16x32_bf16 v[68:71], a[112:115], v[14:17], 0
  s_add_u32 s13, s13, 28857344
  v_mfma_f32_16x16x32_bf16 v[72:75], a[168:171], v[14:17], 0
  s_lshl_b32 s19, s11, 6
  v_mfma_f32_16x16x32_bf16 v[76:79], a[224:227], v[14:17], 0
  s_add_u32 s19, s19, s16
  v_mfma_f32_16x16x32_bf16 v[80:83], v[144:147], v[14:17], 0
  s_mul_i32 s14, s19, 40960
  v_mfma_f32_16x16x32_bf16 v[84:87], v[200:203], v[14:17], 0
  s_waitcnt lgkmcnt(0)
  s_add_u32 s14, s14, 39845888
  v_mfma_f32_16x16x32_bf16 v[88:91], a[4:7], v[26:29], v[88:91]
  ds_read_b128 v[14:17], v2 offset:4096
  v_mfma_f32_16x16x32_bf16 v[92:95], a[60:63], v[26:29], v[92:95]
  ds_read_b128 v[18:21], v2 offset:4352
  v_mfma_f32_16x16x32_bf16 v[96:99], a[116:119], v[26:29], v[96:99]
  s_lshl_b32 s19, s10, 1
  v_mfma_f32_16x16x32_bf16 v[100:103], a[172:175], v[26:29], v[100:103]
  s_and_b32 s20, s8, 1
  v_mfma_f32_16x16x32_bf16 v[104:107], a[228:231], v[26:29], v[104:107]
  s_add_u32 s19, s19, s20
  v_mfma_f32_16x16x32_bf16 v[108:111], v[148:151], v[26:29], v[108:111]
  s_lshl_b32 s20, s19, 8
  v_mfma_f32_16x16x32_bf16 v[112:115], v[204:207], v[26:29], v[112:115]
  s_add_u32 s15, s14, s20
  v_mfma_f32_16x16x32_bf16 v[60:63], a[4:7], v[22:25], v[60:63]
  v_mfma_f32_16x16x32_bf16 v[64:67], a[60:63], v[22:25], v[64:67]
  v_mfma_f32_16x16x32_bf16 v[68:71], a[116:119], v[22:25], v[68:71]
  s_add_u32 s15, s15, 32768
  v_mfma_f32_16x16x32_bf16 v[72:75], a[172:175], v[22:25], v[72:75]
  s_lshl_b32 s20, s19, 10
  v_mfma_f32_16x16x32_bf16 v[76:79], a[228:231], v[22:25], v[76:79]
  s_add_u32 s14, s14, s20
  v_mfma_f32_16x16x32_bf16 v[80:83], v[148:151], v[22:25], v[80:83]
  s_add_u32 s20, s16, 2
  v_mfma_f32_16x16x32_bf16 v[84:87], v[204:207], v[22:25], v[84:87]
  s_waitcnt lgkmcnt(0)
  s_add_u32 s17, s17, s18
  v_mfma_f32_16x16x32_bf16 v[88:91], a[8:11], v[18:21], v[88:91]
  ds_read_b128 v[22:25], v2 offset:6144
  v_mfma_f32_16x16x32_bf16 v[92:95], a[64:67], v[18:21], v[92:95]
  ds_read_b128 v[26:29], v2 offset:6400
  v_mfma_f32_16x16x32_bf16 v[96:99], a[120:123], v[18:21], v[96:99]
  s_min_u32 s19, s20, 63
  v_mfma_f32_16x16x32_bf16 v[100:103], a[176:179], v[18:21], v[100:103]
  s_mul_i32 s19, s19, 28672
  v_mfma_f32_16x16x32_bf16 v[104:107], a[232:235], v[18:21], v[104:107]
  s_mul_i32 s21, s11, 7340032
  v_mfma_f32_16x16x32_bf16 v[108:111], v[152:155], v[18:21], v[108:111]
  s_add_u32 s21, s21, s19
  v_mfma_f32_16x16x32_bf16 v[112:115], v[208:211], v[18:21], v[112:115]
  s_add_u32 s21, s21, 25165824
  v_mfma_f32_16x16x32_bf16 v[60:63], a[8:11], v[14:17], v[60:63]
  v_mfma_f32_16x16x32_bf16 v[64:67], a[64:67], v[14:17], v[64:67]
  v_mfma_f32_16x16x32_bf16 v[68:71], a[120:123], v[14:17], v[68:71]
  v_mfma_f32_16x16x32_bf16 v[72:75], a[176:179], v[14:17], v[72:75]
  v_mfma_f32_16x16x32_bf16 v[76:79], a[232:235], v[14:17], v[76:79]
  v_mfma_f32_16x16x32_bf16 v[80:83], v[152:155], v[14:17], v[80:83]
  v_mfma_f32_16x16x32_bf16 v[84:87], v[208:211], v[14:17], v[84:87]
  s_waitcnt lgkmcnt(0)
  v_mfma_f32_16x16x32_bf16 v[88:91], a[12:15], v[26:29], v[88:91]
  ds_read_b128 v[14:17], v2 offset:8192
  v_mfma_f32_16x16x32_bf16 v[92:95], a[68:71], v[26:29], v[92:95]
  ds_read_b128 v[18:21], v2 offset:8448
  v_mfma_f32_16x16x32_bf16 v[96:99], a[124:127], v[26:29], v[96:99]
  v_mfma_f32_16x16x32_bf16 v[100:103], a[180:183], v[26:29], v[100:103]
  v_mfma_f32_16x16x32_bf16 v[104:107], a[236:239], v[26:29], v[104:107]
  v_mfma_f32_16x16x32_bf16 v[108:111], v[156:159], v[26:29], v[108:111]
  v_mfma_f32_16x16x32_bf16 v[112:115], v[212:215], v[26:29], v[112:115]
  v_mfma_f32_16x16x32_bf16 v[60:63], a[12:15], v[22:25], v[60:63]
  v_mfma_f32_16x16x32_bf16 v[64:67], a[68:71], v[22:25], v[64:67]
  v_mfma_f32_16x16x32_bf16 v[68:71], a[124:127], v[22:25], v[68:71]
  v_mfma_f32_16x16x32_bf16 v[72:75], a[180:183], v[22:25], v[72:75]
  v_mfma_f32_16x16x32_bf16 v[76:79], a[236:239], v[22:25], v[76:79]
  v_mfma_f32_16x16x32_bf16 v[80:83], v[156:159], v[22:25], v[80:83]
  v_mfma_f32_16x16x32_bf16 v[84:87], v[212:215], v[22:25], v[84:87]
  s_waitcnt lgkmcnt(0)
  v_mfma_f32_16x16x32_bf16 v[88:91], a[16:19], v[18:21], v[88:91]
  ds_read_b128 v[22:25], v2 offset:10240
  v_mfma_f32_16x16x32_bf16 v[92:95], a[72:75], v[18:21], v[92:95]
  ds_read_b128 v[26:29], v2 offset:10496
  v_mfma_f32_16x16x32_bf16 v[96:99], a[128:131], v[18:21], v[96:99]
  v_mfma_f32_16x16x32_bf16 v[100:103], a[184:187], v[18:21], v[100:103]
  v_mfma_f32_16x16x32_bf16 v[104:107], a[240:243], v[18:21], v[104:107]
  v_mfma_f32_16x16x32_bf16 v[108:111], v[160:163], v[18:21], v[108:111]
  v_mfma_f32_16x16x32_bf16 v[112:115], v[216:219], v[18:21], v[112:115]
  v_mfma_f32_16x16x32_bf16 v[60:63], a[16:19], v[14:17], v[60:63]
  v_mfma_f32_16x16x32_bf16 v[64:67], a[72:75], v[14:17], v[64:67]
  v_mfma_f32_16x16x32_bf16 v[68:71], a[128:131], v[14:17], v[68:71]
  v_mfma_f32_16x16x32_bf16 v[72:75], a[184:187], v[14:17], v[72:75]
  v_mfma_f32_16x16x32_bf16 v[76:79], a[240:243], v[14:17], v[76:79]
  v_mfma_f32_16x16x32_bf16 v[80:83], v[160:163], v[14:17], v[80:83]
  v_mfma_f32_16x16x32_bf16 v[84:87], v[216:219], v[14:17], v[84:87]
  s_waitcnt lgkmcnt(0)
  v_mfma_f32_16x16x32_bf16 v[88:91], a[20:23], v[26:29], v[88:91]
  ds_read_b128 v[14:17], v2 offset:12288
  v_mfma_f32_16x16x32_bf16 v[92:95], a[76:79], v[26:29], v[92:95]
  ds_read_b128 v[18:21], v2 offset:12544
  v_mfma_f32_16x16x32_bf16 v[96:99], a[132:135], v[26:29], v[96:99]
  v_mfma_f32_16x16x32_bf16 v[100:103], a[188:191], v[26:29], v[100:103]
  v_mfma_f32_16x16x32_bf16 v[104:107], a[244:247], v[26:29], v[104:107]
  v_mfma_f32_16x16x32_bf16 v[108:111], v[164:167], v[26:29], v[108:111]
  v_mfma_f32_16x16x32_bf16 v[112:115], v[220:223], v[26:29], v[112:115]
  v_mfma_f32_16x16x32_bf16 v[60:63], a[20:23], v[22:25], v[60:63]
  v_mfma_f32_16x16x32_bf16 v[64:67], a[76:79], v[22:25], v[64:67]
  v_mfma_f32_16x16x32_bf16 v[68:71], a[132:135], v[22:25], v[68:71]
  v_mfma_f32_16x16x32_bf16 v[72:75], a[188:191], v[22:25], v[72:75]
  v_mfma_f32_16x16x32_bf16 v[76:79], a[244:247], v[22:25], v[76:79]
  v_mfma_f32_16x16x32_bf16 v[80:83], v[164:167], v[22:25], v[80:83]
  v_mfma_f32_16x16x32_bf16 v[84:87], v[220:223], v[22:25], v[84:87]
  s_waitcnt lgkmcnt(0)
  v_mfma_f32_16x16x32_bf16 v[88:91], a[24:27], v[18:21], v[88:91]
  ds_read_b128 v[22:25], v2 offset:14336
  v_mfma_f32_16x16x32_bf16 v[92:95], a[80:83], v[18:21], v[92:95]
  ds_read_b128 v[26:29], v2 offset:14592
  v_mfma_f32_16x16x32_bf16 v[96:99], a[136:139], v[18:21], v[96:99]
  v_mfma_f32_16x16x32_bf16 v[100:103], a[192:195], v[18:21], v[100:103]
  v_mfma_f32_16x16x32_bf16 v[104:107], a[248:251], v[18:21], v[104:107]
  v_mfma_f32_16x16x32_bf16 v[108:111], v[168:171], v[18:21], v[108:111]
  v_mfma_f32_16x16x32_bf16 v[112:115], v[224:227], v[18:21], v[112:115]
  v_mfma_f32_16x16x32_bf16 v[60:63], a[24:27], v[14:17], v[60:63]
  v_mfma_f32_16x16x32_bf16 v[64:67], a[80:83], v[14:17], v[64:67]
  v_mfma_f32_16x16x32_bf16 v[68:71], a[136:139], v[14:17], v[68:71]
  v_mfma_f32_16x16x32_bf16 v[72:75], a[192:195], v[14:17], v[72:75]
  v_mfma_f32_16x16x32_bf16 v[76:79], a[248:251], v[14:17], v[76:79]
  v_mfma_f32_16x16x32_bf16 v[80:83], v[168:171], v[14:17], v[80:83]
  v_mfma_f32_16x16x32_bf16 v[84:87], v[224:227], v[14:17], v[84:87]
  s_waitcnt lgkmcnt(0)
  v_mfma_f32_16x16x32_bf16 v[88:91], a[28:31], v[26:29], v[88:91]
  ds_read_b128 v[14:17], v2 offset:16384
  v_mfma_f32_16x16x32_bf16 v[92:95], a[84:87], v[26:29], v[92:95]
  ds_read_b128 v[18:21], v2 offset:16640
  v_mfma_f32_16x16x32_bf16 v[96:99], a[140:143], v[26:29], v[96:99]
  v_mfma_f32_16x16x32_bf16 v[100:103], a[196:199], v[26:29], v[100:103]
  s_mov_b32 m0, s17
  s_nop 0
  buffer_load_dwordx4 v3, s[4:7], s21 offen offset:0 sc1 lds
  v_mfma_f32_16x16x32_bf16 v[104:107], a[252:255], v[26:29], v[104:107]
  v_mfma_f32_16x16x32_bf16 v[108:111], v[172:175], v[26:29], v[108:111]
  v_mfma_f32_16x16x32_bf16 v[112:115], v[228:231], v[26:29], v[112:115]
  v_mfma_f32_16x16x32_bf16 v[60:63], a[28:31], v[22:25], v[60:63]
  v_mfma_f32_16x16x32_bf16 v[64:67], a[84:87], v[22:25], v[64:67]
  v_mfma_f32_16x16x32_bf16 v[68:71], a[140:143], v[22:25], v[68:71]
  v_mfma_f32_16x16x32_bf16 v[72:75], a[196:199], v[22:25], v[72:75]
  buffer_load_dwordx4 v3, s[4:7], s21 offen offset:1024 sc1 lds
  v_mfma_f32_16x16x32_bf16 v[76:79], a[252:255], v[22:25], v[76:79]
  v_mfma_f32_16x16x32_bf16 v[80:83], v[172:175], v[22:25], v[80:83]
  v_mfma_f32_16x16x32_bf16 v[84:87], v[228:231], v[22:25], v[84:87]
  s_waitcnt lgkmcnt(0)
  v_mfma_f32_16x16x32_bf16 v[88:91], a[32:35], v[18:21], v[88:91]
  ds_read_b128 v[22:25], v2 offset:18432
  v_mfma_f32_16x16x32_bf16 v[92:95], a[88:91], v[18:21], v[92:95]
  ds_read_b128 v[26:29], v2 offset:18688
  v_mfma_f32_16x16x32_bf16 v[96:99], a[144:147], v[18:21], v[96:99]
  v_mfma_f32_16x16x32_bf16 v[100:103], a[200:203], v[18:21], v[100:103]
  buffer_load_dwordx4 v3, s[4:7], s21 offen offset:2048 sc1 lds
  v_mfma_f32_16x16x32_bf16 v[104:107], v[120:123], v[18:21], v[104:107]
  v_mfma_f32_16x16x32_bf16 v[108:111], v[176:179], v[18:21], v[108:111]
  v_mfma_f32_16x16x32_bf16 v[112:115], v[232:235], v[18:21], v[112:115]
  v_mfma_f32_16x16x32_bf16 v[60:63], a[32:35], v[14:17], v[60:63]
  v_mfma_f32_16x16x32_bf16 v[64:67], a[88:91], v[14:17], v[64:67]
  v_mfma_f32_16x16x32_bf16 v[68:71], a[144:147], v[14:17], v[68:71]
  v_mfma_f32_16x16x32_bf16 v[72:75], a[200:203], v[14:17], v[72:75]
  buffer_load_dwordx4 v3, s[4:7], s21 offen offset:3072 sc1 lds
  v_mfma_f32_16x16x32_bf16 v[76:79], v[120:123], v[14:17], v[76:79]
  v_mfma_f32_16x16x32_bf16 v[80:83], v[176:179], v[14:17], v[80:83]
  v_mfma_f32_16x16x32_bf16 v[84:87], v[232:235], v[14:17], v[84:87]
  s_waitcnt lgkmcnt(0)
  v_mfma_f32_16x16x32_bf16 v[88:91], a[36:39], v[26:29], v[88:91]
  ds_read_b128 v[14:17], v2 offset:20480
  v_mfma_f32_16x16x32_bf16 v[92:95], a[92:95], v[26:29], v[92:95]
  ds_read_b128 v[18:21], v2 offset:20736
  v_mfma_f32_16x16x32_bf16 v[96:99], a[148:151], v[26:29], v[96:99]
  v_mfma_f32_16x16x32_bf16 v[100:103], a[204:207], v[26:29], v[100:103]
  s_add_u32 m0, s17, 4096
  s_add_u32 s19, s21, 4096
  buffer_load_dwordx4 v3, s[4:7], s19 offen offset:0 sc1 lds
  v_mfma_f32_16x16x32_bf16 v[104:107], v[124:127], v[26:29], v[104:107]
  v_mfma_f32_16x16x32_bf16 v[108:111], v[180:183], v[26:29], v[108:111]
  v_mfma_f32_16x16x32_bf16 v[112:115], v[236:239], v[26:29], v[112:115]
  v_mfma_f32_16x16x32_bf16 v[60:63], a[36:39], v[22:25], v[60:63]
  v_mfma_f32_16x16x32_bf16 v[64:67], a[92:95], v[22:25], v[64:67]
  v_mfma_f32_16x16x32_bf16 v[68:71], a[148:151], v[22:25], v[68:71]
  v_mfma_f32_16x16x32_bf16 v[72:75], a[204:207], v[22:25], v[72:75]
  buffer_load_dwordx4 v3, s[4:7], s19 offen offset:1024 sc1 lds
  v_mfma_f32_16x16x32_bf16 v[76:79], v[124:127], v[22:25], v[76:79]
  v_mfma_f32_16x16x32_bf16 v[80:83], v[180:183], v[22:25], v[80:83]
  v_mfma_f32_16x16x32_bf16 v[84:87], v[236:239], v[22:25], v[84:87]
  s_waitcnt lgkmcnt(0)
  v_mfma_f32_16x16x32_bf16 v[88:91], a[40:43], v[18:21], v[88:91]
  ds_read_b128 v[22:25], v2 offset:22528
  v_mfma_f32_16x16x32_bf16 v[92:95], a[96:99], v[18:21], v[92:95]
  ds_read_b128 v[26:29], v2 offset:22784
  v_mfma_f32_16x16x32_bf16 v[96:99], a[152:155], v[18:21], v[96:99]
  v_mfma_f32_16x16x32_bf16 v[100:103], a[208:211], v[18:21], v[100:103]
  buffer_load_dwordx4 v3, s[4:7], s19 offen offset:2048 sc1 lds
  v_mfma_f32_16x16x32_bf16 v[104:107], v[128:131], v[18:21], v[104:107]
  v_mfma_f32_16x16x32_bf16 v[108:111], v[184:187], v[18:21], v[108:111]
  v_mfma_f32_16x16x32_bf16 v[112:115], v[240:243], v[18:21], v[112:115]
  v_mfma_f32_16x16x32_bf16 v[60:63], a[40:43], v[14:17], v[60:63]
  v_mfma_f32_16x16x32_bf16 v[64:67], a[96:99], v[14:17], v[64:67]
  v_mfma_f32_16x16x32_bf16 v[68:71], a[152:155], v[14:17], v[68:71]
  v_mfma_f32_16x16x32_bf16 v[72:75], a[208:211], v[14:17], v[72:75]
  v_mfma_f32_16x16x32_bf16 v[76:79], v[128:131], v[14:17], v[76:79]
  v_mfma_f32_16x16x32_bf16 v[80:83], v[184:187], v[14:17], v[80:83]
  v_mfma_f32_16x16x32_bf16 v[84:87], v[240:243], v[14:17], v[84:87]
  s_waitcnt lgkmcnt(0)
  v_mfma_f32_16x16x32_bf16 v[88:91], a[44:47], v[26:29], v[88:91]
  ds_read_b128 v[14:17], v2 offset:24576
  v_mfma_f32_16x16x32_bf16 v[92:95], a[100:103], v[26:29], v[92:95]
  ds_read_b128 v[18:21], v2 offset:24832
  v_mfma_f32_16x16x32_bf16 v[96:99], a[156:159], v[26:29], v[96:99]
  buffer_load_dwordx4 v[44:47], v7, s[4:7], s13 offen sc1
  v_mfma_f32_16x16x32_bf16 v[100:103], a[212:215], v[26:29], v[100:103]
  v_mfma_f32_16x16x32_bf16 v[104:107], v[132:135], v[26:29], v[104:107]
  buffer_load_dwordx4 v[48:51], v7, s[4:7], s13 offen offset:128 sc1
  v_mfma_f32_16x16x32_bf16 v[108:111], v[188:191], v[26:29], v[108:111]
  v_mfma_f32_16x16x32_bf16 v[112:115], v[244:247], v[26:29], v[112:115]
  buffer_load_dwordx4 v[52:55], v8, s[4:7], s13 offen sc1
  v_mfma_f32_16x16x32_bf16 v[60:63], a[44:47], v[22:25], v[60:63]
  buffer_load_dword v56, v9, s[4:7], s13 offen sc1
  v_mfma_f32_16x16x32_bf16 v[64:67], a[100:103], v[22:25], v[64:67]
  v_mfma_f32_16x16x32_bf16 v[68:71], a[156:159], v[22:25], v[68:71]
  buffer_load_dword v57, v9, s[4:7], s13 offen offset:8 sc1
  v_mfma_f32_16x16x32_bf16 v[72:75], a[212:215], v[22:25], v[72:75]
  v_mfma_f32_16x16x32_bf16 v[76:79], v[132:135], v[22:25], v[76:79]
  v_mfma_f32_16x16x32_bf16 v[80:83], v[188:191], v[22:25], v[80:83]
  v_mfma_f32_16x16x32_bf16 v[84:87], v[244:247], v[22:25], v[84:87]
  s_waitcnt lgkmcnt(0)
  v_mfma_f32_16x16x32_bf16 v[88:91], a[48:51], v[18:21], v[88:91]
  ds_read_b128 v[22:25], v2 offset:26624
  v_mfma_f32_16x16x32_bf16 v[92:95], a[104:107], v[18:21], v[92:95]
  ds_read_b128 v[26:29], v2 offset:26880
  v_mfma_f32_16x16x32_bf16 v[96:99], a[160:163], v[18:21], v[96:99]
  v_mfma_f32_16x16x32_bf16 v[100:103], a[216:219], v[18:21], v[100:103]
  v_mfma_f32_16x16x32_bf16 v[104:107], v[136:139], v[18:21], v[104:107]
  v_mfma_f32_16x16x32_bf16 v[108:111], v[192:195], v[18:21], v[108:111]
  v_mfma_f32_16x16x32_bf16 v[112:115], v[248:251], v[18:21], v[112:115]
  v_mfma_f32_16x16x32_bf16 v[60:63], a[48:51], v[14:17], v[60:63]
  v_mfma_f32_16x16x32_bf16 v[64:67], a[104:107], v[14:17], v[64:67]
  v_mfma_f32_16x16x32_bf16 v[68:71], a[160:163], v[14:17], v[68:71]
  v_mfma_f32_16x16x32_bf16 v[72:75], a[216:219], v[14:17], v[72:75]
  v_mfma_f32_16x16x32_bf16 v[76:79], v[136:139], v[14:17], v[76:79]
  v_mfma_f32_16x16x32_bf16 v[80:83], v[192:195], v[14:17], v[80:83]
  v_mfma_f32_16x16x32_bf16 v[84:87], v[248:251], v[14:17], v[84:87]
  s_waitcnt lgkmcnt(0)
  v_mfma_f32_16x16x32_bf16 v[88:91], a[52:55], v[26:29], v[88:91]
  ds_read_b128 v[30:33], v4 offset:256
  v_mfma_f32_16x16x32_bf16 v[92:95], a[108:111], v[26:29], v[92:95]
  ds_read_b128 v[34:37], v4 offset:768
  v_mfma_f32_16x16x32_bf16 v[96:99], a[164:167], v[26:29], v[96:99]
  ds_read_b128 v[38:41], v5 offset:256
  v_mfma_f32_16x16x32_bf16 v[100:103], a[220:223], v[26:29], v[100:103]
  ds_read2_b32 v[42:43], v6 offset0:64 offset1:66
  v_mfma_f32_16x16x32_bf16 v[104:107], v[140:143], v[26:29], v[104:107]
  v_mfma_f32_16x16x32_bf16 v[108:111], v[196:199], v[26:29], v[108:111]
  v_mfma_f32_16x16x32_bf16 v[112:115], v[252:255], v[26:29], v[112:115]
  v_mfma_f32_16x16x32_bf16 v[60:63], a[52:55], v[22:25], v[60:63]
  v_cvt_pk_bf16_f32 v88, v88, v89
  v_cvt_pk_bf16_f32 v89, v92, v93
  v_mfma_f32_16x16x32_bf16 v[64:67], a[108:111], v[22:25], v[64:67]
  v_cvt_pk_bf16_f32 v90, v90, v91
  v_cvt_pk_bf16_f32 v91, v94, v95
  v_mfma_f32_16x16x32_bf16 v[68:71], a[164:167], v[22:25], v[68:71]
  v_cvt_pk_bf16_f32 v96, v96, v97
  v_cvt_pk_bf16_f32 v97, v100, v101
  v_mfma_f32_16x16x32_bf16 v[72:75], a[220:223], v[22:25], v[72:75]
  v_cvt_pk_bf16_f32 v98, v98, v99
  v_cvt_pk_bf16_f32 v99, v102, v103
  v_mfma_f32_16x16x32_bf16 v[76:79], v[140:143], v[22:25], v[76:79]
  v_cvt_pk_bf16_f32 v104, v104, v105
  v_cvt_pk_bf16_f32 v105, v108, v109
  v_mfma_f32_16x16x32_bf16 v[80:83], v[196:199], v[22:25], v[80:83]
  v_cvt_pk_bf16_f32 v106, v106, v107
  v_cvt_pk_bf16_f32 v107, v110, v111
  v_mfma_f32_16x16x32_bf16 v[84:87], v[252:255], v[22:25], v[84:87]
  v_cvt_pk_bf16_f32 v112, v112, v113
  v_cvt_pk_bf16_f32 v113, v114, v115
  ds_read_b128 v[14:17], v4 offset:0
  ds_read_b128 v[18:21], v4 offset:512
  ds_read_b128 v[22:25], v5 offset:0
  ds_read2_b32 v[26:27], v6 offset0:0 offset1:2
  s_waitcnt lgkmcnt(4)
  v_mfma_f32_16x16x32_bf16 v[92:95], v[30:33], v[88:91], 0
  v_cvt_pk_bf16_f32 v60, v60, v61
  v_cvt_pk_bf16_f32 v61, v64, v65
  v_mfma_f32_16x16x32_bf16 v[92:95], v[34:37], v[96:99], v[92:95]
  v_cvt_pk_bf16_f32 v62, v62, v63
  v_cvt_pk_bf16_f32 v63, v66, v67
  v_mfma_f32_16x16x32_bf16 v[92:95], v[38:41], v[104:107], v[92:95]
  v_cvt_pk_bf16_f32 v68, v68, v69
  v_cvt_pk_bf16_f32 v69, v72, v73
  s_waitcnt lgkmcnt(0)
  v_mfma_f32_16x16x32_bf16 v[100:103], v[14:17], v[88:91], 0
  v_cvt_pk_bf16_f32 v70, v70, v71
  v_cvt_pk_bf16_f32 v71, v74, v75
  v_mfma_f32_16x16x32_bf16 v[100:103], v[18:21], v[96:99], v[100:103]
  v_cvt_pk_bf16_f32 v76, v76, v77
  v_cvt_pk_bf16_f32 v77, v80, v81
  v_mfma_f32_16x16x32_bf16 v[100:103], v[22:25], v[104:107], v[100:103]
  v_cvt_pk_bf16_f32 v78, v78, v79
  v_cvt_pk_bf16_f32 v79, v82, v83
  v_mfma_f32_16x16x16_bf16 v[92:95], v[42:43], v[112:113], v[92:95]
  v_cvt_pk_bf16_f32 v84, v84, v85
  v_cvt_pk_bf16_f32 v85, v86, v87
  v_mfma_f32_16x16x32_bf16 v[108:111], v[14:17], v[60:63], 0
  v_mfma_f32_16x16x32_bf16 v[108:111], v[18:21], v[68:71], v[108:111]
  v_mfma_f32_16x16x32_bf16 v[108:111], v[22:25], v[76:79], v[108:111]
  ds_write_b128 v10, v[92:95] offset:2048
  v_mfma_f32_16x16x16_bf16 v[100:103], v[26:27], v[112:113], v[100:103]
  s_nop 1
  v_mfma_f32_16x16x16_bf16 v[108:111], v[26:27], v[84:85], v[108:111]
  s_nop 3
  ds_write_b128 v10, v[100:103] offset:1024
  s_nop 2
  ds_write_b128 v10, v[108:111]
  s_waitcnt lgkmcnt(0)
  s_barrier
  s_cmp_ge_u32 s8, 2
  s_cbranch_scc1 Q_m
  ds_read_b128 v[14:17], v11 offset:0
  ds_read_b128 v[18:21], v11 offset:1024
  ds_read_b128 v[22:25], v11 offset:4096
  ds_read_b128 v[26:29], v11 offset:5120
  ds_read_b128 v[30:33], v11 offset:8192
  ds_read_b128 v[34:37], v11 offset:9216
  ds_read_b128 v[38:41], v11 offset:12288
  ds_read_b128 v[92:95], v11 offset:13312
  s_waitcnt lgkmcnt(4)
  v_pk_add_f32 v[14:15], v[14:15], v[22:23]
  v_pk_add_f32 v[16:17], v[16:17], v[24:25]
  v_pk_add_f32 v[18:19], v[18:19], v[26:27]
  v_pk_add_f32 v[20:21], v[20:21], v[28:29]
  s_waitcnt lgkmcnt(2)
  v_pk_add_f32 v[14:15], v[14:15], v[30:31]
  v_pk_add_f32 v[16:17], v[16:17], v[32:33]
  v_pk_add_f32 v[18:19], v[18:19], v[34:35]
  v_pk_add_f32 v[20:21], v[20:21], v[36:37]
  s_waitcnt lgkmcnt(0)
  v_pk_add_f32 v[14:15], v[14:15], v[38:39]
  v_pk_add_f32 v[16:17], v[16:17], v[40:41]
  v_pk_add_f32 v[18:19], v[18:19], v[92:93]
  v_pk_add_f32 v[20:21], v[20:21], v[94:95]
  v_mov_b32 v25, 0xff800000
  v_cndmask_b32 v14, v25, v14, s[40:41]
  v_cndmask_b32 v15, v25, v15, s[42:43]
  v_cndmask_b32 v16, v25, v16, s[44:45]
  v_cndmask_b32 v17, v25, v17, s[46:47]
  v_cndmask_b32 v18, v25, v18, s[48:49]
  v_cndmask_b32 v19, v25, v19, s[50:51]
  v_cndmask_b32 v20, v25, v20, s[52:53]
  v_cndmask_b32 v21, v25, v21, s[54:55]
  v_max3_f32 v24, v14, v15, v16
  v_max3_f32 v24, v24, v17, v18
  v_max3_f32 v24, v24, v19, v20
  v_max_f32 v24, v24, v21
Q_m:
  s_waitcnt vmcnt(0)
  v_max3_u32 v12, v44, v45, v46
  v_max3_u32 v12, v12, v47, v48
  v_max3_u32 v12, v12, v49, v50
  v_max3_u32 v12, v12, v51, v52
  v_max3_u32 v12, v12, v53, v54
  v_max3_u32 v12, v12, v55, v56
  v_max_u32 v12, v12, v57
  v_cmp_eq_u32 vcc, -1, v12
  s_cbranch_vccz Q_mok
  buffer_load_dwordx4 v[44:47], v7, s[4:7], s13 offen sc1
  buffer_load_dwordx4 v[48:51], v7, s[4:7], s13 offen offset:128 sc1
  buffer_load_dwordx4 v[52:55], v8, s[4:7], s13 offen sc1
  buffer_load_dword v56, v9, s[4:7], s13 offen sc1
  buffer_load_dword v57, v9, s[4:7], s13 offen offset:8 sc1
  s_sub_u32 s99, s99, 1
  s_cbranch_scc1 FAIL
  s_branch Q_m
Q_mok:
  v_mfma_f32_16x16x32_bf16 v[64:67], v[44:47], v[60:63], 0
  v_mfma_f32_16x16x32_bf16 v[64:67], v[48:51], v[68:71], v[64:67]
  v_mfma_f32_16x16x32_bf16 v[64:67], v[52:55], v[76:79], v[64:67]
  v_mfma_f32_16x16x32_bf16 v[72:75], v[44:47], v[88:91], 0
  v_mfma_f32_16x16x32_bf16 v[72:75], v[48:51], v[96:99], v[72:75]
  v_mfma_f32_16x16x32_bf16 v[72:75], v[52:55], v[104:107], v[72:75]
  v_mfma_f32_16x16x16_bf16 v[64:67], v[56:57], v[84:85], v[64:67]
  s_nop 1
  v_mfma_f32_16x16x16_bf16 v[72:75], v[56:57], v[112:113], v[72:75]
  s_nop 3
  ds_write_b64 v10, v[64:65] offset:3072
  s_nop 2
  ds_write_b64 v10, v[72:73] offset:3080
  s_and_b32 s19, s8, 1
  s_mul_i32 s19, s19, 1016
  v_subrev_u32 v0, s19, v11
  s_waitcnt lgkmcnt(0)
  s_barrier
  s_cmp_ge_u32 s8, 2
  s_cbranch_scc1 Q_next
  ds_read_b64 v[30:31], v0 offset:3072
  ds_read_b64 v[32:33], v0 offset:7168
  ds_read_b64 v[34:35], v0 offset:11264
  ds_read_b64 v[36:37], v0 offset:15360
  s_waitcnt lgkmcnt(0)
  v_pk_add_f32 v[30:31], v[30:31], v[32:33]
  v_pk_add_f32 v[34:35], v[34:35], v[36:37]
  v_pk_add_f32 v[22:23], v[30:31], v[34:35]
  v_max3_f32 v24, v24, v22, v23
  v_mov_b32 v25, v24
  s_nop 1
  v_permlane16_swap_b32 v25, v24
  v_max_f32 v24, v24, v25
  v_mov_b32 v25, v24
  s_nop 1
  v_permlane32_swap_b32 v25, v24
  v_max_f32 v24, v24, v25
  v_pk_add_f32 v[14:15], v[14:15], v[24:25] op_sel_hi:[1,0] neg_lo:[0,1] neg_hi:[0,1]
  v_pk_add_f32 v[16:17], v[16:17], v[24:25] op_sel_hi:[1,0] neg_lo:[0,1] neg_hi:[0,1]
  v_pk_add_f32 v[18:19], v[18:19], v[24:25] op_sel_hi:[1,0] neg_lo:[0,1] neg_hi:[0,1]
  v_pk_add_f32 v[20:21], v[20:21], v[24:25] op_sel_hi:[1,0] neg_lo:[0,1] neg_hi:[0,1]
  v_pk_add_f32 v[22:23], v[22:23], v[24:25] op_sel_hi:[1,0] neg_lo:[0,1] neg_hi:[0,1]
  v_exp_f32 v14, v14
  v_exp_f32 v15, v15
  v_exp_f32 v16, v16
  v_exp_f32 v17, v17
  v_exp_f32 v18, v18
  v_exp_f32 v19, v19
  v_exp_f32 v20, v20
  v_exp_f32 v21, v21
  v_exp_f32 v22, v22
  v_exp_f32 v23, v23
  v_pk_add_f32 v[30:31], v[14:15], v[16:17]
  v_pk_add_f32 v[32:33], v[18:19], v[20:21]
  v_pk_add_f32 v[30:31], v[30:31], v[32:33]
  v_pk_add_f32 v[30:31], v[30:31], v[22:23]
  v_add_f32 v24, v30, v31
  v_mov_b32 v25, v24
  s_nop 1
  v_permlane16_swap_b32 v25, v24
  v_add_f32 v24, v24, v25
  v_mov_b32 v25, v24
  s_nop 1
  v_permlane32_swap_b32 v25, v24
  v_add_f32 v24, v24, v25
  v_rcp_f32 v24, v24
  s_nop 0
  v_pk_mul_f32 v[14:15], v[14:15], v[24:25] op_sel_hi:[1,0]
  v_pk_mul_f32 v[16:17], v[16:17], v[24:25] op_sel_hi:[1,0]
  v_pk_mul_f32 v[18:19], v[18:19], v[24:25] op_sel_hi:[1,0]
  v_pk_mul_f32 v[20:21], v[20:21], v[24:25] op_sel_hi:[1,0]
  v_pk_mul_f32 v[22:23], v[22:23], v[24:25] op_sel_hi:[1,0]
  v_cvt_pk_bf16_f32 v30, |v14|, |v18|
  v_cvt_pk_bf16_f32 v31, |v15|, |v19|
  v_cvt_pk_bf16_f32 v32, |v16|, |v20|
  v_cvt_pk_bf16_f32 v33, |v17|, |v21|
  buffer_store_dwordx4 v[30:33], v1, s[4:7], s14 offen sc1
  v_cvt_pk_bf16_f32 v34, |v22|, |v23|
  buffer_store_dword v34, v13, s[4:7], s15 offen sc1
Q_next:
  v_add_u32 v2, s18, v2
  v_add_u32 v4, s18, v4
  v_add_u32 v5, s18, v5
  v_add_u32 v6, s18, v6
  v_add_u32 v58, s18, v58
  s_sub_i32 s18, 0, s18
  s_add_u32 s16, s16, 2
  s_cmp_lt_u32 s16, 64
  s_cbranch_scc1 Q_loop
  s_branch RDONE
K1_rv:
  s_mul_i32 s14, s10, 43
  s_lshr_b32 s14, s14, 7
  s_mul_i32 s15, s14, 3
  s_sub_u32 s23, s10, s15
  s_mov_b32 s10, s14
  v_and_b32 v0, 63, v0
  v_lshlrev_b32 v1, 4, v0
  s_mul_i32 s19, s8, 7168
  v_add_u32 v6, s19, v1
  s_add_u32 s40, s19, 57344
  s_lshr_b32 s101, s10, 1
  s_lshl_b32 s101, s101, 11
  s_add_u32 s101, s101, 18921472
  v_mbcnt_lo_u32_b32 v61, -1, 0
  v_mbcnt_hi_u32_b32 v61, -1, v61
  s_cmp_lg_u32 s8, 0
  s_cbranch_scc1 wcd_202
  v_min_u32 v61, 15, v61
  v_lshlrev_b32 v61, 7, v61
  s_branch wc_201x
wc_201:
  s_sleep 2
wc_201x:
  buffer_load_dword v60, v61, s[4:7], s101 offen sc1
  s_sub_u32 s99, s99, 1
  s_cbranch_scc1 FAIL
  s_waitcnt vmcnt(0)
  v_cmp_eq_u32 vcc, 0, v60
  s_cbranch_vccnz wc_201
wcd_202:
  s_barrier
  s_cmp_lt_i32 s97, 0
  s_cbranch_scc1 nf_203
  s_mov_b32 s101, 18907136
  v_mbcnt_lo_u32_b32 v61, -1, 0
  v_mbcnt_hi_u32_b32 v61, -1, v61
  s_lshl_b32 s100, s8, 6
  v_add_u32 v61, s100, v61
  v_min_u32 v61, 255, v61
  v_lshlrev_b32 v61, 7, v61
  s_branch wc_204x
wc_204:
  s_sleep 2
wc_204x:
  buffer_load_dword v60, v61, s[4:7], s101 offen sc1
  s_sub_u32 s99, s99, 1
  s_cbranch_scc1 FAIL
  s_waitcnt vmcnt(0)
  v_cmp_eq_u32 vcc, 0, v60
  s_cbranch_vccnz wc_204
wcd_205:
  s_barrier
  v_mov_b32 v60, -1
  v_mov_b32 v61, -1
  v_mov_b32 v62, -1
  v_mov_b32 v63, -1
  s_lshl_b32 s100, s97, 2
  s_add_u32 s100, s100, s8
  s_lshl_b32 s100, s100, 10
  s_add_u32 s100, s100, 29753344
fl_206:
  s_cmp_ge_u32 s100, 32505856
  s_cbranch_scc1 fd_207
  buffer_store_dwordx4 v[60:63], v1, s[4:7], s100 offen sc1
  s_add_u32 s100, s100, 360448
  s_branch fl_206
fd_207:
  s_add_u32 s100, s100, 458752
fl_208:
  s_cmp_ge_u32 s100, 34340864
  s_cbranch_scc1 fd_209
  buffer_store_dwordx4 v[60:63], v1, s[4:7], s100 offen sc1
  s_add_u32 s100, s100, 360448
  s_branch fl_208
fd_209:
  s_add_u32 s100, s100, 458752
fl_210:
  s_cmp_ge_u32 s100, 36175872
  s_cbranch_scc1 fd_211
  buffer_store_dwordx4 v[60:63], v1, s[4:7], s100 offen sc1
  s_add_u32 s100, s100, 360448
  s_branch fl_210
fd_211:
  s_add_u32 s100, s100, 458752
fl_212:
  s_cmp_ge_u32 s100, 38010880
  s_cbranch_scc1 fd_213
  buffer_store_dwordx4 v[60:63], v1, s[4:7], s100 offen sc1
  s_add_u32 s100, s100, 360448
  s_branch fl_212
fd_213:
  s_add_u32 s100, s100, 458752
fl_214:
  s_cmp_ge_u32 s100, 39845888
  s_cbranch_scc1 fd_215
  buffer_store_dwordx4 v[60:63], v1, s[4:7], s100 offen sc1
  s_add_u32 s100, s100, 360448
  s_branch fl_214
fd_215:
  s_add_u32 s100, s100, 655360
fl_216:
  s_cmp_ge_u32 s100, 42467328
  s_cbranch_scc1 fd_217
  buffer_store_dwordx4 v[60:63], v1, s[4:7], s100 offen sc1
  s_add_u32 s100, s100, 360448
  s_branch fl_216
fd_217:
  s_add_u32 s100, s100, 655360
fl_218:
  s_cmp_ge_u32 s100, 45088768
  s_cbranch_scc1 fd_219
  buffer_store_dwordx4 v[60:63], v1, s[4:7], s100 offen sc1
  s_add_u32 s100, s100, 360448
  s_branch fl_218
fd_219:
  s_add_u32 s100, s100, 163840
fl_220:
  s_cmp_ge_u32 s100, 45744128
  s_cbranch_scc1 fd_221
  buffer_store_dwordx4 v[60:63], v1, s[4:7], s100 offen sc1
  s_add_u32 s100, s100, 360448
  s_branch fl_220
fd_221:
  s_add_u32 s100, s100, 163840
fl_222:
  s_cmp_ge_u32 s100, 46399488
  s_cbranch_scc1 fd_223
  buffer_store_dwordx4 v[60:63], v1, s[4:7], s100 offen sc1
  s_add_u32 s100, s100, 360448
  s_branch fl_222
fd_223:
  s_waitcnt vmcnt(0)
  s_barrier
  s_cmp_lg_u32 s8, 0
  s_cbranch_scc1 arr_224
  v_mov_b32 v60, 1
  s_mov_b64 exec, 1
  s_mov_b32 s100, 18903040
  buffer_atomic_add v60, off, s[4:7], s100 sc0
  s_waitcnt vmcnt(0)
  v_readfirstlane_b32 s100, v60
  s_cmp_lg_u32 s100, 87
  s_cbranch_scc1 arr_224x
  s_mov_b32 s100, 18903424
  s_nop 1
  buffer_store_dword v60, off, s[4:7], s100 sc1
arr_224x:
  s_mov_b64 exec, -1
arr_224:
nf_203:
  s_cmp_eq_u32 s11, 0
  s_cbranch_scc1 V_nl
  s_lshl_b32 s100, s10, 2
  s_add_u32 s100, s100, s8
  s_mul_i32 s100, s100, 114688
  s_add_u32 s100, s100, 7340032
  s_add_u32 s101, s100, 114688
  v_and_b32 v72, 63, v0
  v_lshlrev_b32 v72, 7, v72
  s_lshl_b32 s12, s23, 13
  s_add_u32 s100, s100, s12
ld_226:
  buffer_load_dword v73, v72, s[4:7], s100 offen
  s_add_u32 s100, s100, 24576
  s_cmp_lt_u32 s100, s101
  s_cbranch_scc1 ld_226
nl_225:
V_nl:
  s_lshl_b32 s19, s10, 2
  s_add_u32 s19, s19, s8
  s_mul_i32 s19, s19, 114688
  s_add_u32 s19, s19, 7340032
  buffer_load_dwordx4 a[0:3], v1, s[4:7], s19 offen offset:0
  buffer_load_dwordx4 a[4:7], v1, s[4:7], s19 offen offset:1024
  buffer_load_dwordx4 a[8:11], v1, s[4:7], s19 offen offset:2048
  buffer_load_dwordx4 a[12:15], v1, s[4:7], s19 offen offset:3072
  s_add_u32 s19, s19, 4096
  buffer_load_dwordx4 a[16:19], v1, s[4:7], s19 offen offset:0
  buffer_load_dwordx4 a[20:23], v1, s[4:7], s19 offen offset:1024
  buffer_load_dwordx4 a[24:27], v1, s[4:7], s19 offen offset:2048
  buffer_load_dwordx4 a[28:31], v1, s[4:7], s19 offen offset:3072
  s_add_u32 s19, s19, 4096
  buffer_load_dwordx4 a[32:35], v1, s[4:7], s19 offen offset:0
  buffer_load_dwordx4 a[36:39], v1, s[4:7], s19 offen offset:1024
  buffer_load_dwordx4 a[40:43], v1, s[4:7], s19 offen offset:2048
  buffer_load_dwordx4 a[44:47], v1, s[4:7], s19 offen offset:3072
  s_add_u32 s19, s19, 4096
  buffer_load_dwordx4 a[48:51], v1, s[4:7], s19 offen offset:0
  buffer_load_dwordx4 a[52:55], v1, s[4:7], s19 offen offset:1024
  buffer_load_dwordx4 a[56:59], v1, s[4:7], s19 offen offset:2048
  buffer_load_dwordx4 a[60:63], v1, s[4:7], s19 offen offset:3072
  s_add_u32 s19, s19, 4096
  buffer_load_dwordx4 a[64:67], v1, s[4:7], s19 offen offset:0
  buffer_load_dwordx4 a[68:71], v1, s[4:7], s19 offen offset:1024
  buffer_load_dwordx4 a[72:75], v1, s[4:7], s19 offen offset:2048
  buffer_load_dwordx4 a[76:79], v1, s[4:7], s19 offen offset:3072
  s_add_u32 s19, s19, 4096
  buffer_load_dwordx4 a[80:83], v1, s[4:7], s19 offen offset:0
  buffer_load_dwordx4 a[84:87], v1, s[4:7], s19 offen offset:1024
  buffer_load_dwordx4 a[88:91], v1, s[4:7], s19 offen offset:2048
  buffer_load_dwordx4 a[92:95], v1, s[4:7], s19 offen offset:3072
  s_add_u32 s19, s19, 4096
  buffer_load_dwordx4 a[96:99], v1, s[4:7], s19 offen offset:0
  buffer_load_dwordx4 a[100:103], v1, s[4:7], s19 offen offset:1024
  buffer_load_dwordx4 a[104:107], v1, s[4:7], s19 offen offset:2048
  buffer_load_dwordx4 a[108:111], v1, s[4:7], s19 offen offset:3072
  s_add_u32 s19, s19, 4096
  buffer_load_dwordx4 a[112:115], v1, s[4:7], s19 offen offset:0
  buffer_load_dwordx4 a[116:119], v1, s[4:7], s19 offen offset:1024
  buffer_load_dwordx4 a[120:123], v1, s[4:7], s19 offen offset:2048
  buffer_load_dwordx4 a[124:127], v1, s[4:7], s19 offen offset:3072
  s_add_u32 s19, s19, 4096
  buffer_load_dwordx4 a[128:131], v1, s[4:7], s19 offen offset:0
  buffer_load_dwordx4 a[132:135], v1, s[4:7], s19 offen offset:1024
  buffer_load_dwordx4 a[136:139], v1, s[4:7], s19 offen offset:2048
  buffer_load_dwordx4 a[140:143], v1, s[4:7], s19 offen offset:3072
  s_add_u32 s19, s19, 4096
  buffer_load_dwordx4 a[144:147], v1, s[4:7], s19 offen offset:0
  buffer_load_dwordx4 a[148:151], v1, s[4:7], s19 offen offset:1024
  buffer_load_dwordx4 a[152:155], v1, s[4:7], s19 offen offset:2048
  buffer_load_dwordx4 a[156:159], v1, s[4:7], s19 offen offset:3072
  s_add_u32 s19, s19, 4096
  buffer_load_dwordx4 a[160:163], v1, s[4:7], s19 offen offset:0
  buffer_load_dwordx4 a[164:167], v1, s[4:7], s19 offen offset:1024
  buffer_load_dwordx4 a[168:171], v1, s[4:7], s19 offen offset:2048
  buffer_load_dwordx4 a[172:175], v1, s[4:7], s19 offen offset:3072
  s_add_u32 s19, s19, 4096
  buffer_load_dwordx4 a[176:179], v1, s[4:7], s19 offen offset:0
  buffer_load_dwordx4 a[180:183], v1, s[4:7], s19 offen offset:1024
  buffer_load_dwordx4 a[184:187], v1, s[4:7], s19 offen offset:2048
  buffer_load_dwordx4 a[188:191], v1, s[4:7], s19 offen offset:3072
  s_add_u32 s19, s19, 4096
  buffer_load_dwordx4 a[192:195], v1, s[4:7], s19 offen offset:0
  buffer_load_dwordx4 a[196:199], v1, s[4:7], s19 offen offset:1024
  buffer_load_dwordx4 a[200:203], v1, s[4:7], s19 offen offset:2048
  buffer_load_dwordx4 a[204:207], v1, s[4:7], s19 offen offset:3072
  s_add_u32 s19, s19, 4096
  buffer_load_dwordx4 a[208:211], v1, s[4:7], s19 offen offset:0
  buffer_load_dwordx4 a[212:215], v1, s[4:7], s19 offen offset:1024
  buffer_load_dwordx4 a[216:219], v1, s[4:7], s19 offen offset:2048
  buffer_load_dwordx4 a[220:223], v1, s[4:7], s19 offen offset:3072
  s_add_u32 s19, s19, 4096
  buffer_load_dwordx4 a[224:227], v1, s[4:7], s19 offen offset:0
  buffer_load_dwordx4 a[228:231], v1, s[4:7], s19 offen offset:1024
  buffer_load_dwordx4 a[232:235], v1, s[4:7], s19 offen offset:2048
  buffer_load_dwordx4 a[236:239], v1, s[4:7], s19 offen offset:3072
  s_add_u32 s19, s19, 4096
  buffer_load_dwordx4 a[240:243], v1, s[4:7], s19 offen offset:0
  buffer_load_dwordx4 a[244:247], v1, s[4:7], s19 offen offset:1024
  buffer_load_dwordx4 a[248:251], v1, s[4:7], s19 offen offset:2048
  buffer_load_dwordx4 a[252:255], v1, s[4:7], s19 offen offset:3072
  s_add_u32 s19, s19, 4096
  buffer_load_dwordx4 v[120:123], v1, s[4:7], s19 offen offset:0
  buffer_load_dwordx4 v[124:127], v1, s[4:7], s19 offen offset:1024
  buffer_load_dwordx4 v[128:131], v1, s[4:7], s19 offen offset:2048
  buffer_load_dwordx4 v[132:135], v1, s[4:7], s19 offen offset:3072
  s_add_u32 s19, s19, 4096
  buffer_load_dwordx4 v[136:139], v1, s[4:7], s19 offen offset:0
  buffer_load_dwordx4 v[140:143], v1, s[4:7], s19 offen offset:1024
  buffer_load_dwordx4 v[144:147], v1, s[4:7], s19 offen offset:2048
  buffer_load_dwordx4 v[148:151], v1, s[4:7], s19 offen offset:3072
  s_add_u32 s19, s19, 4096
  buffer_load_dwordx4 v[152:155], v1, s[4:7], s19 offen offset:0
  buffer_load_dwordx4 v[156:159], v1, s[4:7], s19 offen offset:1024
  buffer_load_dwordx4 v[160:163], v1, s[4:7], s19 offen offset:2048
  buffer_load_dwordx4 v[164:167], v1, s[4:7], s19 offen offset:3072
  s_add_u32 s19, s19, 4096
  buffer_load_dwordx4 v[168:171], v1, s[4:7], s19 offen offset:0
  buffer_load_dwordx4 v[172:175], v1, s[4:7], s19 offen offset:1024
  buffer_load_dwordx4 v[176:179], v1, s[4:7], s19 offen offset:2048
  buffer_load_dwordx4 v[180:183], v1, s[4:7], s19 offen offset:3072
  s_add_u32 s19, s19, 4096
  buffer_load_dwordx4 v[184:187], v1, s[4:7], s19 offen offset:0
  buffer_load_dwordx4 v[188:191], v1, s[4:7], s19 offen offset:1024
  buffer_load_dwordx4 v[192:195], v1, s[4:7], s19 offen offset:2048
  buffer_load_dwordx4 v[196:199], v1, s[4:7], s19 offen offset:3072
  s_add_u32 s19, s19, 4096
  buffer_load_dwordx4 v[200:203], v1, s[4:7], s19 offen offset:0
  buffer_load_dwordx4 v[204:207], v1, s[4:7], s19 offen offset:1024
  buffer_load_dwordx4 v[208:211], v1, s[4:7], s19 offen offset:2048
  buffer_load_dwordx4 v[212:215], v1, s[4:7], s19 offen offset:3072
  s_add_u32 s19, s19, 4096
  buffer_load_dwordx4 v[216:219], v1, s[4:7], s19 offen offset:0
  buffer_load_dwordx4 v[220:223], v1, s[4:7], s19 offen offset:1024
  buffer_load_dwordx4 v[224:227], v1, s[4:7], s19 offen offset:2048
  buffer_load_dwordx4 v[228:231], v1, s[4:7], s19 offen offset:3072
  s_add_u32 s19, s19, 4096
  buffer_load_dwordx4 v[232:235], v1, s[4:7], s19 offen offset:0
  buffer_load_dwordx4 v[236:239], v1, s[4:7], s19 offen offset:1024
  buffer_load_dwordx4 v[240:243], v1, s[4:7], s19 offen offset:2048
  buffer_load_dwordx4 v[244:247], v1, s[4:7], s19 offen offset:3072
  s_add_u32 s19, s19, 4096
  buffer_load_dwordx4 v[248:251], v1, s[4:7], s19 offen offset:0
  buffer_load_dwordx4 v[252:255], v1, s[4:7], s19 offen offset:1024
  s_add_u32 s19, s19, 2048
  s_mul_i32 s20, s8, 14336
  s_add_u32 m0, s20, 0
  s_nop 0
  buffer_load_dwordx4 v1, s[4:7], s19 offen lds
  s_add_u32 s19, s19, 1024
  s_add_u32 m0, s20, 1024
  s_nop 0
  buffer_load_dwordx4 v1, s[4:7], s19 offen lds
  s_add_u32 s19, s19, 1024
  s_add_u32 m0, s20, 2048
  s_nop 0
  buffer_load_dwordx4 v1, s[4:7], s19 offen lds
  s_add_u32 s19, s19, 1024
  s_add_u32 m0, s20, 3072
  s_nop 0
  buffer_load_dwordx4 v1, s[4:7], s19 offen lds
  s_add_u32 s19, s19, 1024
  s_add_u32 m0, s20, 4096
  s_nop 0
  buffer_load_dwordx4 v1, s[4:7], s19 offen lds
  s_add_u32 s19, s19, 1024
  s_add_u32 m0, s20, 5120
  s_nop 0
  buffer_load_dwordx4 v1, s[4:7], s19 offen lds
  s_add_u32 s19, s19, 1024
  s_add_u32 m0, s20, 6144
  s_nop 0
  buffer_load_dwordx4 v1, s[4:7], s19 offen lds
  s_add_u32 s19, s19, 1024
  s_add_u32 m0, s20, 7168
  s_nop 0
  buffer_load_dwordx4 v1, s[4:7], s19 offen lds
  s_add_u32 s19, s19, 1024
  s_add_u32 m0, s20, 8192
  s_nop 0
  buffer_load_dwordx4 v1, s[4:7], s19 offen lds
  s_add_u32 s19, s19, 1024
  s_add_u32 m0, s20, 9216
  s_nop 0
  buffer_load_dwordx4 v1, s[4:7], s19 offen lds
  s_add_u32 s19, s19, 1024
  s_add_u32 m0, s20, 10240
  s_nop 0
  buffer_load_dwordx4 v1, s[4:7], s19 offen lds
  s_add_u32 s19, s19, 1024
  s_add_u32 m0, s20, 11264
  s_nop 0
  buffer_load_dwordx4 v1, s[4:7], s19 offen lds
  s_add_u32 s19, s19, 1024
  s_add_u32 m0, s20, 12288
  s_nop 0
  buffer_load_dwordx4 v1, s[4:7], s19 offen lds
  s_add_u32 s19, s19, 1024
  s_add_u32 m0, s20, 13312
  s_nop 0
  buffer_load_dwordx4 v1, s[4:7], s19 offen lds
  s_add_u32 s19, s19, 1024
  v_add_u32 v4, s20, v1
  s_mov_b32 vcc_lo, 0xaaaaaaaa
  s_mov_b32 vcc_hi, 0xaaaaaaaa
  v_mov_b32 v2, 0x44444444
  v_mov_b32 v60, 0xeeeeeeee
  v_cndmask_b32 v2, v2, v60, vcc
  v_mov_b32 v3, 0x0
  v_bfe_u32 v60, v0, 0, 4
  s_mov_b32 s100, 0x10
  v_mul_lo_u32 v60, v60, s100
  v_add_u32 v3, v3, v60
  v_bfe_u32 v60, v0, 4, 2
  s_mov_b32 s100, 0x200
  v_mul_lo_u32 v60, v60, s100
  v_add_u32 v3, v3, v60
  s_lshl_b32 s20, s8, 8
  s_lshl_b32 s19, s10, 11
  s_add_u32 s20, s20, s19
  s_cmp_lt_u32 s8, 2
  s_cselect_b32 s20, s20, 2146435072
  v_add_u32 v8, s20, v3
  v_mov_b32 v7, v3
  v_add_u32 v3, 57344, v3
  s_and_b32 s19, s8, 1
  s_lshl_b32 s20, s19, 11
  s_add_u32 s20, s20, 122880
  v_add_u32 v9, s20, v1
  s_lshl_b32 s19, s8, 13
  s_add_u32 s41, s19, 122880
  v_add_u32 v5, s41, v1
  v_add_u32 v11, 114688, v1
  s_lshl_b32 s45, s8, 11
  s_add_u32 s45, s45, 114688
  s_cmp_eq_u32 s11, 0
  s_cselect_b32 s19, 6, 6
  s_mov_b32 s21, s23
  s_sub_i32 s22, s23, s19
  s_mov_b32 s24, 28672
  s_mul_i32 s44, s11, 3
  s_add_u32 s44, s44, s23
  s_lshl_b32 s44, s44, 15
  s_add_u32 s44, s44, 62914560
  s_lshl_b32 s19, s10, 2
  s_add_u32 s19, s19, s8
  s_lshl_b32 s19, s19, 13
  s_mul_i32 s43, s11, 33554432
  s_add_u32 s43, s43, s19
  s_add_u32 s43, s43, 67108864
  s_mul_i32 s14, s11, 3
  s_add_u32 s14, s14, s23
  s_lshl_b32 s14, s14, 13
  s_lshr_b32 s19, s19, 6
  s_add_u32 s14, s14, s19
  s_add_u32 s14, s14, 18956288
  s_mov_b32 s101, 18907136
  v_mbcnt_lo_u32_b32 v61, -1, 0
  v_mbcnt_hi_u32_b32 v61, -1, v61
  s_lshl_b32 s100, s8, 6
  v_add_u32 v61, s100, v61
  v_min_u32 v61, 255, v61
  v_lshlrev_b32 v61, 7, v61
  s_branch wc_227x
wc_227:
  s_sleep 2
wc_227x:
  buffer_load_dword v60, v61, s[4:7], s101 offen sc1
  s_sub_u32 s99, s99, 1
  s_cbranch_scc1 FAIL
  s_waitcnt vmcnt(0)
  v_cmp_eq_u32 vcc, 0, v60
  s_cbranch_vccnz wc_227
wcd_228:
  s_barrier
  s_min_u32 s19, s23, 63
  s_mul_i32 s19, s19, 28672
  s_mul_i32 s12, s11, 7340032
  s_add_u32 s12, s12, s19
  s_add_u32 s12, s12, 25165824
  s_mov_b32 m0, s40
  s_nop 0
  buffer_load_dwordx4 v6, s[4:7], s12 offen offset:0 sc1 lds
  buffer_load_dwordx4 v6, s[4:7], s12 offen offset:1024 sc1 lds
  buffer_load_dwordx4 v6, s[4:7], s12 offen offset:2048 sc1 lds
  buffer_load_dwordx4 v6, s[4:7], s12 offen offset:3072 sc1 lds
  s_add_u32 m0, s40, 4096
  s_add_u32 s19, s12, 4096
  buffer_load_dwordx4 v6, s[4:7], s19 offen offset:0 sc1 lds
  buffer_load_dwordx4 v6, s[4:7], s19 offen offset:1024 sc1 lds
  buffer_load_dwordx4 v6, s[4:7], s19 offen offset:2048 sc1 lds
  s_mov_b32 s46, 127
  s_mov_b32 s47, -1
  s_waitcnt vmcnt(0)
V_loop:
  s_cmp_lt_u32 s21, 64
  s_cbranch_scc1 V_pre
  s_barrier
  ds_read_b128 v[88:91], v9 offset:0
  ds_read_b128 v[92:95], v9 offset:1024
  ds_read_b128 v[96:99], v9 offset:8192
  ds_read_b128 v[100:103], v9 offset:9216
  ds_read_b128 v[104:107], v9 offset:16384
  ds_read_b128 v[108:111], v9 offset:17408
  ds_read_b128 v[112:115], v9 offset:24576
  ds_read_b128 v[116:119], v9 offset:25600
  v_lshlrev_b32 v44, 16, v60
  v_and_b32 v45, 0xffff0000, v60
  v_lshlrev_b32 v46, 16, v61
  v_and_b32 v47, 0xffff0000, v61
  v_lshlrev_b32 v48, 16, v62
  v_and_b32 v49, 0xffff0000, v62
  v_lshlrev_b32 v50, 16, v63
  v_and_b32 v51, 0xffff0000, v63
  s_waitcnt lgkmcnt(6)
  v_pk_add_f32 v[44:45], v[44:45], v[88:89]
  v_pk_add_f32 v[46:47], v[46:47], v[90:91]
  v_pk_add_f32 v[48:49], v[48:49], v[92:93]
  v_pk_add_f32 v[50:51], v[50:51], v[94:95]
  s_waitcnt lgkmcnt(4)
  v_pk_add_f32 v[44:45], v[44:45], v[96:97]
  v_pk_add_f32 v[46:47], v[46:47], v[98:99]
  v_pk_add_f32 v[48:49], v[48:49], v[100:101]
  v_pk_add_f32 v[50:51], v[50:51], v[102:103]
  s_waitcnt lgkmcnt(2)
  v_pk_add_f32 v[44:45], v[44:45], v[104:105]
  v_pk_add_f32 v[46:47], v[46:47], v[106:107]
  v_pk_add_f32 v[48:49], v[48:49], v[108:109]
  v_pk_add_f32 v[50:51], v[50:51], v[110:111]
  s_waitcnt lgkmcnt(0)
  v_pk_add_f32 v[44:45], v[44:45], v[112:113]
  v_pk_add_f32 v[46:47], v[46:47], v[114:115]
  v_pk_add_f32 v[48:49], v[48:49], v[116:117]
  v_pk_add_f32 v[50:51], v[50:51], v[118:119]
  v_cvt_pk_bf16_f32 v44, v44, v45
  v_cvt_pk_bf16_f32 v45, v46, v47
  v_cvt_pk_bf16_f32 v46, v48, v49
  v_cvt_pk_bf16_f32 v47, v50, v51
  v_min_u32 v44, -2, v44
  v_min_u32 v45, -2, v45
  v_min_u32 v46, -2, v46
  v_min_u32 v47, -2, v47
  buffer_store_dwordx4 v[44:47], v8, s[4:7], s44 offen sc1
  s_cmp_lt_i32 s47, 0
  s_cbranch_scc1 vlf_229
  s_waitcnt vmcnt(1)
  s_add_u32 s100, s47, 1
  v_mov_b32 v10, s100
  s_mov_b64 exec, 1
  buffer_store_dword v10, off, s[4:7], s14 sc1
  s_mov_b64 exec, -1
  s_mov_b32 s47, -1
vlf_229:
  s_cmp_ge_i32 s22, 64
  s_cbranch_scc1 DONE
  s_max_i32 s20, s22, 0
  s_and_b32 s42, s20, 63
  s_mul_i32 s42, s42, 458752
  s_add_u32 s42, s42, s43
  s_cmp_lt_i32 s22, 0
  s_cselect_b32 s42, 25165824, s42
  s_mul_i32 s15, s20, 57344
  s_mul_i32 s100, s11, 28672
  s_add_u32 s15, s15, s100
  s_add_u32 s15, s15, 28850176
  s_lshl_b32 s100, s8, 11
  s_add_u32 s27, s15, s100
  s_mul_i32 s17, s20, 28672
  s_mul_i32 s100, s11, 7340032
  s_add_u32 s17, s17, s100
  s_add_u32 s17, s17, 27000832
  s_lshl_b32 s100, s11, 6
  s_add_u32 s20, s20, s100
  s_mul_i32 s18, s20, 28672
  s_add_u32 s18, s18, 36175872
  s_mul_i32 s16, s20, 40960
  s_add_u32 s16, s16, 39845888
  s_lshl_b32 s100, s8, 11
  s_add_u32 s26, s16, s100
  s_add_u32 s26, s26, 32768
  s_lshl_b32 s100, s8, 13
  s_add_u32 s16, s16, s100
  s_add_u32 s25, s16, 4096
  s_sub_u32 s13, s14, 18956288
  s_lshl_b32 s13, s13, 5
  s_add_u32 s13, s13, 63176704
  s_barrier
  s_mov_b32 m0, s41
  s_nop 0
  buffer_load_dwordx4 v1, s[4:7], s42 offen offset:0 sc1 lds
  buffer_load_dwordx4 v1, s[4:7], s42 offen offset:1024 sc1 lds
  buffer_load_dwordx4 v1, s[4:7], s42 offen offset:2048 sc1 lds
  buffer_load_dwordx4 v1, s[4:7], s42 offen offset:3072 sc1 lds
  s_add_u32 m0, s41, 4096
  s_add_u32 s42, s42, 4096
  buffer_load_dwordx4 v1, s[4:7], s42 offen offset:0 sc1 lds
  buffer_load_dwordx4 v1, s[4:7], s42 offen offset:1024 sc1 lds
  buffer_load_dwordx4 v1, s[4:7], s42 offen offset:2048 sc1 lds
  buffer_load_dwordx4 v1, s[4:7], s42 offen offset:3072 sc1 lds
  s_mov_b32 m0, s45
  s_nop 0
  buffer_load_dwordx4 v1, s[4:7], s27 offen sc1 lds
  buffer_load_dwordx4 v1, s[4:7], s27 offen offset:1024 sc1 lds
  s_waitcnt vmcnt(0)
  s_barrier
  ds_read_b128 v[12:15], v11 offset:0
  ds_read_b128 v[16:19], v11 offset:1024
  ds_read_b128 v[20:23], v11 offset:2048
  ds_read_b128 v[24:27], v11 offset:3072
  ds_read_b128 v[28:31], v11 offset:4096
  ds_read_b128 v[32:35], v11 offset:5120
  ds_read_b128 v[36:39], v11 offset:6144
  ds_read_b128 v[48:51], v4 offset:0
  ds_read_b128 v[52:55], v4 offset:1024
  ds_read_b128 v[56:59], v4 offset:2048
  ds_read_b128 v[60:63], v4 offset:3072
  v_mov_b64 v[40:41], 0
  v_mov_b64 v[42:43], 0
  v_mov_b64 v[44:45], 0
  v_mov_b64 v[46:47], 0
  s_waitcnt lgkmcnt(4)
  v_max3_u32 v10, v12, v16, v20
  v_max3_u32 v10, v10, v24, v28
  v_max3_u32 v10, v10, v32, v36
  v_cmp_eq_u32 vcc, -1, v10
  s_branch V_vm
V_pre:
  s_cmp_eq_u32 s11, 0
  s_cbranch_scc1 V_nochk
  v_add_u32 v0, s40, v1
  s_waitcnt vmcnt(0)
  ds_read2st64_b32 v[88:89], v0 offset0:0 offset1:4
  ds_read2st64_b32 v[90:91], v0 offset0:8 offset1:12
  ds_read2st64_b32 v[92:93], v0 offset0:16 offset1:20
  ds_read2st64_b32 v[94:95], v0 offset0:24 offset1:24
  s_waitcnt lgkmcnt(0)
  v_max3_u32 v10, v88, v89, v90
  v_max3_u32 v10, v10, v91, v92
  v_max3_u32 v10, v10, v93, v94
  v_cmp_eq_u32 vcc, -1, v10
  s_cbranch_vccz tok_230
  s_add_u32 s19, s12, 4096
stg_231:
  buffer_load_dwordx4 v[88:91], v6, s[4:7], s12 offen offset:0 sc1
  buffer_load_dwordx4 v[92:95], v6, s[4:7], s12 offen offset:1024 sc1
  buffer_load_dwordx4 v[96:99], v6, s[4:7], s12 offen offset:2048 sc1
  buffer_load_dwordx4 v[100:103], v6, s[4:7], s12 offen offset:3072 sc1
  buffer_load_dwordx4 v[104:107], v6, s[4:7], s19 offen offset:0 sc1
  buffer_load_dwordx4 v[108:111], v6, s[4:7], s19 offen offset:1024 sc1
  buffer_load_dwordx4 v[112:115], v6, s[4:7], s19 offen offset:2048 sc1
  s_sub_u32 s99, s99, 1
  s_cbranch_scc1 FAIL
  s_waitcnt vmcnt(6)
  ds_write_b128 v0, v[88:91] offset:0
  s_waitcnt vmcnt(5)
  ds_write_b128 v0, v[92:95] offset:1024
  s_waitcnt vmcnt(4)
  ds_write_b128 v0, v[96:99] offset:2048
  s_waitcnt vmcnt(3)
  ds_write_b128 v0, v[100:103] offset:3072
  s_waitcnt vmcnt(2)
  ds_write_b128 v0, v[104:107] offset:4096
  s_waitcnt vmcnt(1)
  ds_write_b128 v0, v[108:111] offset:5120
  s_waitcnt vmcnt(0)
  ds_write_b128 v0, v[112:115] offset:6144
  v_max3_u32 v10, v88, v92, v96
  v_max3_u32 v10, v10, v100, v104
  v_max3_u32 v10, v10, v108, v112
  v_cmp_eq_u32 vcc, -1, v10
  s_waitcnt lgkmcnt(0)
  s_cbranch_vccnz stg_231
tok_230:
V_nochk:
  s_barrier
  ds_read_b128 v[64:67], v3 offset:0
  ds_read_b128 v[68:71], v3 offset:256
  s_waitcnt lgkmcnt(0)
  v_mfma_f32_16x16x32_bf16 v[12:15], v[64:67], a[0:3], 0
  s_and_b32 s13, s21, 63
  ds_read_b128 v[72:75], v3 offset:2048
  v_mfma_f32_16x16x32_bf16 v[16:19], v[68:71], a[0:3], 0
  s_mul_i32 s13, s13, 458752
  ds_read_b128 v[76:79], v3 offset:2304
  v_mfma_f32_16x16x32_bf16 v[20:23], v[64:67], a[56:59], 0
  s_add_u32 s13, s13, s43
  ds_read_b128 v[88:91], v9 offset:0
  v_mfma_f32_16x16x32_bf16 v[24:27], v[68:71], a[56:59], 0
  s_add_u32 s20, s21, 3
  ds_read_b128 v[92:95], v9 offset:1024
  v_mfma_f32_16x16x32_bf16 v[28:31], v[64:67], a[112:115], 0
  s_add_u32 s40, s40, s24
  ds_read_b128 v[96:99], v9 offset:8192
  v_mfma_f32_16x16x32_bf16 v[32:35], v[68:71], a[112:115], 0
  s_min_u32 s19, s20, 63
  ds_read_b128 v[100:103], v9 offset:9216
  v_mfma_f32_16x16x32_bf16 v[36:39], v[64:67], a[168:171], 0
  s_mul_i32 s19, s19, 28672
  ds_read_b128 v[104:107], v9 offset:16384
  v_mfma_f32_16x16x32_bf16 v[40:43], v[68:71], a[168:171], 0
  s_waitcnt lgkmcnt(5)
  ds_read_b128 v[108:111], v9 offset:17408
  v_mfma_f32_16x16x32_bf16 v[12:15], v[72:75], a[4:7], v[12:15]
  s_mul_i32 s12, s11, 7340032
  ds_read_b128 v[64:67], v3 offset:4096
  v_mfma_f32_16x16x32_bf16 v[16:19], v[76:79], a[4:7], v[16:19]
  s_add_u32 s12, s12, s19
  ds_read_b128 v[68:71], v3 offset:4352
  v_mfma_f32_16x16x32_bf16 v[20:23], v[72:75], a[60:63], v[20:23]
  s_add_u32 s12, s12, 25165824
  ds_read_b128 v[112:115], v9 offset:24576
  v_mfma_f32_16x16x32_bf16 v[24:27], v[76:79], a[60:63], v[24:27]
  s_mov_b32 vcc_lo, s11
  ds_read_b128 v[116:119], v9 offset:25600
  v_lshlrev_b32 v44, 16, v60
  v_mfma_f32_16x16x32_bf16 v[28:31], v[72:75], a[116:119], v[28:31]
  s_mov_b32 vcc_hi, 0
  v_and_b32 v45, 0xffff0000, v60
  v_lshlrev_b32 v46, 16, v61
  v_mfma_f32_16x16x32_bf16 v[32:35], v[76:79], a[116:119], v[32:35]
  s_max_i32 s20, s22, 0
  v_and_b32 v47, 0xffff0000, v61
  v_lshlrev_b32 v48, 16, v62
  v_mfma_f32_16x16x32_bf16 v[36:39], v[72:75], a[172:175], v[36:39]
  s_and_b32 s42, s20, 63
  v_and_b32 v49, 0xffff0000, v62
  v_lshlrev_b32 v50, 16, v63
  v_mfma_f32_16x16x32_bf16 v[40:43], v[76:79], a[172:175], v[40:43]
  s_waitcnt lgkmcnt(2)
  v_and_b32 v51, 0xffff0000, v63
  v_add_f32 v44, v44, v88
  v_mfma_f32_16x16x32_bf16 v[12:15], v[64:67], a[8:11], v[12:15]
  s_mul_i32 s42, s42, 458752
  ds_read_b128 v[72:75], v3 offset:6144
  v_add_f32 v45, v45, v89
  v_mfma_f32_16x16x32_bf16 v[16:19], v[68:71], a[8:11], v[16:19]
  s_add_u32 s42, s42, s43
  ds_read_b128 v[76:79], v3 offset:6400
  v_add_f32 v46, v46, v90
  v_mfma_f32_16x16x32_bf16 v[20:23], v[64:67], a[64:67], v[20:23]
  s_cmp_lt_i32 s22, 0
  s_cselect_b32 s42, 25165824, s42
  v_add_f32 v47, v47, v91
  v_add_f32 v48, v48, v92
  v_mfma_f32_16x16x32_bf16 v[24:27], v[68:71], a[64:67], v[24:27]
  s_mul_i32 s15, s20, 57344
  v_add_f32 v49, v49, v93
  v_add_f32 v50, v50, v94
  v_mfma_f32_16x16x32_bf16 v[28:31], v[64:67], a[120:123], v[28:31]
  s_mul_i32 s100, s11, 28672
  v_add_f32 v51, v51, v95
  v_add_f32 v44, v44, v96
  v_mfma_f32_16x16x32_bf16 v[32:35], v[68:71], a[120:123], v[32:35]
  s_add_u32 s15, s15, s100
  v_add_f32 v45, v45, v97
  v_add_f32 v46, v46, v98
  v_mfma_f32_16x16x32_bf16 v[36:39], v[64:67], a[176:179], v[36:39]
  s_add_u32 s15, s15, 28850176
  v_add_f32 v47, v47, v99
  v_add_f32 v48, v48, v100
  v_mfma_f32_16x16x32_bf16 v[40:43], v[68:71], a[176:179], v[40:43]
  s_waitcnt lgkmcnt(0)
  v_add_f32 v49, v49, v101
  v_add_f32 v50, v50, v102
  v_mfma_f32_16x16x32_bf16 v[12:15], v[72:75], a[12:15], v[12:15]
  s_lshl_b32 s100, s8, 11
  ds_read_b128 v[64:67], v3 offset:8192
  v_add_f32 v51, v51, v103
  v_mfma_f32_16x16x32_bf16 v[16:19], v[76:79], a[12:15], v[16:19]
  s_add_u32 s27, s15, s100
  ds_read_b128 v[68:71], v3 offset:8448
  v_add_f32 v44, v44, v104
  v_mfma_f32_16x16x32_bf16 v[20:23], v[72:75], a[68:71], v[20:23]
  s_mul_i32 s17, s20, 28672
  v_add_f32 v45, v45, v105
  v_add_f32 v46, v46, v106
  v_mfma_f32_16x16x32_bf16 v[24:27], v[76:79], a[68:71], v[24:27]
  s_mul_i32 s100, s11, 7340032
  v_add_f32 v47, v47, v107
  v_add_f32 v48, v48, v108
  v_mfma_f32_16x16x32_bf16 v[28:31], v[72:75], a[124:127], v[28:31]
  s_add_u32 s17, s17, s100
  v_add_f32 v49, v49, v109
  v_add_f32 v50, v50, v110
  v_mfma_f32_16x16x32_bf16 v[32:35], v[76:79], a[124:127], v[32:35]
  s_add_u32 s17, s17, 27000832
  v_add_f32 v51, v51, v111
  v_add_f32 v44, v44, v112
  v_mfma_f32_16x16x32_bf16 v[36:39], v[72:75], a[180:183], v[36:39]
  s_lshl_b32 s100, s11, 6
  v_add_f32 v45, v45, v113
  v_add_f32 v46, v46, v114
  v_mfma_f32_16x16x32_bf16 v[40:43], v[76:79], a[180:183], v[40:43]
  s_waitcnt lgkmcnt(0)
  v_add_f32 v47, v47, v115
  v_add_f32 v48, v48, v116
  v_mfma_f32_16x16x32_bf16 v[12:15], v[64:67], a[16:19], v[12:15]
  s_add_u32 s20, s20, s100
  ds_read_b128 v[72:75], v3 offset:10240
  v_add_f32 v49, v49, v117
  v_mfma_f32_16x16x32_bf16 v[16:19], v[68:71], a[16:19], v[16:19]
  s_mul_i32 s18, s20, 28672
  ds_read_b128 v[76:79], v3 offset:10496
  v_add_f32 v50, v50, v118
  v_mfma_f32_16x16x32_bf16 v[20:23], v[64:67], a[72:75], v[20:23]
  s_add_u32 s18, s18, 36175872
  v_add_f32 v51, v51, v119
  v_cvt_pk_bf16_f32 v44, v44, v45
  v_mfma_f32_16x16x32_bf16 v[24:27], v[68:71], a[72:75], v[24:27]
  s_mul_i32 s16, s20, 40960
  v_cvt_pk_bf16_f32 v45, v46, v47
  v_cvt_pk_bf16_f32 v46, v48, v49
  v_mfma_f32_16x16x32_bf16 v[28:31], v[64:67], a[128:131], v[28:31]
  s_add_u32 s16, s16, 39845888
  v_cvt_pk_bf16_f32 v47, v50, v51
  v_min_u32 v44, -2, v44
  v_mfma_f32_16x16x32_bf16 v[32:35], v[68:71], a[128:131], v[32:35]
  s_lshl_b32 s100, s8, 11
  v_min_u32 v45, -2, v45
  v_min_u32 v46, -2, v46
  v_mfma_f32_16x16x32_bf16 v[36:39], v[64:67], a[184:187], v[36:39]
  s_add_u32 s26, s16, s100
  v_min_u32 v47, -2, v47
  v_mfma_f32_16x16x32_bf16 v[40:43], v[68:71], a[184:187], v[40:43]
  s_waitcnt lgkmcnt(0)
  buffer_store_dwordx4 v[44:47], v8, s[4:7], s44 offen sc1
  v_mfma_f32_16x16x32_bf16 v[12:15], v[72:75], a[20:23], v[12:15]
  s_add_u32 s26, s26, 32768
  ds_read_b128 v[64:67], v3 offset:12288
  v_mfma_f32_16x16x32_bf16 v[16:19], v[76:79], a[20:23], v[16:19]
  s_lshl_b32 s100, s8, 13
  ds_read_b128 v[68:71], v3 offset:12544
  v_mfma_f32_16x16x32_bf16 v[20:23], v[72:75], a[76:79], v[20:23]
  s_add_u32 s16, s16, s100
  v_mfma_f32_16x16x32_bf16 v[24:27], v[76:79], a[76:79], v[24:27]
  s_add_u32 s25, s16, 4096
  v_mfma_f32_16x16x32_bf16 v[28:31], v[72:75], a[132:135], v[28:31]
  v_mfma_f32_16x16x32_bf16 v[32:35], v[76:79], a[132:135], v[32:35]
  v_mfma_f32_16x16x32_bf16 v[36:39], v[72:75], a[188:191], v[36:39]
  v_mfma_f32_16x16x32_bf16 v[40:43], v[76:79], a[188:191], v[40:43]
  s_waitcnt lgkmcnt(0)
  v_mfma_f32_16x16x32_bf16 v[12:15], v[64:67], a[24:27], v[12:15]
  s_cmp_lt_i32 s47, 0
  s_cbranch_scc1 vlf_239
  s_waitcnt vmcnt(1)
  s_add_u32 s100, s47, 1
  v_mov_b32 v10, s100
  s_mov_b64 exec, 1
  buffer_store_dword v10, off, s[4:7], s14 sc1
  s_mov_b64 exec, -1
  s_mov_b32 s47, -1
vlf_239:
  s_barrier
  ds_read_b128 v[72:75], v3 offset:14336
  v_mfma_f32_16x16x32_bf16 v[16:19], v[68:71], a[24:27], v[16:19]
  ds_read_b128 v[76:79], v3 offset:14592
  v_mfma_f32_16x16x32_bf16 v[20:23], v[64:67], a[80:83], v[20:23]
  v_mfma_f32_16x16x32_bf16 v[24:27], v[68:71], a[80:83], v[24:27]
  s_mov_b32 m0, s41
  s_nop 0
  buffer_load_dwordx4 v1, s[4:7], s42 offen offset:0 sc1 lds
  v_mfma_f32_16x16x32_bf16 v[28:31], v[64:67], a[136:139], v[28:31]
  v_mfma_f32_16x16x32_bf16 v[32:35], v[68:71], a[136:139], v[32:35]
  v_mfma_f32_16x16x32_bf16 v[36:39], v[64:67], a[192:195], v[36:39]
  buffer_load_dwordx4 v1, s[4:7], s42 offen offset:1024 sc1 lds
  v_mfma_f32_16x16x32_bf16 v[40:43], v[68:71], a[192:195], v[40:43]
  s_waitcnt lgkmcnt(0)
  v_mfma_f32_16x16x32_bf16 v[12:15], v[72:75], a[28:31], v[12:15]
  ds_read_b128 v[64:67], v3 offset:16384
  v_mfma_f32_16x16x32_bf16 v[16:19], v[76:79], a[28:31], v[16:19]
  ds_read_b128 v[68:71], v3 offset:16640
  v_mfma_f32_16x16x32_bf16 v[20:23], v[72:75], a[84:87], v[20:23]
  v_mfma_f32_16x16x32_bf16 v[24:27], v[76:79], a[84:87], v[24:27]
  buffer_load_dwordx4 v1, s[4:7], s42 offen offset:2048 sc1 lds
  v_mfma_f32_16x16x32_bf16 v[28:31], v[72:75], a[140:143], v[28:31]
  v_mfma_f32_16x16x32_bf16 v[32:35], v[76:79], a[140:143], v[32:35]
  v_mfma_f32_16x16x32_bf16 v[36:39], v[72:75], a[196:199], v[36:39]
  buffer_load_dwordx4 v1, s[4:7], s42 offen offset:3072 sc1 lds
  v_mfma_f32_16x16x32_bf16 v[40:43], v[76:79], a[196:199], v[40:43]
  s_waitcnt lgkmcnt(0)
  v_mfma_f32_16x16x32_bf16 v[12:15], v[64:67], a[32:35], v[12:15]
  ds_read_b128 v[72:75], v3 offset:18432
  v_mfma_f32_16x16x32_bf16 v[16:19], v[68:71], a[32:35], v[16:19]
  ds_read_b128 v[76:79], v3 offset:18688
  v_mfma_f32_16x16x32_bf16 v[20:23], v[64:67], a[88:91], v[20:23]
  v_mfma_f32_16x16x32_bf16 v[24:27], v[68:71], a[88:91], v[24:27]
  s_add_u32 m0, s41, 4096
  s_add_u32 s42, s42, 4096
  buffer_load_dwordx4 v1, s[4:7], s42 offen offset:0 sc1 lds
  v_mfma_f32_16x16x32_bf16 v[28:31], v[64:67], a[144:147], v[28:31]
  v_mfma_f32_16x16x32_bf16 v[32:35], v[68:71], a[144:147], v[32:35]
  v_mfma_f32_16x16x32_bf16 v[36:39], v[64:67], a[200:203], v[36:39]
  buffer_load_dwordx4 v1, s[4:7], s42 offen offset:1024 sc1 lds
  v_mfma_f32_16x16x32_bf16 v[40:43], v[68:71], a[200:203], v[40:43]
  s_waitcnt lgkmcnt(0)
  v_mfma_f32_16x16x32_bf16 v[12:15], v[72:75], a[36:39], v[12:15]
  ds_read_b128 v[64:67], v3 offset:20480
  v_mfma_f32_16x16x32_bf16 v[16:19], v[76:79], a[36:39], v[16:19]
  ds_read_b128 v[68:71], v3 offset:20736
  v_mfma_f32_16x16x32_bf16 v[20:23], v[72:75], a[92:95], v[20:23]
  v_mfma_f32_16x16x32_bf16 v[24:27], v[76:79], a[92:95], v[24:27]
  buffer_load_dwordx4 v1, s[4:7], s42 offen offset:2048 sc1 lds
  v_mfma_f32_16x16x32_bf16 v[28:31], v[72:75], a[148:151], v[28:31]
  v_mfma_f32_16x16x32_bf16 v[32:35], v[76:79], a[148:151], v[32:35]
  v_mfma_f32_16x16x32_bf16 v[36:39], v[72:75], a[204:207], v[36:39]
  buffer_load_dwordx4 v1, s[4:7], s42 offen offset:3072 sc1 lds
  v_mfma_f32_16x16x32_bf16 v[40:43], v[76:79], a[204:207], v[40:43]
  s_waitcnt lgkmcnt(0)
  v_mfma_f32_16x16x32_bf16 v[12:15], v[64:67], a[40:43], v[12:15]
  ds_read_b128 v[72:75], v3 offset:22528
  v_mfma_f32_16x16x32_bf16 v[16:19], v[68:71], a[40:43], v[16:19]
  ds_read_b128 v[76:79], v3 offset:22784
  v_mfma_f32_16x16x32_bf16 v[20:23], v[64:67], a[96:99], v[20:23]
  v_mfma_f32_16x16x32_bf16 v[24:27], v[68:71], a[96:99], v[24:27]
  s_cbranch_vccnz vx_232
  s_mov_b32 m0, s40
  s_nop 0
  buffer_load_dwordx4 v6, s[4:7], s12 offen offset:0 sc1 lds
vx_232:
  v_mfma_f32_16x16x32_bf16 v[28:31], v[64:67], a[152:155], v[28:31]
  v_mfma_f32_16x16x32_bf16 v[32:35], v[68:71], a[152:155], v[32:35]
  v_mfma_f32_16x16x32_bf16 v[36:39], v[64:67], a[208:211], v[36:39]
  s_cbranch_vccnz vx_233
  buffer_load_dwordx4 v6, s[4:7], s12 offen offset:1024 sc1 lds
vx_233:
  v_mfma_f32_16x16x32_bf16 v[40:43], v[68:71], a[208:211], v[40:43]
  s_waitcnt lgkmcnt(0)
  v_mfma_f32_16x16x32_bf16 v[12:15], v[72:75], a[44:47], v[12:15]
  ds_read_b128 v[64:67], v3 offset:24576
  v_mfma_f32_16x16x32_bf16 v[16:19], v[76:79], a[44:47], v[16:19]
  ds_read_b128 v[68:71], v3 offset:24832
  v_mfma_f32_16x16x32_bf16 v[20:23], v[72:75], a[100:103], v[20:23]
  v_mfma_f32_16x16x32_bf16 v[24:27], v[76:79], a[100:103], v[24:27]
  s_cbranch_vccnz vx_234
  buffer_load_dwordx4 v6, s[4:7], s12 offen offset:2048 sc1 lds
vx_234:
  v_mfma_f32_16x16x32_bf16 v[28:31], v[72:75], a[156:159], v[28:31]
  v_mfma_f32_16x16x32_bf16 v[32:35], v[76:79], a[156:159], v[32:35]
  v_mfma_f32_16x16x32_bf16 v[36:39], v[72:75], a[212:215], v[36:39]
  s_cbranch_vccnz vx_235
  buffer_load_dwordx4 v6, s[4:7], s12 offen offset:3072 sc1 lds
vx_235:
  v_mfma_f32_16x16x32_bf16 v[40:43], v[76:79], a[212:215], v[40:43]
  s_waitcnt lgkmcnt(0)
  v_mfma_f32_16x16x32_bf16 v[12:15], v[64:67], a[48:51], v[12:15]
  ds_read_b128 v[72:75], v3 offset:26624
  v_mfma_f32_16x16x32_bf16 v[16:19], v[68:71], a[48:51], v[16:19]
  ds_read_b128 v[76:79], v3 offset:26880
  v_mfma_f32_16x16x32_bf16 v[20:23], v[64:67], a[104:107], v[20:23]
  v_mfma_f32_16x16x32_bf16 v[24:27], v[68:71], a[104:107], v[24:27]
  s_cbranch_vccnz vx_236
  s_add_u32 m0, s40, 4096
  s_add_u32 s19, s12, 4096
  buffer_load_dwordx4 v6, s[4:7], s19 offen offset:0 sc1 lds
vx_236:
  v_mfma_f32_16x16x32_bf16 v[28:31], v[64:67], a[160:163], v[28:31]
  v_mfma_f32_16x16x32_bf16 v[32:35], v[68:71], a[160:163], v[32:35]
  v_mfma_f32_16x16x32_bf16 v[36:39], v[64:67], a[216:219], v[36:39]
  s_cbranch_vccnz vx_237
  buffer_load_dwordx4 v6, s[4:7], s19 offen offset:1024 sc1 lds
vx_237:
  v_mfma_f32_16x16x32_bf16 v[40:43], v[68:71], a[216:219], v[40:43]
  s_waitcnt lgkmcnt(0)
  v_mfma_f32_16x16x32_bf16 v[12:15], v[72:75], a[52:55], v[12:15]
  ds_read_b128 v[64:67], v3 offset:0
  v_mfma_f32_16x16x32_bf16 v[16:19], v[76:79], a[52:55], v[16:19]
  ds_read_b128 v[68:71], v3 offset:256
  v_mfma_f32_16x16x32_bf16 v[20:23], v[72:75], a[108:111], v[20:23]
  ds_read_b128 v[80:83], v4 offset:0
  v_mfma_f32_16x16x32_bf16 v[24:27], v[76:79], a[108:111], v[24:27]
  s_cbranch_vccnz vx_238
  buffer_load_dwordx4 v6, s[4:7], s19 offen offset:2048 sc1 lds
vx_238:
  v_mfma_f32_16x16x32_bf16 v[28:31], v[72:75], a[164:167], v[28:31]
  v_mfma_f32_16x16x32_bf16 v[32:35], v[76:79], a[164:167], v[32:35]
  v_mfma_f32_16x16x32_bf16 v[36:39], v[72:75], a[220:223], v[36:39]
  v_mfma_f32_16x16x32_bf16 v[40:43], v[76:79], a[220:223], v[40:43]
  s_waitcnt lgkmcnt(0)
  v_mfma_f32_16x16x32_bf16 v[88:91], v[64:67], a[224:227], 0
  ds_read_b128 v[72:75], v3 offset:2048
  v_mfma_f32_16x16x32_bf16 v[92:95], v[68:71], a[224:227], 0
  ds_read_b128 v[76:79], v3 offset:2304
  v_cvt_pk_bf16_f32 v12, v12, v16
  v_mfma_f32_16x16x32_bf16 v[96:99], v[64:67], v[144:147], 0
  ds_read_b128 v[84:87], v4 offset:1024
  v_cvt_pk_bf16_f32 v13, v13, v17
  v_mfma_f32_16x16x32_bf16 v[100:103], v[68:71], v[144:147], 0
  v_cvt_pk_bf16_f32 v14, v14, v18
  v_cvt_pk_bf16_f32 v15, v15, v19
  v_mfma_f32_16x16x32_bf16 v[104:107], v[64:67], v[200:203], 0
  buffer_store_dwordx4 v[12:15], v1, s[4:7], s13 offen offset:0 sc1
  v_cvt_pk_bf16_f32 v20, v20, v24
  v_mfma_f32_16x16x32_bf16 v[108:111], v[68:71], v[200:203], 0
  v_cvt_pk_bf16_f32 v21, v21, v25
  v_cvt_pk_bf16_f32 v22, v22, v26
  v_mfma_f32_16x16x32_bf16 v[112:115], v[64:67], v[80:83], 0
  v_cvt_pk_bf16_f32 v23, v23, v27
  v_mfma_f32_16x16x32_bf16 v[116:119], v[68:71], v[80:83], 0
  s_waitcnt lgkmcnt(0)
  buffer_store_dwordx4 v[20:23], v1, s[4:7], s13 offen offset:2048 sc1
  v_cvt_pk_bf16_f32 v28, v28, v32
  v_mfma_f32_16x16x32_bf16 v[88:91], v[72:75], a[228:231], v[88:91]
  ds_read_b128 v[64:67], v3 offset:4096
  v_cvt_pk_bf16_f32 v29, v29, v33
  v_mfma_f32_16x16x32_bf16 v[92:95], v[76:79], a[228:231], v[92:95]
  ds_read_b128 v[68:71], v3 offset:4352
  v_cvt_pk_bf16_f32 v30, v30, v34
  v_mfma_f32_16x16x32_bf16 v[96:99], v[72:75], v[148:151], v[96:99]
  ds_read_b128 v[80:83], v4 offset:2048
  v_cvt_pk_bf16_f32 v31, v31, v35
  v_mfma_f32_16x16x32_bf16 v[100:103], v[76:79], v[148:151], v[100:103]
  buffer_store_dwordx4 v[28:31], v1, s[4:7], s13 offen offset:1024 sc1
  v_cvt_pk_bf16_f32 v36, v36, v40
  v_mfma_f32_16x16x32_bf16 v[104:107], v[72:75], v[204:207], v[104:107]
  v_cvt_pk_bf16_f32 v37, v37, v41
  v_cvt_pk_bf16_f32 v38, v38, v42
  v_mfma_f32_16x16x32_bf16 v[108:111], v[76:79], v[204:207], v[108:111]
  v_cvt_pk_bf16_f32 v39, v39, v43
  v_mfma_f32_16x16x32_bf16 v[112:115], v[72:75], v[84:87], v[112:115]
  buffer_store_dwordx4 v[36:39], v1, s[4:7], s13 offen offset:3072 sc1
  v_mfma_f32_16x16x32_bf16 v[116:119], v[76:79], v[84:87], v[116:119]
  s_waitcnt lgkmcnt(0)
  v_mfma_f32_16x16x32_bf16 v[88:91], v[64:67], a[232:235], v[88:91]
  ds_read_b128 v[72:75], v3 offset:6144
  v_mfma_f32_16x16x32_bf16 v[92:95], v[68:71], a[232:235], v[92:95]
  ds_read_b128 v[76:79], v3 offset:6400
  v_mfma_f32_16x16x32_bf16 v[96:99], v[64:67], v[152:155], v[96:99]
  ds_read_b128 v[84:87], v4 offset:3072
  v_mfma_f32_16x16x32_bf16 v[100:103], v[68:71], v[152:155], v[100:103]
  v_mfma_f32_16x16x32_bf16 v[104:107], v[64:67], v[208:211], v[104:107]
  v_mfma_f32_16x16x32_bf16 v[108:111], v[68:71], v[208:211], v[108:111]
  v_mfma_f32_16x16x32_bf16 v[112:115], v[64:67], v[80:83], v[112:115]
  v_mfma_f32_16x16x32_bf16 v[116:119], v[68:71], v[80:83], v[116:119]
  s_waitcnt lgkmcnt(0)
  v_mfma_f32_16x16x32_bf16 v[88:91], v[72:75], a[236:239], v[88:91]
  ds_read_b128 v[64:67], v3 offset:8192
  v_mfma_f32_16x16x32_bf16 v[92:95], v[76:79], a[236:239], v[92:95]
  ds_read_b128 v[68:71], v3 offset:8448
  v_mfma_f32_16x16x32_bf16 v[96:99], v[72:75], v[156:159], v[96:99]
  ds_read_b128 v[80:83], v4 offset:4096
  v_mfma_f32_16x16x32_bf16 v[100:103], v[76:79], v[156:159], v[100:103]
  v_mfma_f32_16x16x32_bf16 v[104:107], v[72:75], v[212:215], v[104:107]
  v_mfma_f32_16x16x32_bf16 v[108:111], v[76:79], v[212:215], v[108:111]
  v_mfma_f32_16x16x32_bf16 v[112:115], v[72:75], v[84:87], v[112:115]
  v_mfma_f32_16x16x32_bf16 v[116:119], v[76:79], v[84:87], v[116:119]
  s_waitcnt lgkmcnt(0)
  v_mfma_f32_16x16x32_bf16 v[88:91], v[64:67], a[240:243], v[88:91]
  ds_read_b128 v[72:75], v3 offset:10240
  v_mfma_f32_16x16x32_bf16 v[92:95], v[68:71], a[240:243], v[92:95]
  ds_read_b128 v[76:79], v3 offset:10496
  v_mfma_f32_16x16x32_bf16 v[96:99], v[64:67], v[160:163], v[96:99]
  ds_read_b128 v[84:87], v4 offset:5120
  v_mfma_f32_16x16x32_bf16 v[100:103], v[68:71], v[160:163], v[100:103]
  s_mov_b32 m0, s45
  s_nop 0
  buffer_load_dwordx4 v1, s[4:7], s27 offen sc1 lds
  v_mfma_f32_16x16x32_bf16 v[104:107], v[64:67], v[216:219], v[104:107]
  v_mfma_f32_16x16x32_bf16 v[108:111], v[68:71], v[216:219], v[108:111]
  v_mfma_f32_16x16x32_bf16 v[112:115], v[64:67], v[80:83], v[112:115]
  buffer_load_dwordx4 v1, s[4:7], s27 offen offset:1024 sc1 lds
  v_mfma_f32_16x16x32_bf16 v[116:119], v[68:71], v[80:83], v[116:119]
  s_waitcnt lgkmcnt(0)
  v_mfma_f32_16x16x32_bf16 v[88:91], v[72:75], a[244:247], v[88:91]
  ds_read_b128 v[64:67], v3 offset:12288
  v_mfma_f32_16x16x32_bf16 v[92:95], v[76:79], a[244:247], v[92:95]
  ds_read_b128 v[68:71], v3 offset:12544
  v_mfma_f32_16x16x32_bf16 v[96:99], v[72:75], v[164:167], v[96:99]
  ds_read_b128 v[80:83], v4 offset:6144
  v_mfma_f32_16x16x32_bf16 v[100:103], v[76:79], v[164:167], v[100:103]
  v_mfma_f32_16x16x32_bf16 v[104:107], v[72:75], v[220:223], v[104:107]
  v_mfma_f32_16x16x32_bf16 v[108:111], v[76:79], v[220:223], v[108:111]
  v_mfma_f32_16x16x32_bf16 v[112:115], v[72:75], v[84:87], v[112:115]
  v_mfma_f32_16x16x32_bf16 v[116:119], v[76:79], v[84:87], v[116:119]
  s_waitcnt lgkmcnt(0)
  v_mfma_f32_16x16x32_bf16 v[88:91], v[64:67], a[248:251], v[88:91]
  ds_read_b128 v[72:75], v3 offset:14336
  v_mfma_f32_16x16x32_bf16 v[92:95], v[68:71], a[248:251], v[92:95]
  ds_read_b128 v[76:79], v3 offset:14592
  v_mfma_f32_16x16x32_bf16 v[96:99], v[64:67], v[168:171], v[96:99]
  ds_read_b128 v[84:87], v4 offset:7168
  v_mfma_f32_16x16x32_bf16 v[100:103], v[68:71], v[168:171], v[100:103]
  v_mfma_f32_16x16x32_bf16 v[104:107], v[64:67], v[224:227], v[104:107]
  v_mfma_f32_16x16x32_bf16 v[108:111], v[68:71], v[224:227], v[108:111]
  v_mfma_f32_16x16x32_bf16 v[112:115], v[64:67], v[80:83], v[112:115]
  v_mfma_f32_16x16x32_bf16 v[116:119], v[68:71], v[80:83], v[116:119]
  s_waitcnt lgkmcnt(0)
  v_mfma_f32_16x16x32_bf16 v[88:91], v[72:75], a[252:255], v[88:91]
  ds_read_b128 v[64:67], v3 offset:16384
  v_mfma_f32_16x16x32_bf16 v[92:95], v[76:79], a[252:255], v[92:95]
  ds_read_b128 v[68:71], v3 offset:16640
  v_mfma_f32_16x16x32_bf16 v[96:99], v[72:75], v[172:175], v[96:99]
  ds_read_b128 v[80:83], v4 offset:8192
  v_mfma_f32_16x16x32_bf16 v[100:103], v[76:79], v[172:175], v[100:103]
  v_mfma_f32_16x16x32_bf16 v[104:107], v[72:75], v[228:231], v[104:107]
  v_mfma_f32_16x16x32_bf16 v[108:111], v[76:79], v[228:231], v[108:111]
  v_mfma_f32_16x16x32_bf16 v[112:115], v[72:75], v[84:87], v[112:115]
  v_mfma_f32_16x16x32_bf16 v[116:119], v[76:79], v[84:87], v[116:119]
  s_waitcnt lgkmcnt(0)
  v_mfma_f32_16x16x32_bf16 v[88:91], v[64:67], v[120:123], v[88:91]
  ds_read_b128 v[72:75], v3 offset:18432
  v_mfma_f32_16x16x32_bf16 v[92:95], v[68:71], v[120:123], v[92:95]
  ds_read_b128 v[76:79], v3 offset:18688
  v_mfma_f32_16x16x32_bf16 v[96:99], v[64:67], v[176:179], v[96:99]
  ds_read_b128 v[84:87], v4 offset:9216
  v_mfma_f32_16x16x32_bf16 v[100:103], v[68:71], v[176:179], v[100:103]
  v_mfma_f32_16x16x32_bf16 v[104:107], v[64:67], v[232:235], v[104:107]
  v_mfma_f32_16x16x32_bf16 v[108:111], v[68:71], v[232:235], v[108:111]
  v_mfma_f32_16x16x32_bf16 v[112:115], v[64:67], v[80:83], v[112:115]
  v_mfma_f32_16x16x32_bf16 v[116:119], v[68:71], v[80:83], v[116:119]
  s_waitcnt lgkmcnt(0)
  v_mfma_f32_16x16x32_bf16 v[88:91], v[72:75], v[124:127], v[88:91]
  ds_read_b128 v[64:67], v3 offset:20480
  v_mfma_f32_16x16x32_bf16 v[92:95], v[76:79], v[124:127], v[92:95]
  ds_read_b128 v[68:71], v3 offset:20736
  v_mfma_f32_16x16x32_bf16 v[96:99], v[72:75], v[180:183], v[96:99]
  ds_read_b128 v[80:83], v4 offset:10240
  v_mfma_f32_16x16x32_bf16 v[100:103], v[76:79], v[180:183], v[100:103]
  v_mfma_f32_16x16x32_bf16 v[104:107], v[72:75], v[236:239], v[104:107]
  v_mfma_f32_16x16x32_bf16 v[108:111], v[76:79], v[236:239], v[108:111]
  v_mfma_f32_16x16x32_bf16 v[112:115], v[72:75], v[84:87], v[112:115]
  v_mfma_f32_16x16x32_bf16 v[116:119], v[76:79], v[84:87], v[116:119]
  s_waitcnt lgkmcnt(0)
  v_mfma_f32_16x16x32_bf16 v[88:91], v[64:67], v[128:131], v[88:91]
  s_waitcnt vmcnt(0)
  s_barrier
  ds_read_b128 v[72:75], v3 offset:22528
  v_mfma_f32_16x16x32_bf16 v[92:95], v[68:71], v[128:131], v[92:95]
  ds_read_b128 v[76:79], v3 offset:22784
  v_mfma_f32_16x16x32_bf16 v[96:99], v[64:67], v[184:187], v[96:99]
  ds_read_b128 v[84:87], v4 offset:11264
  v_mfma_f32_16x16x32_bf16 v[100:103], v[68:71], v[184:187], v[100:103]
  ds_read_b128 v[12:15], v11 offset:0
  v_mfma_f32_16x16x32_bf16 v[104:107], v[64:67], v[240:243], v[104:107]
  ds_read_b128 v[16:19], v11 offset:1024
  v_mfma_f32_16x16x32_bf16 v[108:111], v[68:71], v[240:243], v[108:111]
  ds_read_b128 v[20:23], v11 offset:2048
  v_mfma_f32_16x16x32_bf16 v[112:115], v[64:67], v[80:83], v[112:115]
  ds_read_b128 v[24:27], v11 offset:3072
  v_mfma_f32_16x16x32_bf16 v[116:119], v[68:71], v[80:83], v[116:119]
  s_waitcnt lgkmcnt(4)
  ds_read_b128 v[28:31], v11 offset:4096
  v_mfma_f32_16x16x32_bf16 v[88:91], v[72:75], v[132:135], v[88:91]
  ds_read_b128 v[64:67], v3 offset:24576
  v_mfma_f32_16x16x32_bf16 v[92:95], v[76:79], v[132:135], v[92:95]
  ds_read_b128 v[68:71], v3 offset:24832
  v_mfma_f32_16x16x32_bf16 v[96:99], v[72:75], v[188:191], v[96:99]
  ds_read_b128 v[80:83], v4 offset:12288
  v_mfma_f32_16x16x32_bf16 v[100:103], v[76:79], v[188:191], v[100:103]
  ds_read_b128 v[32:35], v11 offset:5120
  v_mfma_f32_16x16x32_bf16 v[104:107], v[72:75], v[244:247], v[104:107]
  ds_read_b128 v[36:39], v11 offset:6144
  v_mfma_f32_16x16x32_bf16 v[108:111], v[76:79], v[244:247], v[108:111]
  ds_read_b128 v[48:51], v4 offset:0
  v_mfma_f32_16x16x32_bf16 v[112:115], v[72:75], v[84:87], v[112:115]
  ds_read_b128 v[52:55], v4 offset:1024
  v_mfma_f32_16x16x32_bf16 v[116:119], v[76:79], v[84:87], v[116:119]
  s_waitcnt lgkmcnt(4)
  ds_read_b128 v[56:59], v4 offset:2048
  v_mfma_f32_16x16x32_bf16 v[88:91], v[64:67], v[136:139], v[88:91]
  ds_read_b128 v[72:75], v3 offset:26624
  v_mfma_f32_16x16x32_bf16 v[92:95], v[68:71], v[136:139], v[92:95]
  ds_read_b128 v[76:79], v3 offset:26880
  v_mfma_f32_16x16x32_bf16 v[96:99], v[64:67], v[192:195], v[96:99]
  ds_read_b128 v[84:87], v4 offset:13312
  v_mfma_f32_16x16x32_bf16 v[100:103], v[68:71], v[192:195], v[100:103]
  ds_read_b128 v[60:63], v4 offset:3072
  v_mov_b64 v[40:41], 0
  v_mfma_f32_16x16x32_bf16 v[104:107], v[64:67], v[248:251], v[104:107]
  v_mov_b64 v[42:43], 0
  v_mov_b64 v[44:45], 0
  v_mfma_f32_16x16x32_bf16 v[108:111], v[68:71], v[248:251], v[108:111]
  v_mov_b64 v[46:47], 0
  s_waitcnt lgkmcnt(7)
  v_max3_u32 v10, v12, v16, v20
  v_mfma_f32_16x16x32_bf16 v[112:115], v[64:67], v[80:83], v[112:115]
  v_max3_u32 v10, v10, v24, v28
  v_max3_u32 v10, v10, v32, v36
  v_mfma_f32_16x16x32_bf16 v[116:119], v[68:71], v[80:83], v[116:119]
  s_waitcnt lgkmcnt(1)
  v_cmp_eq_u32 vcc, -1, v10
  v_mfma_f32_16x16x32_bf16 v[88:91], v[72:75], v[140:143], v[88:91]
  s_add_u32 s13, s13, 4096
  v_mfma_f32_16x16x32_bf16 v[92:95], v[76:79], v[140:143], v[92:95]
  v_mfma_f32_16x16x32_bf16 v[96:99], v[72:75], v[196:199], v[96:99]
  v_mfma_f32_16x16x32_bf16 v[100:103], v[76:79], v[196:199], v[100:103]
  v_cvt_pk_bf16_f32 v88, v88, v92
  v_cvt_pk_bf16_f32 v89, v89, v93
  v_mfma_f32_16x16x32_bf16 v[104:107], v[72:75], v[252:255], v[104:107]
  v_cvt_pk_bf16_f32 v90, v90, v94
  v_cvt_pk_bf16_f32 v91, v91, v95
  v_mfma_f32_16x16x32_bf16 v[108:111], v[76:79], v[252:255], v[108:111]
  buffer_store_dwordx4 v[88:91], v1, s[4:7], s13 offen offset:0 sc1
  v_cvt_pk_bf16_f32 v96, v96, v100
  v_mfma_f32_16x16x32_bf16 v[112:115], v[72:75], v[84:87], v[112:115]
  v_cvt_pk_bf16_f32 v97, v97, v101
  v_cvt_pk_bf16_f32 v98, v98, v102
  v_mfma_f32_16x16x32_bf16 v[116:119], v[76:79], v[84:87], v[116:119]
  v_cvt_pk_bf16_f32 v99, v99, v103
  buffer_store_dwordx4 v[96:99], v1, s[4:7], s13 offen offset:2048 sc1
  v_add_u32 v3, s24, v3
  s_sub_i32 s24, 0, s24
  s_cmp_lt_i32 s22, 0
  s_cbranch_scc1 V_nopost
V_vm:
  s_cbranch_vccnz V_mbad
V_mok:
  v_smfmac_f32_16x16x64_bf16 v[40:43], v[12:15], a[0:7], v2
  v_cvt_pk_bf16_f32 v104, v104, v108
  v_smfmac_f32_16x16x64_bf16 v[40:43], v[16:19], a[8:15], v2
  v_cvt_pk_bf16_f32 v105, v105, v109
  v_smfmac_f32_16x16x64_bf16 v[40:43], v[20:23], a[16:23], v2
  v_cvt_pk_bf16_f32 v106, v106, v110
  v_smfmac_f32_16x16x64_bf16 v[40:43], v[24:27], a[24:31], v2
  v_cvt_pk_bf16_f32 v107, v107, v111
  v_smfmac_f32_16x16x64_bf16 v[40:43], v[28:31], a[32:39], v2
  buffer_store_dwordx4 v[104:107], v1, s[4:7], s13 offen offset:1024 sc1
  v_smfmac_f32_16x16x64_bf16 v[40:43], v[32:35], a[40:47], v2
  v_mov_b64 v[64:65], 0
  v_mov_b64 v[66:67], 0
  v_smfmac_f32_16x16x64_bf16 v[40:43], v[36:39], a[48:55], v2
  v_cvt_pk_bf16_f32 v112, v112, v116
  v_cvt_pk_bf16_f32 v113, v113, v117
  s_waitcnt lgkmcnt(2)
  v_smfmac_f32_16x16x64_bf16 v[64:67], v[12:15], v[48:55], v2
  v_cvt_pk_bf16_f32 v114, v114, v118
  v_cvt_pk_bf16_f32 v115, v115, v119
  v_smfmac_f32_16x16x64_bf16 v[44:47], v[12:15], a[56:63], v2
  buffer_store_dwordx4 v[112:115], v1, s[4:7], s13 offen offset:3072 sc1
  v_add_f32 v40, v40, v41
  v_smfmac_f32_16x16x64_bf16 v[44:47], v[16:19], a[64:71], v2
  v_add_f32 v42, v42, v43
  v_smfmac_f32_16x16x64_bf16 v[44:47], v[20:23], a[72:79], v2
  buffer_load_dwordx4 v[76:79], v7, s[4:7], s26 offen offset:0 sc1
  v_cvt_pk_bf16_f32 v68, v40, v42
  v_smfmac_f32_16x16x64_bf16 v[44:47], v[24:27], a[80:87], v2
  v_mov_b64 v[40:41], 0
  v_smfmac_f32_16x16x64_bf16 v[44:47], v[28:31], a[88:95], v2
  buffer_load_dwordx4 v[80:83], v7, s[4:7], s26 offen offset:256 sc1
  v_mov_b64 v[42:43], 0
  v_smfmac_f32_16x16x64_bf16 v[44:47], v[32:35], a[96:103], v2
  ds_read_b128 v[48:51], v4 offset:4096
  v_smfmac_f32_16x16x64_bf16 v[44:47], v[36:39], a[104:111], v2
  ds_read_b128 v[52:55], v4 offset:5120
  s_waitcnt lgkmcnt(2)
  v_smfmac_f32_16x16x64_bf16 v[64:67], v[16:19], v[56:63], v2
  buffer_load_dwordx4 v[84:87], v8, s[4:7], s17 offen sc1
  v_smfmac_f32_16x16x64_bf16 v[40:43], v[12:15], a[112:119], v2
  v_add_f32 v44, v44, v45
  v_smfmac_f32_16x16x64_bf16 v[40:43], v[16:19], a[120:127], v2
  v_add_f32 v46, v46, v47
  v_smfmac_f32_16x16x64_bf16 v[40:43], v[20:23], a[128:135], v2
  buffer_load_dwordx4 v[88:91], v1, s[4:7], s16 offen offset:0 sc1
  v_cvt_pk_bf16_f32 v72, v44, v46
  v_smfmac_f32_16x16x64_bf16 v[40:43], v[24:27], a[136:143], v2
  v_mov_b64 v[44:45], 0
  v_smfmac_f32_16x16x64_bf16 v[40:43], v[28:31], a[144:151], v2
  buffer_load_dwordx4 v[92:95], v1, s[4:7], s16 offen offset:1024 sc1
  v_mov_b64 v[46:47], 0
  v_smfmac_f32_16x16x64_bf16 v[40:43], v[32:35], a[152:159], v2
  ds_read_b128 v[56:59], v4 offset:6144
  v_smfmac_f32_16x16x64_bf16 v[40:43], v[36:39], a[160:167], v2
  ds_read_b128 v[60:63], v4 offset:7168
  s_waitcnt lgkmcnt(2)
  v_smfmac_f32_16x16x64_bf16 v[64:67], v[20:23], v[48:55], v2
  buffer_load_dwordx4 v[96:99], v1, s[4:7], s16 offen offset:2048 sc1
  v_smfmac_f32_16x16x64_bf16 v[44:47], v[12:15], a[168:175], v2
  v_add_f32 v40, v40, v41
  v_smfmac_f32_16x16x64_bf16 v[44:47], v[16:19], a[176:183], v2
  v_add_f32 v42, v42, v43
  v_smfmac_f32_16x16x64_bf16 v[44:47], v[20:23], a[184:191], v2
  buffer_load_dwordx4 v[100:103], v1, s[4:7], s16 offen offset:3072 sc1
  v_cvt_pk_bf16_f32 v69, v40, v42
  v_smfmac_f32_16x16x64_bf16 v[44:47], v[24:27], a[192:199], v2
  v_mov_b64 v[40:41], 0
  v_smfmac_f32_16x16x64_bf16 v[44:47], v[28:31], a[200:207], v2
  buffer_load_dwordx4 v[104:107], v1, s[4:7], s25 offen offset:0 sc1
  v_mov_b64 v[42:43], 0
  v_smfmac_f32_16x16x64_bf16 v[44:47], v[32:35], a[208:215], v2
  ds_read_b128 v[48:51], v4 offset:8192
  v_smfmac_f32_16x16x64_bf16 v[44:47], v[36:39], a[216:223], v2
  ds_read_b128 v[52:55], v4 offset:9216
  s_waitcnt lgkmcnt(2)
  v_smfmac_f32_16x16x64_bf16 v[64:67], v[24:27], v[56:63], v2
  buffer_load_dwordx4 v[108:111], v1, s[4:7], s25 offen offset:1024 sc1
  v_smfmac_f32_16x16x64_bf16 v[40:43], v[12:15], a[224:231], v2
  v_add_f32 v44, v44, v45
  v_smfmac_f32_16x16x64_bf16 v[40:43], v[16:19], a[232:239], v2
  v_add_f32 v46, v46, v47
  v_smfmac_f32_16x16x64_bf16 v[40:43], v[20:23], a[240:247], v2
  buffer_load_dwordx4 v[112:115], v1, s[4:7], s25 offen offset:2048 sc1
  v_cvt_pk_bf16_f32 v73, v44, v46
  v_smfmac_f32_16x16x64_bf16 v[40:43], v[24:27], a[248:255], v2
  v_mov_b64 v[44:45], 0
  v_smfmac_f32_16x16x64_bf16 v[40:43], v[28:31], v[120:127], v2
  buffer_load_dwordx4 v[116:119], v1, s[4:7], s25 offen offset:3072 sc1
  v_mov_b64 v[46:47], 0
  v_smfmac_f32_16x16x64_bf16 v[40:43], v[32:35], v[128:135], v2
  ds_read_b128 v[56:59], v4 offset:10240
  v_smfmac_f32_16x16x64_bf16 v[40:43], v[36:39], v[136:143], v2
  ds_read_b128 v[60:63], v4 offset:11264
  s_waitcnt lgkmcnt(2)
  v_smfmac_f32_16x16x64_bf16 v[64:67], v[28:31], v[48:55], v2
  v_smfmac_f32_16x16x64_bf16 v[44:47], v[12:15], v[144:151], v2
  v_add_f32 v40, v40, v41
  v_smfmac_f32_16x16x64_bf16 v[44:47], v[16:19], v[152:159], v2
  v_add_f32 v42, v42, v43
  v_smfmac_f32_16x16x64_bf16 v[44:47], v[20:23], v[160:167], v2
  v_cvt_pk_bf16_f32 v70, v40, v42
  v_smfmac_f32_16x16x64_bf16 v[44:47], v[24:27], v[168:175], v2
  v_mov_b64 v[40:41], 0
  v_smfmac_f32_16x16x64_bf16 v[44:47], v[28:31], v[176:183], v2
  v_mov_b64 v[42:43], 0
  v_smfmac_f32_16x16x64_bf16 v[44:47], v[32:35], v[184:191], v2
  ds_read_b128 v[48:51], v4 offset:12288
  v_smfmac_f32_16x16x64_bf16 v[44:47], v[36:39], v[192:199], v2
  ds_read_b128 v[52:55], v4 offset:13312
  s_waitcnt lgkmcnt(2)
  v_smfmac_f32_16x16x64_bf16 v[64:67], v[32:35], v[56:63], v2
  s_cmp_ge_u32 s21, 64
  s_cbranch_scc1 V_nf
  s_cmp_eq_u32 s11, 0
  s_cbranch_scc1 V_nf
  s_waitcnt vmcnt(11)
  s_add_u32 s100, s21, 1
  v_mov_b32 v10, s100
  s_mov_b64 exec, 1
  buffer_store_dword v10, off, s[4:7], s14 sc1
  s_mov_b64 exec, -1
V_nf:
  v_smfmac_f32_16x16x64_bf16 v[40:43], v[12:15], v[200:207], v2
  v_add_f32 v44, v44, v45
  v_smfmac_f32_16x16x64_bf16 v[40:43], v[16:19], v[208:215], v2
  v_add_f32 v46, v46, v47
  v_smfmac_f32_16x16x64_bf16 v[40:43], v[20:23], v[216:223], v2
  v_cvt_pk_bf16_f32 v74, v44, v46
  v_smfmac_f32_16x16x64_bf16 v[40:43], v[24:27], v[224:231], v2
  v_smfmac_f32_16x16x64_bf16 v[40:43], v[28:31], v[232:239], v2
  v_smfmac_f32_16x16x64_bf16 v[40:43], v[32:35], v[240:247], v2
  v_smfmac_f32_16x16x64_bf16 v[40:43], v[36:39], v[248:255], v2
  s_waitcnt lgkmcnt(0)
  v_smfmac_f32_16x16x64_bf16 v[64:67], v[36:39], v[48:55], v2
  ds_read_b128 v[12:15], v5 offset:0
  ds_read_b128 v[16:19], v5 offset:1024
  ds_read_b128 v[20:23], v5 offset:2048
  ds_read_b128 v[24:27], v5 offset:3072
  ds_read_b128 v[28:31], v5 offset:4096
  ds_read_b128 v[32:35], v5 offset:5120
  ds_read_b128 v[36:39], v5 offset:6144
  v_add_f32 v40, v40, v41
  v_add_f32 v42, v42, v43
  v_cvt_pk_bf16_f32 v71, v40, v42
  v_add_f32 v64, v64, v65
  v_add_f32 v66, v66, v67
  v_cvt_pk_bf16_f32 v75, v64, v66
  ds_read_b128 v[40:43], v5 offset:7168
  v_permlane32_swap_b32 v68, v70
  v_permlane32_swap_b32 v69, v71
  v_permlane32_swap_b32 v72, v74
  v_permlane32_swap_b32 v73, v75
  v_permlane16_swap_b32 v68, v69
  v_permlane16_swap_b32 v70, v71
  v_permlane16_swap_b32 v72, v73
  v_permlane16_swap_b32 v74, v75
  s_cmp_ge_u32 s21, 64
  s_cbranch_scc1 V_w0
  s_cmp_eq_u32 s11, 0
  s_cbranch_scc1 V_w0
  s_mov_b32 m0, s40
  s_nop 0
  buffer_load_dwordx4 v6, s[4:7], s12 offen offset:0 sc1 lds
  buffer_load_dwordx4 v6, s[4:7], s12 offen offset:1024 sc1 lds
  buffer_load_dwordx4 v6, s[4:7], s12 offen offset:2048 sc1 lds
  buffer_load_dwordx4 v6, s[4:7], s12 offen offset:3072 sc1 lds
  s_add_u32 m0, s40, 4096
  s_add_u32 s19, s12, 4096
  buffer_load_dwordx4 v6, s[4:7], s19 offen offset:0 sc1 lds
  buffer_load_dwordx4 v6, s[4:7], s19 offen offset:1024 sc1 lds
  buffer_load_dwordx4 v6, s[4:7], s19 offen offset:2048 sc1 lds
  s_waitcnt vmcnt(8)
  s_branch V_w1
V_w0:
  s_waitcnt vmcnt(0)
V_w1:
  v_max3_u32 v10, v88, v92, v96
  v_max3_u32 v10, v10, v100, v104
  v_max3_u32 v10, v10, v108, v112
  v_max3_u32 v10, v10, v116, v76
  v_max3_u32 v10, v10, v77, v78
  v_max3_u32 v10, v10, v79, v80
  v_max3_u32 v10, v10, v81, v82
  v_max3_u32 v10, v10, v83, v84
  v_cmp_eq_u32 vcc, -1, v10
  s_cbranch_vccz V_pok
  buffer_load_dwordx4 v[76:79], v7, s[4:7], s26 offen offset:0 sc1
  buffer_load_dwordx4 v[80:83], v7, s[4:7], s26 offen offset:256 sc1
  buffer_load_dwordx4 v[84:87], v8, s[4:7], s17 offen sc1
  buffer_load_dwordx4 v[88:91], v1, s[4:7], s16 offen offset:0 sc1
  buffer_load_dwordx4 v[92:95], v1, s[4:7], s16 offen offset:1024 sc1
  buffer_load_dwordx4 v[96:99], v1, s[4:7], s16 offen offset:2048 sc1
  buffer_load_dwordx4 v[100:103], v1, s[4:7], s16 offen offset:3072 sc1
  buffer_load_dwordx4 v[104:107], v1, s[4:7], s25 offen offset:0 sc1
  buffer_load_dwordx4 v[108:111], v1, s[4:7], s25 offen offset:1024 sc1
  buffer_load_dwordx4 v[112:115], v1, s[4:7], s25 offen offset:2048 sc1
  buffer_load_dwordx4 v[116:119], v1, s[4:7], s25 offen offset:3072 sc1
  s_sub_u32 s99, s99, 1
  s_cbranch_scc1 FAIL
  s_branch V_w0
V_pok:
  s_waitcnt lgkmcnt(0)
  v_mfma_f32_16x16x32_bf16 v[44:47], v[68:71], v[76:79], 0
  v_mfma_f32_16x16x32_bf16 v[44:47], v[12:15], v[88:91], v[44:47]
  v_mfma_f32_16x16x32_bf16 v[44:47], v[16:19], v[96:99], v[44:47]
  v_mfma_f32_16x16x32_bf16 v[44:47], v[28:31], v[104:107], v[44:47]
  v_mfma_f32_16x16x32_bf16 v[44:47], v[32:35], v[112:115], v[44:47]
  v_mfma_f32_16x16x32_bf16 v[48:51], v[72:75], v[76:79], 0
  v_mfma_f32_16x16x32_bf16 v[48:51], v[20:23], v[88:91], v[48:51]
  v_mfma_f32_16x16x32_bf16 v[48:51], v[24:27], v[96:99], v[48:51]
  ds_write_b128 v5, v[44:47] offset:0
  v_mfma_f32_16x16x32_bf16 v[48:51], v[36:39], v[104:107], v[48:51]
  v_mfma_f32_16x16x32_bf16 v[48:51], v[40:43], v[112:115], v[48:51]
  v_mfma_f32_16x16x32_bf16 v[52:55], v[68:71], v[80:83], 0
  v_mfma_f32_16x16x32_bf16 v[52:55], v[12:15], v[92:95], v[52:55]
  v_mfma_f32_16x16x32_bf16 v[52:55], v[16:19], v[100:103], v[52:55]
  ds_write_b128 v5, v[48:51] offset:1024
  v_mfma_f32_16x16x32_bf16 v[52:55], v[28:31], v[108:111], v[52:55]
  v_mfma_f32_16x16x32_bf16 v[52:55], v[32:35], v[116:119], v[52:55]
  v_mfma_f32_16x16x32_bf16 v[56:59], v[72:75], v[80:83], 0
  v_mfma_f32_16x16x32_bf16 v[56:59], v[20:23], v[92:95], v[56:59]
  v_mfma_f32_16x16x32_bf16 v[56:59], v[24:27], v[100:103], v[56:59]
  ds_write_b128 v5, v[52:55] offset:2048
  v_mfma_f32_16x16x32_bf16 v[56:59], v[36:39], v[108:111], v[56:59]
  v_mfma_f32_16x16x32_bf16 v[56:59], v[40:43], v[116:119], v[56:59]
  v_mov_b64 v[60:61], v[84:85]
  v_mov_b64 v[62:63], v[86:87]
  s_mov_b32 s44, s18
  s_mov_b32 s46, s22
  s_nop 3
  ds_write_b128 v5, v[56:59] offset:3072
  s_cmp_ge_u32 s21, 64
  s_cbranch_scc1 V_next
  s_cmp_eq_u32 s11, 0
  s_cbranch_scc0 V_next
  s_branch V_fl
V_mbad:
  s_add_u32 s19, s15, 4096
  buffer_load_dwordx4 v[12:15], v1, s[4:7], s15 offen offset:0 sc1
  buffer_load_dwordx4 v[16:19], v1, s[4:7], s15 offen offset:1024 sc1
  buffer_load_dwordx4 v[20:23], v1, s[4:7], s15 offen offset:2048 sc1
  buffer_load_dwordx4 v[24:27], v1, s[4:7], s15 offen offset:3072 sc1
  buffer_load_dwordx4 v[28:31], v1, s[4:7], s19 offen offset:0 sc1
  buffer_load_dwordx4 v[32:35], v1, s[4:7], s19 offen offset:1024 sc1
  buffer_load_dwordx4 v[36:39], v1, s[4:7], s19 offen offset:2048 sc1
  s_sub_u32 s99, s99, 1
  s_cbranch_scc1 FAIL
  s_waitcnt vmcnt(0)
  v_max3_u32 v10, v12, v16, v20
  v_max3_u32 v10, v10, v24, v28
  v_max3_u32 v10, v10, v32, v36
  v_cmp_eq_u32 vcc, -1, v10
  s_branch V_vm
V_nopost:
  v_cvt_pk_bf16_f32 v104, v104, v108
  v_cvt_pk_bf16_f32 v105, v105, v109
  v_cvt_pk_bf16_f32 v106, v106, v110
  v_cvt_pk_bf16_f32 v107, v107, v111
  buffer_store_dwordx4 v[104:107], v1, s[4:7], s13 offen offset:1024 sc1
  v_cvt_pk_bf16_f32 v112, v112, v116
  v_cvt_pk_bf16_f32 v113, v113, v117
  v_cvt_pk_bf16_f32 v114, v114, v118
  v_cvt_pk_bf16_f32 v115, v115, v119
  buffer_store_dwordx4 v[112:115], v1, s[4:7], s13 offen offset:3072 sc1
  s_cmp_eq_u32 s11, 0
  s_cbranch_scc1 V_fl
  s_mov_b32 m0, s40
  s_nop 0
  buffer_load_dwordx4 v6, s[4:7], s12 offen offset:0 sc1 lds
  buffer_load_dwordx4 v6, s[4:7], s12 offen offset:1024 sc1 lds
  buffer_load_dwordx4 v6, s[4:7], s12 offen offset:2048 sc1 lds
  buffer_load_dwordx4 v6, s[4:7], s12 offen offset:3072 sc1 lds
  s_add_u32 m0, s40, 4096
  s_add_u32 s19, s12, 4096
  buffer_load_dwordx4 v6, s[4:7], s19 offen offset:0 sc1 lds
  buffer_load_dwordx4 v6, s[4:7], s19 offen offset:1024 sc1 lds
  buffer_load_dwordx4 v6, s[4:7], s19 offen offset:2048 sc1 lds
  s_waitcnt vmcnt(7)
  s_add_u32 s100, s21, 1
  v_mov_b32 v10, s100
  s_mov_b64 exec, 1
  buffer_store_dword v10, off, s[4:7], s14 sc1
  s_mov_b64 exec, -1
  s_branch V_next
V_fl:
  s_mov_b32 s47, s21
V_next:
  s_add_u32 s21, s21, 3
  s_add_i32 s22, s22, 3
  s_waitcnt lgkmcnt(0)
  s_branch V_loop
RDONE:
  s_cmp_lt_i32 s96, 0
  s_cbranch_scc1 DONE
  s_mov_b32 s10, s96
  s_waitcnt vmcnt(0) lgkmcnt(0)
  s_barrier
  s_branch K1_rp
FAIL:
  s_mov_b64 exec, 1
  v_mov_b32 v5, 1
  buffer_atomic_add v5, off, s[92:95], 0 offset:68
DONE:
K1_end:
  s_endpgm
.section .rodata,"a"
.p2align 6
.amdhsa_kernel interleave_layers__memory_aug_recurrent_mem_tr__mixer_channel_mlp__prompt_kernel
  .amdhsa_next_free_vgpr 512
  .amdhsa_next_free_sgpr 102
  .amdhsa_accum_offset 256
  .amdhsa_group_segment_fixed_size 0
  .amdhsa_kernarg_size 120
  .amdhsa_user_sgpr_count 2
  .amdhsa_user_sgpr_kernarg_segment_ptr 1
  .amdhsa_system_sgpr_workgroup_id_x 1
  .amdhsa_float_denorm_mode_32 3
.end_amdhsa_kernel
```
